```python
import torch

def _softmax(x, axis=-1):
    return torch.softmax(x, dim=axis)
def _gelu(x):
    return torch.nn.functional.gelu(x, approximate="tanh")
def _silu(x):
    return torch.nn.functional.silu(x)
def _sigmoid(x):
    return torch.sigmoid(x)
def _layernorm(x, axis=-1, eps=1e-5):
    m = x.mean(dim=axis, keepdim=True)
    v = x.var(dim=axis, keepdim=True, unbiased=False)
    return (x - m) / torch.sqrt(v + eps)
def _scatter_add(tgt, idx, src, axis=0):
    return tgt.clone().index_add_(axis, idx, src)
def _segment_sum(src, seg, n):
    out = torch.zeros((n,) + src.shape[1:], dtype=src.dtype)
    return out.index_add_(0, seg, src)
def _pad(x, pw):
    flat = tuple(v for pair in reversed(pw) for v in pair)
    return torch.nn.functional.pad(x, flat)

kernel_name = 'standalone__mixer_token_mlp__prompt'

def setup_inputs():

    _w = (lambda a: (lambda t: t.to(torch.bfloat16) if t.is_floating_point() else t)(torch.as_tensor(a)))
    B, S, D, F = 1, 2048, 1024, 3584
    return {
        "x": _w((lambda *s: torch.randn(*s, dtype=torch.bfloat16) * 0.05)(B, S, D)),
        "w1": _w((lambda *s: torch.randn(*s, dtype=torch.bfloat16) * 0.2)(S, F) * (S ** -0.5)),
        "b1": _w((lambda *s: torch.randn(*s, dtype=torch.bfloat16) * 1.6)(F) * 0.02),
        "w2": _w((lambda *s: torch.randn(*s, dtype=torch.bfloat16) * 0.05)(F, S) * (F ** -0.5)),
        "b2": _w((lambda *s: torch.randn(*s, dtype=torch.bfloat16) * 0.1)(S) * 0.02),
    }

def reference(x, w1, b1, w2, b2):
    B, S, D = x.shape
    h = _layernorm(x, axis=-1)
    u = torch.einsum("bsd,sf->bdf", h, w1) + b1
    u = _gelu(u)
    y = torch.einsum("bdf,fs->bds", u, w2) + b2
    return (lambda x, *d: x.permute(*d))(y, 0, 2, 1)
```

```asm
; @launch grid=(256,1,1) block=(256,1,1) lds=163840
.amdgcn_target "amdgcn-amd-amdhsa--gfx950"
.text
.globl standalone__mixer_token_mlp__prompt_kernel
.p2align 8
.type standalone__mixer_token_mlp__prompt_kernel,@function
standalone__mixer_token_mlp__prompt_kernel:
  s_cmp_ge_u32 s2, 256
  s_cbranch_scc1 L_end
  s_load_dwordx16 s[40:55], s[0:1], 0
  v_lshrrev_b32 v24, 6, v0
  v_and_b32 v0, 63, v0
  v_readfirstlane_b32 s56, v24
  v_lshlrev_b32 v34, 7, v0
  s_getpc_b64 s[36:37]
L_pc:
  s_and_b32 s37, s37, 0xffff
  s_mov_b32 s38, L_last-L_pc
  s_mov_b32 s39, 0x20000
  s_lshr_b32 s91, s2, 3
  s_and_b32 s91, s91, 7
  s_lshl_b32 s91, s91, 13
  s_cmp_eq_u32 s56, 0
  s_cselect_b32 s91, s91, 1073741824
  buffer_load_dword v35, v34, s[36:39], s91 offen
  v_lshlrev_b32 v25, 2, v0
  s_add_u32 s82, s2, 0
  s_and_b32 s82, s82, 255
  s_lshr_b32 s87, s82, 2
  s_and_b32 s88, s82, 3
  s_lshl_b32 s87, s87, 16
  s_lshl_b32 s88, s88, 13
  s_add_u32 s87, s87, s88
  s_lshl_b32 s88, s56, 9
  s_add_u32 s87, s87, s88
  s_add_u32 s88, s87, 4096
  s_add_u32 s89, s87, 32768
  s_add_u32 s90, s87, 36864
  s_mov_b32 s6, 4194304
  s_mov_b32 s7, 0x20000
  s_mov_b32 s18, 268435456
  s_mov_b32 s19, 0x20000
  s_waitcnt lgkmcnt(0)
  s_mov_b32 s4, s40
  s_mov_b32 s5, s41
  s_mov_b32 s16, s54
  s_mov_b32 s17, s55
  buffer_load_dword v40, v25, s[4:7], s87 offen offset:0
  buffer_load_dword v41, v25, s[4:7], s87 offen offset:256
  buffer_load_dword v42, v25, s[4:7], s87 offen offset:2048
  buffer_load_dword v43, v25, s[4:7], s87 offen offset:2304
  buffer_load_dword v44, v25, s[4:7], s88 offen offset:0
  buffer_load_dword v45, v25, s[4:7], s88 offen offset:256
  buffer_load_dword v46, v25, s[4:7], s88 offen offset:2048
  buffer_load_dword v47, v25, s[4:7], s88 offen offset:2304
  buffer_load_dword v48, v25, s[4:7], s89 offen offset:0
  buffer_load_dword v49, v25, s[4:7], s89 offen offset:256
  buffer_load_dword v50, v25, s[4:7], s89 offen offset:2048
  buffer_load_dword v51, v25, s[4:7], s89 offen offset:2304
  buffer_load_dword v52, v25, s[4:7], s90 offen offset:0
  buffer_load_dword v53, v25, s[4:7], s90 offen offset:256
  buffer_load_dword v54, v25, s[4:7], s90 offen offset:2048
  buffer_load_dword v55, v25, s[4:7], s90 offen offset:2304
  buffer_load_dword v21, off, s[16:19], 0 sc1
  s_and_b32 s87, s2, 7
  s_lshr_b32 s88, s2, 3
  s_cmp_ge_u32 s88, 28
  s_cselect_b32 s86, 1, 0
  s_cselect_b32 s22, 0, 268435456
  s_mov_b32 s20, s54
  s_mov_b32 s21, s55
  s_mov_b32 s23, 0x20000
  s_and_b32 s96, s87, 1
  s_lshl_b32 s91, s96, 2
  s_and_b32 s94, s88, 3
  s_add_u32 s91, s91, s94
  s_lshr_b32 s89, s87, 1
  s_lshr_b32 s90, s88, 3
  s_lshl_b32 s93, s90, 1
  s_lshr_b32 s93, 0x21, s93
  s_and_b32 s93, s93, 3
  s_lshl_b32 s92, s87, 2
  s_add_u32 s92, s92, s93
  s_lshl_b32 s93, s90, 2
  s_add_u32 s93, s93, 3
  s_cmp_eq_u32 s87, 7
  s_cselect_b32 s92, s93, s92
  s_lshl_b32 s93, s89, 2
  s_add_u32 s93, s93, 15
  s_and_b32 s95, s88, 7
  s_cmp_eq_u32 s90, 3
  s_cselect_b32 s92, s93, s92
  s_cselect_b32 s91, s91, s95
  s_cmp_ge_u32 s92, 14
  s_cselect_b32 s93, 1, 0
  s_and_b32 s94, s88, 7
  s_lshr_b32 s95, s88, 3
  s_lshl_b32 s95, s95, 2
  s_add_u32 s90, s89, 0
  s_and_b32 s90, s90, 3
  s_add_u32 s95, s95, s90
  s_mov_b32 s28, s44
  s_mov_b32 s29, s45
  s_mov_b32 s30, 7168
  s_mov_b32 s31, 0x20000
  s_mov_b32 s32, s48
  s_mov_b32 s33, s49
  s_mov_b32 s34, 4096
  s_mov_b32 s35, 0x20000
  v_lshrrev_b32 v26, 4, v0
  v_and_b32 v27, 15, v0
  s_lshl_b32 s87, s92, 8
  s_lshl_b32 s88, s56, 6
  s_add_u32 s87, s87, s88
  v_lshlrev_b32 v32, 3, v26
  s_lshl_b32 s89, s95, 8
  s_add_u32 s89, s89, s88
  v_lshlrev_b32 v33, 1, v27
  buffer_load_dwordx2 v[96:97], v32, s[28:31], s87 offen
  buffer_load_dwordx2 v[98:99], v32, s[28:31], s87 offen offset:32
  buffer_load_ushort v18, v33, s[32:35], s89 offen
  buffer_load_ushort v19, v33, s[32:35], s89 offen offset:32
  s_mov_b32 s28, s42
  s_mov_b32 s29, s43
  s_mov_b32 s30, 14680064
  s_mov_b32 s32, s46
  s_mov_b32 s33, s47
  s_mov_b32 s34, 14680064
  s_and_b32 s87, s2, 7
  s_mov_b32 s89, 768
  v_and_b32 v28, 7, v0
  v_lshlrev_b32 v29, 7, v28
  s_lshl_b32 s88, s87, 10
  v_add_u32 v69, s88, v29
  v_lshrrev_b32 v30, 1, v28
  v_lshlrev_b32 v30, 10, v30
  v_and_b32 v29, 0x80, v29
  v_add3_u32 v30, v30, v29, s89
  s_cmp_eq_u32 s87, 7
  s_cselect_b64 vcc, -1, 0
  s_lshr_b32 s88, s87, 1
  s_lshl_b32 s88, s88, 10
  v_cndmask_b32 v69, v69, v30, vcc
  s_add_u32 s88, s88, 3840
  v_add_u32 v30, s88, v29
  v_lshrrev_b32 v29, 3, v0
  v_xor_b32 v31, s87, v29
  v_lshlrev_b32 v31, 31, v31
  v_or_b32 v30, v30, v31
  v_cmp_lt_u32 vcc, 5, v28
  v_mul_u32_u24 v29, 7168, v29
  s_nop 0
  v_cndmask_b32 v69, v69, v30, vcc
  v_add_u32 v69, v69, v29
  s_and_b32 s88, s2, 6
  s_lshl_b32 s88, s88, 2
  s_lshr_b32 s90, 50529027, s88
  s_and_b32 s90, s90, 0xff
  s_lshl_b32 s97, s90, 5
  s_lshr_b32 s89, s2, 3
  s_add_u32 s88, s56, 3
  s_and_b32 s88, s88, 3
  s_lshl_b32 s87, s88, 5
  s_add_u32 s87, s87, s89
  s_mul_i32 s87, s87, 57344
  s_cmp_lt_u32 s88, s90
  s_cselect_b32 s87, s87, 1073741824
  buffer_load_dword v35, v69, s[28:31], s87 offen
  s_lshl_b32 s87, s92, 8
  s_add_u32 s8, s42, s87
  s_addc_u32 s9, s43, 0
  s_sub_u32 s10, 14680064, s87
  s_mov_b32 s11, 0x20000
  s_mul_i32 s87, s96, 7340032
  s_lshl_b32 s88, s95, 8
  s_add_u32 s87, s87, s88
  s_add_u32 s12, s46, s87
  s_addc_u32 s13, s47, 0
  s_sub_u32 s14, 14680064, s87
  s_mov_b32 s15, 0x20000
  s_lshl_b32 s58, s56, 12
  s_add_u32 s59, s58, 81920
  v_lshrrev_b32 v28, 1, v27
  v_xor_b32 v28, v28, v26
  v_lshlrev_b32 v28, 5, v28
  v_and_b32 v29, 1, v0
  v_lshl_or_b32 v28, v29, 4, v28
  v_xor_b32 v29, 0x80, v28
  s_lshl_b32 s87, s56, 4
  v_add_u32 v30, s87, v26
  v_mul_u32_u24 v31, 7168, v30
  v_add_u32 v8, v31, v28
  v_add_u32 v9, v31, v29
  v_add_u32 v9, 27648, v9
  v_add_u32 v10, v31, v28
  v_add_u32 v10, 55296, v10
  v_add_u32 v11, v31, v29
  v_add_u32 v11, 82944, v11
  v_mul_u32_u24 v31, 4096, v30
  v_add_u32 v12, v31, v28
  v_add_u32 v13, v31, v29
  v_add_u32 v13, 15360, v13
  v_add_u32 v14, v31, v28
  v_add_u32 v14, 30720, v14
  v_add_u32 v15, v31, v29
  v_add_u32 v15, 46080, v15
  v_and_b32 v29, 1, v26
  v_lshrrev_b32 v30, 3, v27
  v_lshl_or_b32 v30, v29, 4, v30
  s_and_b32 s88, s82, 3
  s_lshl_b32 s88, s88, 1
  v_add_u32 v30, s88, v30
  v_add_u32 v31, 8, v30
  v_mul_u32_u24 v28, 37, v30
  v_lshrrev_b32 v28, 8, v28
  v_add_u32 v30, v30, v28
  v_and_b32 v29, 7, v30
  v_cmp_lt_u32 vcc, 2, v29
  s_nop 1
  v_addc_co_u32 v30, vcc, 0, v30, vcc
  v_mul_u32_u24 v28, 37, v31
  v_lshrrev_b32 v28, 8, v28
  v_add_u32 v31, v31, v28
  v_and_b32 v29, 7, v31
  v_cmp_lt_u32 vcc, 2, v29
  s_nop 1
  v_addc_co_u32 v31, vcc, 0, v31, vcc
  v_lshrrev_b32 v28, 5, v0
  v_mul_u32_u24 v28, 327680, v28
  v_and_b32 v29, 7, v0
  v_lshl_or_b32 v28, v29, 4, v28
  v_lshl_add_u32 v30, v30, 7, v28
  v_lshl_add_u32 v31, v31, 7, v28
  s_lshl_b32 s66, s56, 8
  s_lshr_b32 s88, s82, 2
  s_add_u32 s66, s66, s88
  s_mul_i32 s66, s66, 5120
  s_add_u32 s66, s66, 1048576
  s_add_u32 s67, s66, 655360
  s_lshl_b32 s74, s56, 13
  s_lshl_b32 s88, s82, 5
  s_add_u32 s74, s74, s88
  s_add_u32 s74, s74, 4096
  v_cmp_eq_u32 vcc, 0, v0
  v_bfrev_b32 v28, 1
  s_lshl_b32 s88, s56, 6
  v_cndmask_b32 v22, v28, 0, vcc
  s_add_u32 s88, s88, 81920
  v_lshl_add_u32 v28, v26, 4, s88
  v_and_b32 v29, 7, v0
  v_lshlrev_b32 v29, 2, v29
  v_add_u32 v29, 81920, v29
  s_mov_b32 s87, 0x3f803f80
  s_waitcnt vmcnt(14)
  v_dot2_f32_bf16 v72, v40, s87, 0
  v_dot2_f32_bf16 v80, v40, v40, 0
  v_dot2_f32_bf16 v73, v42, s87, 0
  v_dot2_f32_bf16 v81, v42, v42, 0
  v_dot2_f32_bf16 v74, v44, s87, 0
  v_dot2_f32_bf16 v82, v44, v44, 0
  v_dot2_f32_bf16 v75, v46, s87, 0
  v_dot2_f32_bf16 v83, v46, v46, 0
  v_dot2_f32_bf16 v72, v41, s87, v72
  v_dot2_f32_bf16 v80, v41, v41, v80
  v_dot2_f32_bf16 v73, v43, s87, v73
  v_dot2_f32_bf16 v81, v43, v43, v81
  v_dot2_f32_bf16 v74, v45, s87, v74
  v_dot2_f32_bf16 v82, v45, v45, v82
  v_dot2_f32_bf16 v75, v47, s87, v75
  v_dot2_f32_bf16 v83, v47, v47, v83
  s_waitcnt vmcnt(5)
  v_dot2_f32_bf16 v76, v48, s87, 0
  v_dot2_f32_bf16 v84, v48, v48, 0
  v_dot2_f32_bf16 v77, v50, s87, 0
  v_dot2_f32_bf16 v85, v50, v50, 0
  v_dot2_f32_bf16 v78, v52, s87, 0
  v_dot2_f32_bf16 v86, v52, v52, 0
  v_dot2_f32_bf16 v79, v54, s87, 0
  v_dot2_f32_bf16 v87, v54, v54, 0
  v_dot2_f32_bf16 v76, v49, s87, v76
  v_dot2_f32_bf16 v84, v49, v49, v84
  v_dot2_f32_bf16 v77, v51, s87, v77
  v_dot2_f32_bf16 v85, v51, v51, v85
  v_dot2_f32_bf16 v78, v53, s87, v78
  v_dot2_f32_bf16 v86, v53, v53, v86
  v_dot2_f32_bf16 v79, v55, s87, v79
  v_dot2_f32_bf16 v87, v55, v55, v87
  v_readfirstlane_b32 s57, v21
  v_permlane32_swap_b32 v72, v80
  v_permlane32_swap_b32 v73, v81
  v_permlane32_swap_b32 v74, v82
  v_permlane32_swap_b32 v75, v83
  v_permlane32_swap_b32 v76, v84
  v_permlane32_swap_b32 v77, v85
  v_permlane32_swap_b32 v78, v86
  v_permlane32_swap_b32 v79, v87
  v_add_f32 v72, v72, v80
  v_add_f32 v73, v73, v81
  v_add_f32 v74, v74, v82
  v_add_f32 v75, v75, v83
  v_add_f32 v76, v76, v84
  v_add_f32 v77, v77, v85
  v_add_f32 v78, v78, v86
  v_add_f32 v79, v79, v87
  s_mul_i32 s57, s57, 1664525
  s_add_u32 s57, s57, 1013904223
  v_permlane16_swap_b32 v72, v76
  v_permlane16_swap_b32 v73, v77
  v_permlane16_swap_b32 v74, v78
  v_permlane16_swap_b32 v75, v79
  v_add_f32 v72, v72, v76
  v_add_f32 v73, v73, v77
  v_add_f32 v74, v74, v78
  v_add_f32 v75, v75, v79
  v_add_f32_dpp v72, v72, v72 row_ror:8 row_mask:0xf bank_mask:0xf
  v_add_f32_dpp v73, v73, v73 row_ror:8 row_mask:0xf bank_mask:0xf
  v_add_f32_dpp v74, v74, v74 row_ror:8 row_mask:0xf bank_mask:0xf
  v_add_f32_dpp v75, v75, v75 row_ror:8 row_mask:0xf bank_mask:0xf
  v_add_f32_dpp v72, v72, v72 row_ror:4 row_mask:0xf bank_mask:0xf
  v_add_f32_dpp v73, v73, v73 row_ror:4 row_mask:0xf bank_mask:0xf
  v_add_f32_dpp v74, v74, v74 row_ror:4 row_mask:0xf bank_mask:0xf
  v_add_f32_dpp v75, v75, v75 row_ror:4 row_mask:0xf bank_mask:0xf
  v_add_f32_dpp v72, v72, v72 row_ror:2 row_mask:0xf bank_mask:0xf
  v_add_f32_dpp v73, v73, v73 row_ror:2 row_mask:0xf bank_mask:0xf
  v_add_f32_dpp v74, v74, v74 row_ror:2 row_mask:0xf bank_mask:0xf
  v_add_f32_dpp v75, v75, v75 row_ror:2 row_mask:0xf bank_mask:0xf
  v_add_f32_dpp v72, v72, v72 row_ror:1 row_mask:0xf bank_mask:0xf
  v_add_f32_dpp v73, v73, v73 row_ror:1 row_mask:0xf bank_mask:0xf
  v_add_f32_dpp v74, v74, v74 row_ror:1 row_mask:0xf bank_mask:0xf
  v_add_f32_dpp v75, v75, v75 row_ror:1 row_mask:0xf bank_mask:0xf
  s_mov_b32 exec_lo, 0x10001
  s_mov_b32 exec_hi, 0x10001
  ds_write_b128 v28, v[72:75]
  s_mov_b64 exec, -1
  v_lshlrev_b32 v104, 16, v40
  v_and_b32 v105, 0xffff0000, v40
  v_lshlrev_b32 v106, 16, v42
  v_and_b32 v107, 0xffff0000, v42
  v_lshlrev_b32 v108, 16, v44
  v_and_b32 v109, 0xffff0000, v44
  v_lshlrev_b32 v110, 16, v46
  v_and_b32 v111, 0xffff0000, v46
  v_lshlrev_b32 v112, 16, v48
  v_and_b32 v113, 0xffff0000, v48
  v_lshlrev_b32 v114, 16, v50
  v_and_b32 v115, 0xffff0000, v50
  v_lshlrev_b32 v116, 16, v52
  v_and_b32 v117, 0xffff0000, v52
  v_lshlrev_b32 v118, 16, v54
  v_and_b32 v119, 0xffff0000, v54
  s_waitcnt lgkmcnt(0)
  s_barrier
  ds_read2_b32 v[72:73], v29 offset0:0 offset1:16
  ds_read2_b32 v[74:75], v29 offset0:32 offset1:48
  ds_read2_b32 v[76:77], v29 offset0:8 offset1:24
  ds_read2_b32 v[78:79], v29 offset0:40 offset1:56
  v_lshlrev_b32 v120, 16, v41
  v_and_b32 v121, 0xffff0000, v41
  v_lshlrev_b32 v122, 16, v43
  v_and_b32 v123, 0xffff0000, v43
  v_lshlrev_b32 v124, 16, v45
  v_and_b32 v125, 0xffff0000, v45
  v_lshlrev_b32 v126, 16, v47
  v_and_b32 v127, 0xffff0000, v47
  v_lshlrev_b32 v128, 16, v49
  v_and_b32 v129, 0xffff0000, v49
  v_lshlrev_b32 v130, 16, v51
  v_and_b32 v131, 0xffff0000, v51
  v_lshlrev_b32 v132, 16, v53
  v_and_b32 v133, 0xffff0000, v53
  v_lshlrev_b32 v134, 16, v55
  v_and_b32 v135, 0xffff0000, v55
  s_waitcnt lgkmcnt(0)
  v_add_f32 v72, v72, v73
  v_add_f32 v74, v74, v75
  v_add_f32 v76, v76, v77
  v_add_f32 v78, v78, v79
  v_add_f32 v72, v72, v74
  v_add_f32 v76, v76, v78
  v_mul_f32 v72, 981467136, v72
  v_mul_f32 v76, 981467136, v76
  v_fma_f32 v76, -v72, v72, v76
  v_max_f32 v76, 0, v76
  v_add_f32 v76, 925353388, v76
  v_rsq_f32 v76, v76
  s_nop 0
  v_mul_f32 v72, v72, v76
  s_nop 0
  v_mov_b32_dpp v40, v76 row_newbcast:0 row_mask:0xf bank_mask:0xf
  v_mov_b32_dpp v41, v72 row_newbcast:0 row_mask:0xf bank_mask:0xf
  v_mov_b32_dpp v42, v76 row_newbcast:1 row_mask:0xf bank_mask:0xf
  v_mov_b32_dpp v43, v72 row_newbcast:1 row_mask:0xf bank_mask:0xf
  v_mov_b32_dpp v44, v76 row_newbcast:2 row_mask:0xf bank_mask:0xf
  v_mov_b32_dpp v45, v72 row_newbcast:2 row_mask:0xf bank_mask:0xf
  v_mov_b32_dpp v46, v76 row_newbcast:3 row_mask:0xf bank_mask:0xf
  v_mov_b32_dpp v47, v72 row_newbcast:3 row_mask:0xf bank_mask:0xf
  v_mov_b32_dpp v48, v76 row_newbcast:4 row_mask:0xf bank_mask:0xf
  v_mov_b32_dpp v49, v72 row_newbcast:4 row_mask:0xf bank_mask:0xf
  v_mov_b32_dpp v50, v76 row_newbcast:5 row_mask:0xf bank_mask:0xf
  v_mov_b32_dpp v51, v72 row_newbcast:5 row_mask:0xf bank_mask:0xf
  v_mov_b32_dpp v52, v76 row_newbcast:6 row_mask:0xf bank_mask:0xf
  v_mov_b32_dpp v53, v72 row_newbcast:6 row_mask:0xf bank_mask:0xf
  v_mov_b32_dpp v54, v76 row_newbcast:7 row_mask:0xf bank_mask:0xf
  v_mov_b32_dpp v55, v72 row_newbcast:7 row_mask:0xf bank_mask:0xf
  v_pk_fma_f32 v[104:105], v[104:105], v[40:41], v[40:41] op_sel:[0,0,1] op_sel_hi:[1,0,1] neg_lo:[0,0,1] neg_hi:[0,0,1]
  v_pk_fma_f32 v[106:107], v[106:107], v[42:43], v[42:43] op_sel:[0,0,1] op_sel_hi:[1,0,1] neg_lo:[0,0,1] neg_hi:[0,0,1]
  v_pk_fma_f32 v[108:109], v[108:109], v[44:45], v[44:45] op_sel:[0,0,1] op_sel_hi:[1,0,1] neg_lo:[0,0,1] neg_hi:[0,0,1]
  v_pk_fma_f32 v[110:111], v[110:111], v[46:47], v[46:47] op_sel:[0,0,1] op_sel_hi:[1,0,1] neg_lo:[0,0,1] neg_hi:[0,0,1]
  v_pk_fma_f32 v[112:113], v[112:113], v[48:49], v[48:49] op_sel:[0,0,1] op_sel_hi:[1,0,1] neg_lo:[0,0,1] neg_hi:[0,0,1]
  v_pk_fma_f32 v[114:115], v[114:115], v[50:51], v[50:51] op_sel:[0,0,1] op_sel_hi:[1,0,1] neg_lo:[0,0,1] neg_hi:[0,0,1]
  v_pk_fma_f32 v[116:117], v[116:117], v[52:53], v[52:53] op_sel:[0,0,1] op_sel_hi:[1,0,1] neg_lo:[0,0,1] neg_hi:[0,0,1]
  v_pk_fma_f32 v[118:119], v[118:119], v[54:55], v[54:55] op_sel:[0,0,1] op_sel_hi:[1,0,1] neg_lo:[0,0,1] neg_hi:[0,0,1]
  v_cvt_pk_bf16_f32 v80, v104, v106
  v_cvt_pk_bf16_f32 v81, v108, v110
  v_cvt_pk_bf16_f32 v82, v112, v114
  v_cvt_pk_bf16_f32 v83, v116, v118
  buffer_store_dwordx4 v[80:83], v30, s[16:19], s66 offen sc1
  v_cvt_pk_bf16_f32 v84, v105, v107
  v_cvt_pk_bf16_f32 v85, v109, v111
  v_cvt_pk_bf16_f32 v86, v113, v115
  v_cvt_pk_bf16_f32 v87, v117, v119
  buffer_store_dwordx4 v[84:87], v31, s[16:19], s66 offen sc1
  v_pk_fma_f32 v[120:121], v[120:121], v[40:41], v[40:41] op_sel:[0,0,1] op_sel_hi:[1,0,1] neg_lo:[0,0,1] neg_hi:[0,0,1]
  v_pk_fma_f32 v[122:123], v[122:123], v[42:43], v[42:43] op_sel:[0,0,1] op_sel_hi:[1,0,1] neg_lo:[0,0,1] neg_hi:[0,0,1]
  v_pk_fma_f32 v[124:125], v[124:125], v[44:45], v[44:45] op_sel:[0,0,1] op_sel_hi:[1,0,1] neg_lo:[0,0,1] neg_hi:[0,0,1]
  v_pk_fma_f32 v[126:127], v[126:127], v[46:47], v[46:47] op_sel:[0,0,1] op_sel_hi:[1,0,1] neg_lo:[0,0,1] neg_hi:[0,0,1]
  v_pk_fma_f32 v[128:129], v[128:129], v[48:49], v[48:49] op_sel:[0,0,1] op_sel_hi:[1,0,1] neg_lo:[0,0,1] neg_hi:[0,0,1]
  v_pk_fma_f32 v[130:131], v[130:131], v[50:51], v[50:51] op_sel:[0,0,1] op_sel_hi:[1,0,1] neg_lo:[0,0,1] neg_hi:[0,0,1]
  v_pk_fma_f32 v[132:133], v[132:133], v[52:53], v[52:53] op_sel:[0,0,1] op_sel_hi:[1,0,1] neg_lo:[0,0,1] neg_hi:[0,0,1]
  v_pk_fma_f32 v[134:135], v[134:135], v[54:55], v[54:55] op_sel:[0,0,1] op_sel_hi:[1,0,1] neg_lo:[0,0,1] neg_hi:[0,0,1]
  v_cvt_pk_bf16_f32 v88, v120, v122
  v_cvt_pk_bf16_f32 v89, v124, v126
  v_cvt_pk_bf16_f32 v90, v128, v130
  v_cvt_pk_bf16_f32 v91, v132, v134
  buffer_store_dwordx4 v[88:91], v30, s[16:19], s67 offen sc1
  v_cvt_pk_bf16_f32 v92, v121, v123
  v_cvt_pk_bf16_f32 v93, v125, v127
  v_cvt_pk_bf16_f32 v94, v129, v131
  v_cvt_pk_bf16_f32 v95, v133, v135
  buffer_store_dwordx4 v[92:95], v31, s[16:19], s67 offen sc1
  s_cmp_lg_u32 s86, 0
  s_cbranch_scc1 L_spare
  s_add_u32 m0, s58, 0
  s_mov_b32 s67, 0
  buffer_load_dwordx4 v8, s[8:11], s67 offen offset:0  lds
  buffer_load_dwordx4 v9, s[8:11], s67 offen offset:1024  lds
  buffer_load_dwordx4 v10, s[8:11], s67 offen offset:2048  lds
  buffer_load_dwordx4 v11, s[8:11], s67 offen offset:3072  lds
  s_add_u32 m0, s58, 16384
  s_mov_b32 s67, 458752
  buffer_load_dwordx4 v8, s[8:11], s67 offen offset:0  lds
  buffer_load_dwordx4 v9, s[8:11], s67 offen offset:1024  lds
  buffer_load_dwordx4 v10, s[8:11], s67 offen offset:2048  lds
  buffer_load_dwordx4 v11, s[8:11], s67 offen offset:3072  lds
  v_lshrrev_b32 v28, 2, v0
  v_and_b32 v29, 7, v28
  s_lshl_b32 s87, s56, 1
  v_xor_b32 v29, s87, v29
  v_lshlrev_b32 v29, 5, v29
  v_lshl_or_b32 v29, v28, 8, v29
  v_and_b32 v28, 3, v0
  v_lshl_or_b32 v4, v28, 3, v29
  v_add_u32 v5, 40960, v4
  v_xor_b32 v6, 32, v4
  v_add_u32 v7, 40960, v6
  v_lshlrev_b32 v16, 7, v0
  s_and_b32 s88, s2, 6
  s_lshl_b32 s88, s88, 2
  s_lshr_b32 s97, 33685507, s88
  s_and_b32 s97, s97, 0xff
  s_lshr_b32 s87, 84083456, s88
  s_and_b32 s87, s87, 0xff
  s_add_u32 s87, s87, s56
  s_mul_i32 s87, s87, 28
  s_lshr_b32 s88, s2, 3
  s_add_u32 s87, s87, s88
  s_and_b32 s88, s2, 1
  s_mul_i32 s88, s88, 7340032
  s_add_u32 s3, s87, 704
  s_lshl_b32 s3, s3, 13
  s_add_u32 s3, s3, s88
  s_cmp_lt_u32 s87, 192
  s_cselect_b32 s3, s3, 1073741824
  s_cmp_lt_u32 s56, s97
  s_cselect_b32 s3, s3, 1073741824
  s_mov_b64 exec, 0
  s_cmp_eq_u32 s56, 0
  s_cbranch_scc1 L_mark0
  s_cmp_eq_u32 s56, 1
  s_cbranch_scc1 L_mark1
  s_cmp_eq_u32 s56, 2
  s_cbranch_scc1 L_mark2
  s_branch L_mark3
L_touched:
  s_mov_b64 exec, -1
  s_waitcnt vmcnt(8)
  v_mov_b32 v38, s57
  buffer_store_dword v38, v22, s[16:19], s74 offen sc1
  v_lshl_or_b32 v18, v19, 16, v18
  s_add_u32 m0, s58, 32768
  s_mov_b32 s67, 917504
  buffer_load_dwordx4 v8, s[8:11], s67 offen offset:0  lds
  buffer_load_dwordx4 v9, s[8:11], s67 offen offset:1024  lds
  buffer_load_dwordx4 v10, s[8:11], s67 offen offset:2048  lds
  buffer_load_dwordx4 v11, s[8:11], s67 offen offset:3072  lds
  s_add_u32 m0, s58, 49152
  s_mov_b32 s67, 1376256
  buffer_load_dwordx4 v8, s[8:11], s67 offen offset:0  lds
  buffer_load_dwordx4 v9, s[8:11], s67 offen offset:1024  lds
  buffer_load_dwordx4 v10, s[8:11], s67 offen offset:2048  lds
  buffer_load_dwordx4 v11, s[8:11], s67 offen offset:3072  lds
  s_add_u32 m0, s58, 65536
  s_mov_b32 s67, 1835008
  buffer_load_dwordx4 v8, s[8:11], s67 offen offset:0  lds
  buffer_load_dwordx4 v9, s[8:11], s67 offen offset:1024  lds
  buffer_load_dwordx4 v10, s[8:11], s67 offen offset:2048  lds
  buffer_load_dwordx4 v11, s[8:11], s67 offen offset:3072  lds
  s_waitcnt vmcnt(17)
  s_barrier
  ds_read_b64_tr_b16 v[136:137], v4 offset:0
  ds_read_b64_tr_b16 v[138:139], v4 offset:4096
  ds_read_b64_tr_b16 v[140:141], v6 offset:0
  ds_read_b64_tr_b16 v[142:143], v6 offset:4096
  ds_read_b64_tr_b16 v[144:145], v4 offset:8192
  ds_read_b64_tr_b16 v[146:147], v4 offset:12288
  ds_read_b64_tr_b16 v[148:149], v6 offset:8192
  ds_read_b64_tr_b16 v[150:151], v6 offset:12288
  s_lshl_b32 s87, s91, 1
  s_add_u32 s87, s87, s93
  s_mul_i32 s88, s87, 327680
  s_add_u32 s61, s88, 1048576
  s_xor_b32 s88, s87, 1
  s_mul_i32 s88, s88, 327680
  s_add_u32 s62, s88, 1048576
  s_lshr_b32 s89, s56, 1
  s_mul_i32 s89, s89, 5120
  s_mul_i32 s90, s56, 5120
  s_bitcmp0_b32 s56, 0
  s_cselect_b32 s60, s61, s62
  s_add_u32 s60, s60, s89
  s_add_u32 s61, s61, s90
  s_add_u32 s62, s62, s90
  s_lshl_b32 s87, s91, 1
  s_add_u32 s87, s87, s93
  s_mul_i32 s68, s87, 112
  s_xor_b32 s87, s87, 1
  s_mul_i32 s69, s87, 112
  s_lshl_b32 s88, s92, 2
  s_add_u32 s88, s88, s56
  s_add_u32 s68, s68, s88
  s_add_u32 s69, s69, s88
  s_lshl_b32 s70, s68, 5
  s_lshl_b32 s71, s69, 5
  s_add_u32 s70, s70, 65536
  s_add_u32 s71, s71, 65536
  s_mul_i32 s68, s68, 5120
  s_mul_i32 s69, s69, 5120
  s_add_u32 s68, s68, 7340032
  s_add_u32 s69, s69, 7340032
  s_waitcnt vmcnt(13) lgkmcnt(0)
  s_barrier
  ds_read_b64_tr_b16 v[152:153], v4 offset:16384
  ds_read_b64_tr_b16 v[154:155], v4 offset:20480
  ds_read_b64_tr_b16 v[156:157], v6 offset:16384
  ds_read_b64_tr_b16 v[158:159], v6 offset:20480
  ds_read_b64_tr_b16 v[160:161], v4 offset:24576
  ds_read_b64_tr_b16 v[162:163], v4 offset:28672
  ds_read_b64_tr_b16 v[164:165], v6 offset:24576
  ds_read_b64_tr_b16 v[166:167], v6 offset:28672
  s_add_u32 m0, s58, 0
  s_mov_b32 s67, 2293760
  buffer_load_dwordx4 v8, s[8:11], s67 offen offset:0  lds
  buffer_load_dwordx4 v9, s[8:11], s67 offen offset:1024  lds
  buffer_load_dwordx4 v10, s[8:11], s67 offen offset:2048  lds
  buffer_load_dwordx4 v11, s[8:11], s67 offen offset:3072  lds
  s_lshr_b32 s75, s91, 1
  s_lshl_b32 s75, s75, 13
  s_lshl_b32 s88, s56, 11
  s_add_u32 s75, s75, s88
  s_add_u32 s75, s75, 4096
  v_lshlrev_b32 v28, 4, v0
  v_add_u32 v2, 81920, v28
  v_add_u32 v3, 122880, v28
  v_lshlrev_b32 v32, 5, v0
  v_and_b32 v30, 7, v0
  v_lshlrev_b32 v30, 4, v30
  v_lshrrev_b32 v1, 3, v0
  v_mul_u32_u24 v28, 37, v1
  v_lshrrev_b32 v28, 8, v28
  v_add_u32 v1, v1, v28
  v_and_b32 v29, 7, v1
  v_cmp_lt_u32 vcc, 2, v29
  s_nop 1
  v_addc_co_u32 v1, vcc, 0, v1, vcc
  v_lshl_add_u32 v1, v1, 7, v30
  v_lshrrev_b32 v17, 3, v0
  v_add_u32 v17, 8, v17
  v_mul_u32_u24 v28, 37, v17
  v_lshrrev_b32 v28, 8, v28
  v_add_u32 v17, v17, v28
  v_and_b32 v29, 7, v17
  v_cmp_lt_u32 vcc, 2, v29
  s_nop 1
  v_addc_co_u32 v17, vcc, 0, v17, vcc
  v_lshl_add_u32 v17, v17, 7, v30
  v_subrev_u32 v17, 1024, v17
  v_lshrrev_b32 v20, 3, v0
  v_add_u32 v20, 16, v20
  v_mul_u32_u24 v28, 37, v20
  v_lshrrev_b32 v28, 8, v28
  v_add_u32 v20, v20, v28
  v_and_b32 v29, 7, v20
  v_cmp_lt_u32 vcc, 2, v29
  s_nop 1
  v_addc_co_u32 v20, vcc, 0, v20, vcc
  v_lshl_add_u32 v20, v20, 7, v30
  v_subrev_u32 v20, 2048, v20
  v_lshrrev_b32 v21, 3, v0
  v_add_u32 v21, 24, v21
  v_mul_u32_u24 v28, 37, v21
  v_lshrrev_b32 v28, 8, v28
  v_add_u32 v21, v21, v28
  v_and_b32 v29, 7, v21
  v_cmp_lt_u32 vcc, 2, v29
  s_nop 1
  v_addc_co_u32 v21, vcc, 0, v21, vcc
  v_lshl_add_u32 v21, v21, 7, v30
  v_subrev_u32 v21, 3072, v21
  s_waitcnt vmcnt(12) lgkmcnt(0)
  s_barrier
  ds_read_b64_tr_b16 v[168:169], v4 offset:32768
  ds_read_b64_tr_b16 v[170:171], v4 offset:36864
  ds_read_b64_tr_b16 v[172:173], v6 offset:32768
  ds_read_b64_tr_b16 v[174:175], v6 offset:36864
  ds_read_b64_tr_b16 v[176:177], v5 offset:0
  ds_read_b64_tr_b16 v[178:179], v5 offset:4096
  ds_read_b64_tr_b16 v[180:181], v7 offset:0
  ds_read_b64_tr_b16 v[182:183], v7 offset:4096
  s_add_u32 m0, s58, 16384
  s_mov_b32 s67, 2752512
  buffer_load_dwordx4 v8, s[8:11], s67 offen offset:0  lds
  buffer_load_dwordx4 v9, s[8:11], s67 offen offset:1024  lds
  buffer_load_dwordx4 v10, s[8:11], s67 offen offset:2048  lds
  buffer_load_dwordx4 v11, s[8:11], s67 offen offset:3072  lds
  s_lshl_b32 s87, s94, 1
  s_add_u32 s87, s87, s96
  s_mul_i32 s64, s87, 112
  s_xor_b32 s87, s87, 1
  s_mul_i32 s65, s87, 112
  s_mul_i32 s87, s96, 56
  s_add_u32 s64, s64, s87
  s_add_u32 s65, s65, s87
  s_lshl_b32 s72, s64, 5
  s_lshl_b32 s73, s65, 5
  s_add_u32 s72, s72, 65536
  s_add_u32 s73, s73, 65536
  s_mul_i32 s64, s64, 5120
  s_mul_i32 s65, s65, 5120
  s_add_u32 s64, s64, 7340032
  s_add_u32 s65, s65, 7340032
  s_add_u32 s87, s64, 204800
  s_bitcmp0_b32 s56, 0
  s_cselect_b32 s63, s87, s65
  s_add_u32 s63, s63, s89
  s_add_u32 s64, s64, s90
  s_add_u32 s65, s65, s90
  s_waitcnt vmcnt(12) lgkmcnt(0)
  s_barrier
  ds_read_b64_tr_b16 v[184:185], v5 offset:8192
  ds_read_b64_tr_b16 v[186:187], v5 offset:12288
  ds_read_b64_tr_b16 v[188:189], v7 offset:8192
  ds_read_b64_tr_b16 v[190:191], v7 offset:12288
  ds_read_b64_tr_b16 v[192:193], v5 offset:16384
  ds_read_b64_tr_b16 v[194:195], v5 offset:20480
  ds_read_b64_tr_b16 v[196:197], v7 offset:16384
  ds_read_b64_tr_b16 v[198:199], v7 offset:20480
  s_add_u32 m0, s58, 32768
  s_mov_b32 s67, 3211264
  buffer_load_dwordx4 v8, s[8:11], s67 offen offset:0  lds
  buffer_load_dwordx4 v9, s[8:11], s67 offen offset:1024  lds
  buffer_load_dwordx4 v10, s[8:11], s67 offen offset:2048  lds
  buffer_load_dwordx4 v11, s[8:11], s67 offen offset:3072  lds
  s_lshl_b32 s87, s2, 2
  s_add_u32 s87, s87, s56
  s_xor_b32 s88, s87, 4
  s_lshl_b32 s76, s87, 5
  s_lshl_b32 s77, s88, 5
  s_add_u32 s76, s76, 131072
  s_add_u32 s77, s77, 131072
  s_mul_i32 s78, s87, 10240
  s_mul_i32 s80, s88, 10240
  s_add_u32 s78, s78, 16777216
  s_add_u32 s80, s80, 16777216
  s_add_u32 s79, s78, 5120
  s_add_u32 s81, s80, 5120
  s_lshl_b32 s87, s95, 18
  s_lshl_b32 s88, s94, 8
  s_add_u32 s87, s87, s88
  s_xor_b32 s88, s96, 1
  s_lshl_b32 s88, s88, 7
  s_add_u32 s87, s87, s88
  s_add_u32 s24, s50, s87
  s_addc_u32 s25, s51, 0
  s_sub_u32 s26, 4194304, s87
  s_mov_b32 s27, 0x20000
  s_mov_b32 s83, 32768
  s_mov_b32 s84, 3184710632
  v_mov_b32 v23, 3222493025
  s_waitcnt vmcnt(12) lgkmcnt(0)
  s_barrier
  ds_read_b64_tr_b16 v[200:201], v5 offset:24576
  ds_read_b64_tr_b16 v[202:203], v5 offset:28672
  ds_read_b64_tr_b16 v[204:205], v7 offset:24576
  ds_read_b64_tr_b16 v[206:207], v7 offset:28672
  ds_read_b64_tr_b16 v[208:209], v5 offset:32768
  ds_read_b64_tr_b16 v[210:211], v5 offset:36864
  ds_read_b64_tr_b16 v[212:213], v7 offset:32768
  ds_read_b64_tr_b16 v[214:215], v7 offset:36864
  s_add_u32 m0, s58, 49152
  s_mov_b32 s67, 3670016
  buffer_load_dwordx4 v8, s[8:11], s67 offen offset:0  lds
  buffer_load_dwordx4 v9, s[8:11], s67 offen offset:1024  lds
  buffer_load_dwordx4 v10, s[8:11], s67 offen offset:2048  lds
  buffer_load_dwordx4 v11, s[8:11], s67 offen offset:3072  lds
  s_waitcnt vmcnt(12) lgkmcnt(0)
  s_barrier
  ds_read_b64_tr_b16 v[216:217], v4 offset:0
  ds_read_b64_tr_b16 v[218:219], v4 offset:4096
  ds_read_b64_tr_b16 v[220:221], v6 offset:0
  ds_read_b64_tr_b16 v[222:223], v6 offset:4096
  ds_read_b64_tr_b16 v[224:225], v4 offset:8192
  ds_read_b64_tr_b16 v[226:227], v4 offset:12288
  ds_read_b64_tr_b16 v[228:229], v6 offset:8192
  ds_read_b64_tr_b16 v[230:231], v6 offset:12288
  s_add_u32 m0, s58, 65536
  s_mov_b32 s67, 4128768
  buffer_load_dwordx4 v8, s[8:11], s67 offen offset:0  lds
  buffer_load_dwordx4 v9, s[8:11], s67 offen offset:1024  lds
  buffer_load_dwordx4 v10, s[8:11], s67 offen offset:2048  lds
  buffer_load_dwordx4 v11, s[8:11], s67 offen offset:3072  lds
  v_lshlrev_b32 v24, 16, v96
  v_and_b32 v25, 0xffff0000, v96
  v_lshlrev_b32 v26, 16, v97
  v_and_b32 v27, 0xffff0000, v97
  v_lshlrev_b32 v28, 16, v98
  v_and_b32 v29, 0xffff0000, v98
  v_lshlrev_b32 v30, 16, v99
  v_and_b32 v31, 0xffff0000, v99
  s_waitcnt vmcnt(12) lgkmcnt(0)
  s_barrier
  buffer_load_dword v39, v32, s[16:19], s75 offen sc1
  ds_read_b64_tr_b16 v[232:233], v4 offset:16384
  ds_read_b64_tr_b16 v[234:235], v4 offset:20480
  ds_read_b64_tr_b16 v[236:237], v6 offset:16384
  ds_read_b64_tr_b16 v[238:239], v6 offset:20480
  ds_read_b64_tr_b16 v[240:241], v4 offset:24576
  ds_read_b64_tr_b16 v[242:243], v4 offset:28672
  ds_read_b64_tr_b16 v[244:245], v6 offset:24576
  ds_read_b64_tr_b16 v[246:247], v6 offset:28672
  s_add_u32 m0, s58, 0
  s_mov_b32 s67, 4587520
  buffer_load_dwordx4 v8, s[8:11], s67 offen offset:0  lds
  buffer_load_dwordx4 v9, s[8:11], s67 offen offset:1024  lds
  buffer_load_dwordx4 v10, s[8:11], s67 offen offset:2048  lds
  buffer_load_dwordx4 v11, s[8:11], s67 offen offset:3072  lds
  s_waitcnt vmcnt(13) lgkmcnt(0)
  s_barrier
  ds_read_b64_tr_b16 v[248:249], v4 offset:32768
  ds_read_b64_tr_b16 v[250:251], v4 offset:36864
  ds_read_b64_tr_b16 v[252:253], v6 offset:32768
  ds_read_b64_tr_b16 v[254:255], v6 offset:36864
  ds_read_b64_tr_b16 a[0:1], v5 offset:0
  ds_read_b64_tr_b16 a[2:3], v5 offset:4096
  ds_read_b64_tr_b16 a[4:5], v7 offset:0
  ds_read_b64_tr_b16 a[6:7], v7 offset:4096
  s_add_u32 m0, s58, 16384
  s_mov_b32 s67, 5046272
  buffer_load_dwordx4 v8, s[8:11], s67 offen offset:0  lds
  buffer_load_dwordx4 v9, s[8:11], s67 offen offset:1024  lds
  buffer_load_dwordx4 v10, s[8:11], s67 offen offset:2048  lds
  buffer_load_dwordx4 v11, s[8:11], s67 offen offset:3072  lds
  s_waitcnt vmcnt(13) lgkmcnt(0)
  s_waitcnt vmcnt(8)
  v_cmp_ne_u32 vcc, s57, v39
  s_cbranch_vccnz L_spin_f1
L_ret_f1:
  s_barrier
  s_add_u32 m0, s59, 0
  s_add_u32 s66, s60, 0
  buffer_load_dwordx4 v1, s[16:19], s66 offen offset:0 sc1 lds
  buffer_load_dwordx4 v17, s[16:19], s66 offen offset:1024 sc1 lds
  buffer_load_dwordx4 v20, s[16:19], s66 offen offset:2048 sc1 lds
  buffer_load_dwordx4 v21, s[16:19], s66 offen offset:3072 sc1 lds
  ds_read_b64_tr_b16 a[8:9], v5 offset:8192
  ds_read_b64_tr_b16 a[10:11], v5 offset:12288
  ds_read_b64_tr_b16 a[12:13], v7 offset:8192
  ds_read_b64_tr_b16 a[14:15], v7 offset:12288
  ds_read_b64_tr_b16 a[16:17], v5 offset:16384
  ds_read_b64_tr_b16 a[18:19], v5 offset:20480
  ds_read_b64_tr_b16 a[20:21], v7 offset:16384
  ds_read_b64_tr_b16 a[22:23], v7 offset:20480
  s_add_u32 m0, s59, 16384
  s_add_u32 s66, s60, 10240
  buffer_load_dwordx4 v1, s[16:19], s66 offen offset:0 sc1 lds
  buffer_load_dwordx4 v17, s[16:19], s66 offen offset:1024 sc1 lds
  buffer_load_dwordx4 v20, s[16:19], s66 offen offset:2048 sc1 lds
  buffer_load_dwordx4 v21, s[16:19], s66 offen offset:3072 sc1 lds
  s_add_u32 m0, s58, 32768
  s_mov_b32 s67, 5505024
  buffer_load_dwordx4 v8, s[8:11], s67 offen offset:0  lds
  buffer_load_dwordx4 v9, s[8:11], s67 offen offset:1024  lds
  buffer_load_dwordx4 v10, s[8:11], s67 offen offset:2048  lds
  buffer_load_dwordx4 v11, s[8:11], s67 offen offset:3072  lds
  s_waitcnt lgkmcnt(0)
  s_barrier
  ds_read_b64_tr_b16 a[24:25], v5 offset:24576
  ds_read_b64_tr_b16 a[26:27], v5 offset:28672
  ds_read_b64_tr_b16 a[28:29], v7 offset:24576
  ds_read_b64_tr_b16 a[30:31], v7 offset:28672
  ds_read_b64_tr_b16 a[32:33], v5 offset:32768
  ds_read_b64_tr_b16 a[34:35], v5 offset:36864
  ds_read_b64_tr_b16 a[36:37], v7 offset:32768
  ds_read_b64_tr_b16 a[38:39], v7 offset:36864
  s_add_u32 m0, s59, 32768
  s_add_u32 s66, s60, 20480
  buffer_load_dwordx4 v1, s[16:19], s66 offen offset:0 sc1 lds
  buffer_load_dwordx4 v17, s[16:19], s66 offen offset:1024 sc1 lds
  buffer_load_dwordx4 v20, s[16:19], s66 offen offset:2048 sc1 lds
  buffer_load_dwordx4 v21, s[16:19], s66 offen offset:3072 sc1 lds
  s_add_u32 m0, s58, 49152
  s_mov_b32 s67, 5963776
  buffer_load_dwordx4 v8, s[8:11], s67 offen offset:0  lds
  buffer_load_dwordx4 v9, s[8:11], s67 offen offset:1024  lds
  buffer_load_dwordx4 v10, s[8:11], s67 offen offset:2048  lds
  buffer_load_dwordx4 v11, s[8:11], s67 offen offset:3072  lds
  s_branch L_main
L_spare:
  s_sub_u32 s67, s2, 224
  s_lshl_b32 s67, s67, 2
  s_add_u32 s67, s67, s56
  s_add_u32 s66, s67, 768
  s_lshl_b32 s66, s66, 13
  s_lshr_b32 s66, s2, 3
  s_and_b32 s66, s66, 3
  s_lshl_b32 s66, s66, 2
  s_add_u32 s66, s66, s56
  s_add_u32 s66, s66, s97
  s_mul_i32 s66, s66, 57344
  buffer_load_dword v35, v69, s[28:31], s66 offen
  s_add_u32 s66, s66, 917504
  s_lshl_b32 s87, s95, 18
  s_lshl_b32 s88, s94, 8
  s_add_u32 s87, s87, s88
  s_xor_b32 s88, s96, 1
  s_lshl_b32 s88, s88, 7
  s_add_u32 s87, s87, s88
  s_add_u32 s24, s50, s87
  s_addc_u32 s25, s51, 0
  s_sub_u32 s26, 4194304, s87
  s_mov_b32 s27, 0x20000
  s_mov_b32 s83, 32768
  s_mov_b32 s84, 3184710632
  v_mov_b32 v23, 3222493025
  s_lshl_b32 s87, s91, 1
  s_add_u32 s87, s87, s93
  s_mul_i32 s88, s87, 327680
  s_add_u32 s61, s88, 1048576
  s_xor_b32 s88, s87, 1
  s_mul_i32 s88, s88, 327680
  s_add_u32 s62, s88, 1048576
  s_lshr_b32 s89, s56, 1
  s_mul_i32 s89, s89, 5120
  s_mul_i32 s90, s56, 5120
  s_bitcmp0_b32 s56, 0
  s_cselect_b32 s60, s61, s62
  s_add_u32 s60, s60, s89
  s_add_u32 s61, s61, s90
  s_add_u32 s62, s62, s90
  s_lshl_b32 s87, s91, 1
  s_add_u32 s87, s87, s93
  s_mul_i32 s68, s87, 112
  s_xor_b32 s87, s87, 1
  s_mul_i32 s69, s87, 112
  s_lshl_b32 s88, s92, 2
  s_add_u32 s88, s88, s56
  s_add_u32 s68, s68, s88
  s_add_u32 s69, s69, s88
  s_lshl_b32 s70, s68, 5
  s_lshl_b32 s71, s69, 5
  s_add_u32 s70, s70, 65536
  s_add_u32 s71, s71, 65536
  s_mul_i32 s68, s68, 5120
  s_mul_i32 s69, s69, 5120
  s_add_u32 s68, s68, 7340032
  s_add_u32 s69, s69, 7340032
  s_lshr_b32 s75, s91, 1
  s_lshl_b32 s75, s75, 13
  s_lshl_b32 s88, s56, 11
  s_add_u32 s75, s75, s88
  s_add_u32 s75, s75, 4096
  s_lshl_b32 s87, s94, 1
  s_add_u32 s87, s87, s96
  s_mul_i32 s64, s87, 112
  s_xor_b32 s87, s87, 1
  s_mul_i32 s65, s87, 112
  s_mul_i32 s87, s96, 56
  s_add_u32 s64, s64, s87
  s_add_u32 s65, s65, s87
  s_lshl_b32 s72, s64, 5
  s_lshl_b32 s73, s65, 5
  s_add_u32 s72, s72, 65536
  s_add_u32 s73, s73, 65536
  s_mul_i32 s64, s64, 5120
  s_mul_i32 s65, s65, 5120
  s_add_u32 s64, s64, 7340032
  s_add_u32 s65, s65, 7340032
  s_add_u32 s87, s64, 204800
  s_bitcmp0_b32 s56, 0
  s_cselect_b32 s63, s87, s65
  s_add_u32 s63, s63, s89
  s_add_u32 s64, s64, s90
  s_add_u32 s65, s65, s90
  s_lshl_b32 s87, s2, 2
  s_add_u32 s87, s87, s56
  s_xor_b32 s88, s87, 4
  s_lshl_b32 s76, s87, 5
  s_lshl_b32 s77, s88, 5
  s_add_u32 s76, s76, 131072
  s_add_u32 s77, s77, 131072
  s_mul_i32 s78, s87, 10240
  s_mul_i32 s80, s88, 10240
  s_add_u32 s78, s78, 16777216
  s_add_u32 s80, s80, 16777216
  s_add_u32 s79, s78, 5120
  s_add_u32 s81, s80, 5120
  v_lshlrev_b32 v28, 4, v0
  v_add_u32 v2, 81920, v28
  v_add_u32 v3, 122880, v28
  v_lshlrev_b32 v32, 5, v0
  v_and_b32 v30, 7, v0
  v_lshlrev_b32 v30, 4, v30
  v_lshrrev_b32 v1, 3, v0
  v_mul_u32_u24 v28, 37, v1
  v_lshrrev_b32 v28, 8, v28
  v_add_u32 v1, v1, v28
  v_and_b32 v29, 7, v1
  v_cmp_lt_u32 vcc, 2, v29
  s_nop 1
  v_addc_co_u32 v1, vcc, 0, v1, vcc
  v_lshl_add_u32 v1, v1, 7, v30
  v_lshrrev_b32 v17, 3, v0
  v_add_u32 v17, 8, v17
  v_mul_u32_u24 v28, 37, v17
  v_lshrrev_b32 v28, 8, v28
  v_add_u32 v17, v17, v28
  v_and_b32 v29, 7, v17
  v_cmp_lt_u32 vcc, 2, v29
  s_nop 1
  v_addc_co_u32 v17, vcc, 0, v17, vcc
  v_lshl_add_u32 v17, v17, 7, v30
  v_subrev_u32 v17, 1024, v17
  v_lshrrev_b32 v20, 3, v0
  v_add_u32 v20, 16, v20
  v_mul_u32_u24 v28, 37, v20
  v_lshrrev_b32 v28, 8, v28
  v_add_u32 v20, v20, v28
  v_and_b32 v29, 7, v20
  v_cmp_lt_u32 vcc, 2, v29
  s_nop 1
  v_addc_co_u32 v20, vcc, 0, v20, vcc
  v_lshl_add_u32 v20, v20, 7, v30
  v_subrev_u32 v20, 2048, v20
  v_lshrrev_b32 v21, 3, v0
  v_add_u32 v21, 24, v21
  v_mul_u32_u24 v28, 37, v21
  v_lshrrev_b32 v28, 8, v28
  v_add_u32 v21, v21, v28
  v_and_b32 v29, 7, v21
  v_cmp_lt_u32 vcc, 2, v29
  s_nop 1
  v_addc_co_u32 v21, vcc, 0, v21, vcc
  v_lshl_add_u32 v21, v21, 7, v30
  v_subrev_u32 v21, 3072, v21
  v_lshrrev_b32 v28, 2, v0
  v_and_b32 v29, 7, v28
  s_lshl_b32 s87, s56, 1
  v_xor_b32 v29, s87, v29
  v_lshlrev_b32 v29, 5, v29
  v_lshl_or_b32 v29, v28, 8, v29
  v_and_b32 v28, 3, v0
  v_lshl_or_b32 v4, v28, 3, v29
  v_add_u32 v5, 40960, v4
  v_xor_b32 v6, 32, v4
  v_add_u32 v7, 40960, v6
  v_lshlrev_b32 v16, 7, v0
  s_and_b32 s88, s2, 6
  s_lshl_b32 s88, s88, 2
  s_lshr_b32 s97, 33685507, s88
  s_and_b32 s97, s97, 0xff
  s_lshr_b32 s87, 84083456, s88
  s_and_b32 s87, s87, 0xff
  s_add_u32 s87, s87, s56
  s_mul_i32 s87, s87, 28
  s_lshr_b32 s88, s2, 3
  s_add_u32 s87, s87, s88
  s_and_b32 s88, s2, 1
  s_mul_i32 s88, s88, 7340032
  s_add_u32 s3, s87, 704
  s_lshl_b32 s3, s3, 13
  s_add_u32 s3, s3, s88
  s_cmp_lt_u32 s87, 192
  s_cselect_b32 s3, s3, 1073741824
  s_cmp_lt_u32 s56, s97
  s_cselect_b32 s3, s3, 1073741824
  s_waitcnt vmcnt(1)
  v_lshl_or_b32 v18, v19, 16, v18
  v_mov_b32 v38, s57
  buffer_store_dword v38, v22, s[16:19], s74 offen sc1
  s_barrier
  buffer_load_dword v35, v69, s[28:31], s66 offen
  s_add_u32 s66, s66, 917504
  buffer_load_dword v35, v69, s[28:31], s66 offen
  s_add_u32 s66, s66, 917504
  buffer_load_dword v35, v69, s[28:31], s66 offen
  s_add_u32 s66, s66, 917504
  buffer_load_dword v35, v69, s[28:31], s66 offen
  s_add_u32 s66, s66, 917504
  buffer_load_dword v35, v69, s[28:31], s66 offen
  s_add_u32 s66, s66, 917504
  buffer_load_dword v35, v69, s[28:31], s66 offen
  s_add_u32 s66, s66, 917504
  buffer_load_dword v35, v69, s[28:31], s66 offen
  s_add_u32 s66, s66, 917504
  buffer_load_dword v35, v69, s[28:31], s66 offen
  s_add_u32 s66, s66, 917504
  buffer_load_dword v35, v69, s[28:31], s66 offen
  s_add_u32 s66, s66, 917504
  s_and_b32 s90, s67, 63
  s_lshl_b32 s90, s90, 13
  s_cmp_ge_u32 s67, 64
  s_cselect_b32 s67, 7340032, 0
  s_add_u32 s90, s90, s67
  buffer_load_dword v35, v34, s[32:35], s90 offen
  s_add_u32 s90, s90, 524288
  buffer_load_dword v35, v34, s[32:35], s90 offen
  s_add_u32 s90, s90, 524288
  buffer_load_dword v35, v34, s[32:35], s90 offen
  s_add_u32 s90, s90, 524288
  buffer_load_dword v35, v34, s[32:35], s90 offen
  s_add_u32 s90, s90, 524288
  buffer_load_dword v35, v34, s[32:35], s90 offen
  s_add_u32 s90, s90, 524288
  buffer_load_dword v35, v34, s[32:35], s90 offen
  s_add_u32 s90, s90, 524288
  buffer_load_dword v35, v34, s[32:35], s90 offen
  s_add_u32 s90, s90, 524288
  buffer_load_dword v35, v34, s[32:35], s90 offen
  s_add_u32 s90, s90, 524288
  buffer_load_dword v35, v34, s[32:35], s90 offen
  s_add_u32 s90, s90, 524288
  buffer_load_dword v35, v34, s[32:35], s90 offen
  s_add_u32 s90, s90, 524288
  buffer_load_dword v35, v34, s[32:35], s90 offen
  s_add_u32 s90, s90, 524288
  s_add_u32 m0, s58, 32768
  s_mov_b32 s67, 0
  buffer_load_dwordx4 v12, s[12:15], s67 offen offset:0  lds
  buffer_load_dwordx4 v13, s[12:15], s67 offen offset:1024  lds
  buffer_load_dwordx4 v14, s[12:15], s67 offen offset:2048  lds
  buffer_load_dwordx4 v15, s[12:15], s67 offen offset:3072  lds
  s_add_u32 m0, s58, 49152
  s_mov_b32 s67, 262144
  buffer_load_dwordx4 v12, s[12:15], s67 offen offset:0  lds
  buffer_load_dwordx4 v13, s[12:15], s67 offen offset:1024  lds
  buffer_load_dwordx4 v14, s[12:15], s67 offen offset:2048  lds
  buffer_load_dwordx4 v15, s[12:15], s67 offen offset:3072  lds
  s_add_u32 m0, s58, 65536
  s_mov_b32 s67, 524288
  buffer_load_dwordx4 v12, s[12:15], s67 offen offset:0  lds
  buffer_load_dwordx4 v13, s[12:15], s67 offen offset:1024  lds
  buffer_load_dwordx4 v14, s[12:15], s67 offen offset:2048  lds
  buffer_load_dwordx4 v15, s[12:15], s67 offen offset:3072  lds
  s_add_u32 m0, s58, 0
  s_mov_b32 s67, 786432
  buffer_load_dwordx4 v12, s[12:15], s67 offen offset:0  lds
  buffer_load_dwordx4 v13, s[12:15], s67 offen offset:1024  lds
  buffer_load_dwordx4 v14, s[12:15], s67 offen offset:2048  lds
  buffer_load_dwordx4 v15, s[12:15], s67 offen offset:3072  lds
  s_add_u32 m0, s58, 16384
  s_mov_b32 s67, 1048576
  buffer_load_dwordx4 v12, s[12:15], s67 offen offset:0  lds
  buffer_load_dwordx4 v13, s[12:15], s67 offen offset:1024  lds
  buffer_load_dwordx4 v14, s[12:15], s67 offen offset:2048  lds
  buffer_load_dwordx4 v15, s[12:15], s67 offen offset:3072  lds
  s_waitcnt vmcnt(16)
  s_barrier
  ds_read_b64_tr_b16 a[16:17], v4 offset:32768
  ds_read_b64_tr_b16 a[18:19], v4 offset:36864
  ds_read_b64_tr_b16 a[20:21], v6 offset:32768
  ds_read_b64_tr_b16 a[22:23], v6 offset:36864
  ds_read_b64_tr_b16 a[24:25], v5 offset:0
  ds_read_b64_tr_b16 a[26:27], v5 offset:4096
  ds_read_b64_tr_b16 a[28:29], v7 offset:0
  ds_read_b64_tr_b16 a[30:31], v7 offset:4096
  s_waitcnt vmcnt(12) lgkmcnt(0)
  s_barrier
  ds_read_b64_tr_b16 a[32:33], v5 offset:8192
  ds_read_b64_tr_b16 a[34:35], v5 offset:12288
  ds_read_b64_tr_b16 a[36:37], v7 offset:8192
  ds_read_b64_tr_b16 a[38:39], v7 offset:12288
  ds_read_b64_tr_b16 a[40:41], v5 offset:16384
  ds_read_b64_tr_b16 a[42:43], v5 offset:20480
  ds_read_b64_tr_b16 a[44:45], v7 offset:16384
  ds_read_b64_tr_b16 a[46:47], v7 offset:20480
  s_add_u32 m0, s58, 32768
  s_mov_b32 s67, 1310720
  buffer_load_dwordx4 v12, s[12:15], s67 offen offset:0  lds
  buffer_load_dwordx4 v13, s[12:15], s67 offen offset:1024  lds
  buffer_load_dwordx4 v14, s[12:15], s67 offen offset:2048  lds
  buffer_load_dwordx4 v15, s[12:15], s67 offen offset:3072  lds
  s_waitcnt vmcnt(12) lgkmcnt(0)
  s_barrier
  ds_read_b64_tr_b16 a[48:49], v5 offset:24576
  ds_read_b64_tr_b16 a[50:51], v5 offset:28672
  ds_read_b64_tr_b16 a[52:53], v7 offset:24576
  ds_read_b64_tr_b16 a[54:55], v7 offset:28672
  ds_read_b64_tr_b16 a[56:57], v5 offset:32768
  ds_read_b64_tr_b16 a[58:59], v5 offset:36864
  ds_read_b64_tr_b16 a[60:61], v7 offset:32768
  ds_read_b64_tr_b16 a[62:63], v7 offset:36864
  s_add_u32 m0, s58, 49152
  s_mov_b32 s67, 1572864
  buffer_load_dwordx4 v12, s[12:15], s67 offen offset:0  lds
  buffer_load_dwordx4 v13, s[12:15], s67 offen offset:1024  lds
  buffer_load_dwordx4 v14, s[12:15], s67 offen offset:2048  lds
  buffer_load_dwordx4 v15, s[12:15], s67 offen offset:3072  lds
  s_waitcnt vmcnt(12) lgkmcnt(0)
  s_barrier
  ds_read_b64_tr_b16 a[64:65], v4 offset:0
  ds_read_b64_tr_b16 a[66:67], v4 offset:4096
  ds_read_b64_tr_b16 a[68:69], v6 offset:0
  ds_read_b64_tr_b16 a[70:71], v6 offset:4096
  ds_read_b64_tr_b16 a[72:73], v4 offset:8192
  ds_read_b64_tr_b16 a[74:75], v4 offset:12288
  ds_read_b64_tr_b16 a[76:77], v6 offset:8192
  ds_read_b64_tr_b16 a[78:79], v6 offset:12288
  s_add_u32 m0, s58, 65536
  s_mov_b32 s67, 1835008
  buffer_load_dwordx4 v12, s[12:15], s67 offen offset:0  lds
  buffer_load_dwordx4 v13, s[12:15], s67 offen offset:1024  lds
  buffer_load_dwordx4 v14, s[12:15], s67 offen offset:2048  lds
  buffer_load_dwordx4 v15, s[12:15], s67 offen offset:3072  lds
  s_waitcnt vmcnt(12) lgkmcnt(0)
  s_barrier
  ds_read_b64_tr_b16 a[80:81], v4 offset:16384
  ds_read_b64_tr_b16 a[82:83], v4 offset:20480
  ds_read_b64_tr_b16 a[84:85], v6 offset:16384
  ds_read_b64_tr_b16 a[86:87], v6 offset:20480
  ds_read_b64_tr_b16 a[88:89], v4 offset:24576
  ds_read_b64_tr_b16 a[90:91], v4 offset:28672
  ds_read_b64_tr_b16 a[92:93], v6 offset:24576
  ds_read_b64_tr_b16 a[94:95], v6 offset:28672
  s_add_u32 m0, s58, 0
  s_mov_b32 s67, 2097152
  buffer_load_dwordx4 v12, s[12:15], s67 offen offset:0  lds
  buffer_load_dwordx4 v13, s[12:15], s67 offen offset:1024  lds
  buffer_load_dwordx4 v14, s[12:15], s67 offen offset:2048  lds
  buffer_load_dwordx4 v15, s[12:15], s67 offen offset:3072  lds
  s_waitcnt vmcnt(12) lgkmcnt(0)
  s_barrier
  ds_read_b64_tr_b16 a[96:97], v4 offset:32768
  ds_read_b64_tr_b16 a[98:99], v4 offset:36864
  ds_read_b64_tr_b16 a[100:101], v6 offset:32768
  ds_read_b64_tr_b16 a[102:103], v6 offset:36864
  ds_read_b64_tr_b16 a[104:105], v5 offset:0
  ds_read_b64_tr_b16 a[106:107], v5 offset:4096
  ds_read_b64_tr_b16 a[108:109], v7 offset:0
  ds_read_b64_tr_b16 a[110:111], v7 offset:4096
  s_add_u32 m0, s58, 16384
  s_mov_b32 s67, 2359296
  buffer_load_dwordx4 v12, s[12:15], s67 offen offset:0  lds
  buffer_load_dwordx4 v13, s[12:15], s67 offen offset:1024  lds
  buffer_load_dwordx4 v14, s[12:15], s67 offen offset:2048  lds
  buffer_load_dwordx4 v15, s[12:15], s67 offen offset:3072  lds
  s_waitcnt vmcnt(12) lgkmcnt(0)
  s_barrier
  ds_read_b64_tr_b16 a[112:113], v5 offset:8192
  ds_read_b64_tr_b16 a[114:115], v5 offset:12288
  ds_read_b64_tr_b16 a[116:117], v7 offset:8192
  ds_read_b64_tr_b16 a[118:119], v7 offset:12288
  ds_read_b64_tr_b16 a[120:121], v5 offset:16384
  ds_read_b64_tr_b16 a[122:123], v5 offset:20480
  ds_read_b64_tr_b16 a[124:125], v7 offset:16384
  ds_read_b64_tr_b16 a[126:127], v7 offset:20480
  s_add_u32 m0, s58, 32768
  s_mov_b32 s67, 2621440
  buffer_load_dwordx4 v12, s[12:15], s67 offen offset:0  lds
  buffer_load_dwordx4 v13, s[12:15], s67 offen offset:1024  lds
  buffer_load_dwordx4 v14, s[12:15], s67 offen offset:2048  lds
  buffer_load_dwordx4 v15, s[12:15], s67 offen offset:3072  lds
  s_waitcnt vmcnt(12) lgkmcnt(0)
  s_barrier
  ds_read_b64_tr_b16 a[128:129], v5 offset:24576
  ds_read_b64_tr_b16 a[130:131], v5 offset:28672
  ds_read_b64_tr_b16 a[132:133], v7 offset:24576
  ds_read_b64_tr_b16 a[134:135], v7 offset:28672
  ds_read_b64_tr_b16 a[136:137], v5 offset:32768
  ds_read_b64_tr_b16 a[138:139], v5 offset:36864
  ds_read_b64_tr_b16 a[140:141], v7 offset:32768
  ds_read_b64_tr_b16 a[142:143], v7 offset:36864
  s_add_u32 m0, s58, 49152
  s_mov_b32 s67, 2883584
  buffer_load_dwordx4 v12, s[12:15], s67 offen offset:0  lds
  buffer_load_dwordx4 v13, s[12:15], s67 offen offset:1024  lds
  buffer_load_dwordx4 v14, s[12:15], s67 offen offset:2048  lds
  buffer_load_dwordx4 v15, s[12:15], s67 offen offset:3072  lds
  s_waitcnt vmcnt(12) lgkmcnt(0)
  s_barrier
  ds_read_b64_tr_b16 a[144:145], v4 offset:0
  ds_read_b64_tr_b16 a[146:147], v4 offset:4096
  ds_read_b64_tr_b16 a[148:149], v6 offset:0
  ds_read_b64_tr_b16 a[150:151], v6 offset:4096
  ds_read_b64_tr_b16 a[152:153], v4 offset:8192
  ds_read_b64_tr_b16 a[154:155], v4 offset:12288
  ds_read_b64_tr_b16 a[156:157], v6 offset:8192
  ds_read_b64_tr_b16 a[158:159], v6 offset:12288
  s_add_u32 m0, s58, 65536
  s_mov_b32 s67, 3145728
  buffer_load_dwordx4 v12, s[12:15], s67 offen offset:0  lds
  buffer_load_dwordx4 v13, s[12:15], s67 offen offset:1024  lds
  buffer_load_dwordx4 v14, s[12:15], s67 offen offset:2048  lds
  buffer_load_dwordx4 v15, s[12:15], s67 offen offset:3072  lds
  s_waitcnt vmcnt(12) lgkmcnt(0)
  s_barrier
  ds_read_b64_tr_b16 a[160:161], v4 offset:16384
  ds_read_b64_tr_b16 a[162:163], v4 offset:20480
  ds_read_b64_tr_b16 a[164:165], v6 offset:16384
  ds_read_b64_tr_b16 a[166:167], v6 offset:20480
  ds_read_b64_tr_b16 a[168:169], v4 offset:24576
  ds_read_b64_tr_b16 a[170:171], v4 offset:28672
  ds_read_b64_tr_b16 a[172:173], v6 offset:24576
  ds_read_b64_tr_b16 a[174:175], v6 offset:28672
  s_waitcnt lgkmcnt(0)
  s_barrier
  s_waitcnt vmcnt(0) lgkmcnt(0)
  v_subrev_u32 v37, 81920, v2
  v_min_u32 v37, 880, v37
  v_lshlrev_b32 v37, 1, v37
  buffer_load_dword v39, v37, s[16:19], s72 offen sc1
  s_waitcnt vmcnt(0)
  v_cmp_ne_u32 vcc, s57, v39
  s_cbranch_vccnz L_spin_xs
L_ret_xs:
  s_add_u32 m0, s59, 32768
  s_add_u32 s66, s64, 0
  buffer_load_dwordx4 v1, s[16:19], s66 offen offset:0 sc1 lds
  buffer_load_dwordx4 v17, s[16:19], s66 offen offset:1024 sc1 lds
  buffer_load_dwordx4 v20, s[16:19], s66 offen offset:2048 sc1 lds
  s_waitcnt vmcnt(0)
  s_branch L_join
L_spin_f1:
  s_mov_b32 s82, 1048576
L_spinl_f1:
  buffer_load_dword v39, v32, s[16:19], s75 offen sc1
  s_waitcnt vmcnt(0)
  v_cmp_ne_u32 vcc, s57, v39
  s_cbranch_vccz L_ret_f1
  s_sleep 2
  s_sub_u32 s82, s82, 1
  s_cbranch_scc0 L_spinl_f1
  s_branch L_ret_f1
L_spin_x:
  s_mov_b32 s82, 1048576
L_spinl_x:
  buffer_load_dword v39, v37, s[16:19], s72 offen sc1
  s_waitcnt vmcnt(0)
  v_cmp_ne_u32 vcc, s57, v39
  s_cbranch_vccz L_ret_x
  s_sleep 2
  s_sub_u32 s82, s82, 1
  s_cbranch_scc0 L_spinl_x
  s_branch L_ret_x
L_spin_y:
  s_mov_b32 s82, 1048576
L_spinl_y:
  buffer_load_dword v39, v37, s[16:19], s73 offen sc1
  s_waitcnt vmcnt(0)
  v_cmp_ne_u32 vcc, s57, v39
  s_cbranch_vccz L_ret_y
  s_sleep 2
  s_sub_u32 s82, s82, 1
  s_cbranch_scc0 L_spinl_y
  s_branch L_ret_y
L_spin_3:
  s_mov_b32 s82, 1048576
L_spinl_3:
  buffer_load_dword v39, off, s[16:19], s77 sc1
  s_waitcnt vmcnt(0)
  v_cmp_ne_u32 vcc, s57, v39
  s_cbranch_vccz L_ret_3
  s_sleep 2
  s_sub_u32 s82, s82, 1
  s_cbranch_scc0 L_spinl_3
  s_branch L_ret_3
L_spin_xs:
  s_mov_b32 s82, 1048576
L_spinl_xs:
  buffer_load_dword v39, v37, s[16:19], s72 offen sc1
  s_waitcnt vmcnt(0)
  v_cmp_ne_u32 vcc, s57, v39
  s_cbranch_vccz L_ret_xs
  s_sleep 2
  s_sub_u32 s82, s82, 1
  s_cbranch_scc0 L_spinl_xs
  s_branch L_ret_xs
L_end:
  s_endpgm
.p2align 12
L_main:
L_mark0:
  s_cbranch_execz L_mark4
  s_waitcnt vmcnt(16) lgkmcnt(0)
  s_barrier
  ds_read_b64_tr_b16 a[40:41], v4 offset:0
  ds_read_b128 v[104:107], v2 offset:0
  s_add_u32 m0, s58, 65536
  s_mov_b32 s67, 6422528
  buffer_load_dwordx4 v8, s[8:11], s67 offen offset:0  lds
  ds_read_b128 v[108:111], v2 offset:1024
  ds_read_b64_tr_b16 a[42:43], v4 offset:4096
  ds_read_b128 v[112:115], v2 offset:2048
  buffer_load_dwordx4 v9, s[8:11], s67 offen offset:1024  lds
  ds_read_b128 v[116:119], v2 offset:3072
  ds_read_b64_tr_b16 a[44:45], v6 offset:0
  ds_read_b128 v[120:123], v2 offset:4096
  buffer_load_dwordx4 v10, s[8:11], s67 offen offset:2048  lds
  ds_read_b128 v[124:127], v2 offset:5120
  ds_read_b64_tr_b16 a[46:47], v6 offset:4096
  s_waitcnt lgkmcnt(6)
  v_mfma_f32_16x16x32_bf16 v[40:43], v[136:139], v[104:107], v[24:27]
  ds_read_b128 v[128:131], v2 offset:6144
  v_mfma_f32_16x16x32_bf16 v[44:47], v[140:143], v[104:107], v[28:31]
  buffer_load_dwordx4 v11, s[8:11], s67 offen offset:3072  lds
  v_mfma_f32_16x16x32_bf16 v[52:55], v[140:143], v[108:111], v[28:31]
  ds_read_b128 v[132:135], v2 offset:7168
  s_waitcnt lgkmcnt(6)
  v_mfma_f32_16x16x32_bf16 v[48:51], v[136:139], v[108:111], v[24:27]
  ds_read_b64_tr_b16 a[48:49], v4 offset:8192
  v_mfma_f32_16x16x32_bf16 v[56:59], v[136:139], v[112:115], v[24:27]
  ds_read_b128 v[104:107], v2 offset:8192
  s_add_u32 m0, s59, 49152
  s_add_u32 s66, s60, 30720
  v_mfma_f32_16x16x32_bf16 v[60:63], v[140:143], v[112:115], v[28:31]
  buffer_load_dwordx4 v1, s[16:19], s66 offen offset:0 sc1 lds
  v_mfma_f32_16x16x32_bf16 v[68:71], v[140:143], v[116:119], v[28:31]
  ds_read_b128 v[108:111], v2 offset:9216
  s_waitcnt lgkmcnt(6)
  v_mfma_f32_16x16x32_bf16 v[64:67], v[136:139], v[116:119], v[24:27]
  ds_read_b64_tr_b16 a[50:51], v4 offset:12288
  v_mfma_f32_16x16x32_bf16 v[72:75], v[136:139], v[120:123], v[24:27]
  ds_read_b128 v[112:115], v2 offset:10240
  v_mfma_f32_16x16x32_bf16 v[76:79], v[140:143], v[120:123], v[28:31]
  buffer_load_dwordx4 v17, s[16:19], s66 offen offset:1024 sc1 lds
  v_mfma_f32_16x16x32_bf16 v[84:87], v[140:143], v[124:127], v[28:31]
  ds_read_b128 v[116:119], v2 offset:11264
  s_waitcnt lgkmcnt(6)
  v_mfma_f32_16x16x32_bf16 v[80:83], v[136:139], v[124:127], v[24:27]
  ds_read_b64_tr_b16 a[52:53], v6 offset:8192
  v_mfma_f32_16x16x32_bf16 v[88:91], v[136:139], v[128:131], v[24:27]
  ds_read_b128 v[120:123], v2 offset:12288
  v_mfma_f32_16x16x32_bf16 v[92:95], v[140:143], v[128:131], v[28:31]
  buffer_load_dwordx4 v20, s[16:19], s66 offen offset:2048 sc1 lds
  v_mfma_f32_16x16x32_bf16 v[100:103], v[140:143], v[132:135], v[28:31]
  ds_read_b128 v[124:127], v2 offset:13312
  s_waitcnt lgkmcnt(6)
  v_mfma_f32_16x16x32_bf16 v[96:99], v[136:139], v[132:135], v[24:27]
  ds_read_b64_tr_b16 a[54:55], v6 offset:12288
  v_mfma_f32_16x16x32_bf16 v[40:43], v[144:147], v[104:107], v[40:43]
  ds_read_b128 v[128:131], v2 offset:14336
  v_mfma_f32_16x16x32_bf16 v[44:47], v[148:151], v[104:107], v[44:47]
  buffer_load_dwordx4 v21, s[16:19], s66 offen offset:3072 sc1 lds
  v_mfma_f32_16x16x32_bf16 v[52:55], v[148:151], v[108:111], v[52:55]
  ds_read_b128 v[132:135], v2 offset:15360
  s_waitcnt lgkmcnt(6)
  v_mfma_f32_16x16x32_bf16 v[48:51], v[144:147], v[108:111], v[48:51]
  s_waitcnt vmcnt(20)
  s_barrier
  ds_read_b64_tr_b16 a[56:57], v4 offset:16384
  v_mfma_f32_16x16x32_bf16 v[56:59], v[144:147], v[112:115], v[56:59]
  ds_read_b128 v[104:107], v2 offset:16384
  s_add_u32 m0, s59, 65536
  s_add_u32 s66, s60, 40960
  v_mfma_f32_16x16x32_bf16 v[60:63], v[148:151], v[112:115], v[60:63]
  buffer_load_dwordx4 v1, s[16:19], s66 offen offset:0 sc1 lds
  v_mfma_f32_16x16x32_bf16 v[68:71], v[148:151], v[116:119], v[68:71]
  ds_read_b128 v[108:111], v2 offset:17408
  s_waitcnt lgkmcnt(6)
  v_mfma_f32_16x16x32_bf16 v[64:67], v[144:147], v[116:119], v[64:67]
  ds_read_b64_tr_b16 a[58:59], v4 offset:20480
  v_mfma_f32_16x16x32_bf16 v[72:75], v[144:147], v[120:123], v[72:75]
  ds_read_b128 v[112:115], v2 offset:18432
  v_mfma_f32_16x16x32_bf16 v[76:79], v[148:151], v[120:123], v[76:79]
  buffer_load_dwordx4 v17, s[16:19], s66 offen offset:1024 sc1 lds
  v_mfma_f32_16x16x32_bf16 v[84:87], v[148:151], v[124:127], v[84:87]
  ds_read_b128 v[116:119], v2 offset:19456
  s_waitcnt lgkmcnt(6)
  v_mfma_f32_16x16x32_bf16 v[80:83], v[144:147], v[124:127], v[80:83]
  ds_read_b64_tr_b16 a[60:61], v6 offset:16384
  v_mfma_f32_16x16x32_bf16 v[88:91], v[144:147], v[128:131], v[88:91]
  ds_read_b128 v[120:123], v2 offset:20480
  v_mfma_f32_16x16x32_bf16 v[92:95], v[148:151], v[128:131], v[92:95]
  buffer_load_dwordx4 v20, s[16:19], s66 offen offset:2048 sc1 lds
  v_mfma_f32_16x16x32_bf16 v[100:103], v[148:151], v[132:135], v[100:103]
  ds_read_b128 v[124:127], v2 offset:21504
  s_waitcnt lgkmcnt(6)
  v_mfma_f32_16x16x32_bf16 v[96:99], v[144:147], v[132:135], v[96:99]
  ds_read_b64_tr_b16 a[62:63], v6 offset:20480
  v_mfma_f32_16x16x32_bf16 v[40:43], v[152:155], v[104:107], v[40:43]
  ds_read_b128 v[128:131], v2 offset:22528
  v_mfma_f32_16x16x32_bf16 v[44:47], v[156:159], v[104:107], v[44:47]
  buffer_load_dwordx4 v21, s[16:19], s66 offen offset:3072 sc1 lds
  v_mfma_f32_16x16x32_bf16 v[52:55], v[156:159], v[108:111], v[52:55]
  ds_read_b128 v[132:135], v2 offset:23552
  s_waitcnt lgkmcnt(6)
  v_mfma_f32_16x16x32_bf16 v[48:51], v[152:155], v[108:111], v[48:51]
  ds_read_b64_tr_b16 a[64:65], v4 offset:24576
  v_mfma_f32_16x16x32_bf16 v[56:59], v[152:155], v[112:115], v[56:59]
  ds_read_b128 v[104:107], v2 offset:24576
  v_mfma_f32_16x16x32_bf16 v[60:63], v[156:159], v[112:115], v[60:63]
  v_mfma_f32_16x16x32_bf16 v[68:71], v[156:159], v[116:119], v[68:71]
  ds_read_b128 v[108:111], v2 offset:25600
  s_waitcnt lgkmcnt(6)
  v_mfma_f32_16x16x32_bf16 v[64:67], v[152:155], v[116:119], v[64:67]
  ds_read_b64_tr_b16 a[66:67], v4 offset:28672
  v_mfma_f32_16x16x32_bf16 v[72:75], v[152:155], v[120:123], v[72:75]
  ds_read_b128 v[112:115], v2 offset:26624
  v_mfma_f32_16x16x32_bf16 v[76:79], v[156:159], v[120:123], v[76:79]
  v_mfma_f32_16x16x32_bf16 v[84:87], v[156:159], v[124:127], v[84:87]
  ds_read_b128 v[116:119], v2 offset:27648
  s_waitcnt lgkmcnt(6)
  v_mfma_f32_16x16x32_bf16 v[80:83], v[152:155], v[124:127], v[80:83]
  ds_read_b64_tr_b16 a[68:69], v6 offset:24576
  v_mfma_f32_16x16x32_bf16 v[88:91], v[152:155], v[128:131], v[88:91]
  ds_read_b128 v[120:123], v2 offset:28672
  v_mfma_f32_16x16x32_bf16 v[92:95], v[156:159], v[128:131], v[92:95]
  v_mfma_f32_16x16x32_bf16 v[100:103], v[156:159], v[132:135], v[100:103]
  ds_read_b128 v[124:127], v2 offset:29696
  s_waitcnt lgkmcnt(6)
  v_mfma_f32_16x16x32_bf16 v[96:99], v[152:155], v[132:135], v[96:99]
  ds_read_b64_tr_b16 a[70:71], v6 offset:28672
  v_mfma_f32_16x16x32_bf16 v[40:43], v[160:163], v[104:107], v[40:43]
  ds_read_b128 v[128:131], v2 offset:30720
  v_mfma_f32_16x16x32_bf16 v[44:47], v[164:167], v[104:107], v[44:47]
  v_mfma_f32_16x16x32_bf16 v[52:55], v[164:167], v[108:111], v[52:55]
  ds_read_b128 v[132:135], v2 offset:31744
  s_waitcnt lgkmcnt(6)
  v_mfma_f32_16x16x32_bf16 v[48:51], v[160:163], v[108:111], v[48:51]
  s_waitcnt vmcnt(16)
  s_barrier
  ds_read_b64_tr_b16 a[72:73], v4 offset:32768
  v_mfma_f32_16x16x32_bf16 v[56:59], v[160:163], v[112:115], v[56:59]
  ds_read_b128 v[104:107], v2 offset:32768
  s_add_u32 m0, s58, 0
  s_mov_b32 s67, 6881280
  v_mfma_f32_16x16x32_bf16 v[60:63], v[164:167], v[112:115], v[60:63]
  buffer_load_dwordx4 v8, s[8:11], s67 offen offset:0  lds
  v_mfma_f32_16x16x32_bf16 v[68:71], v[164:167], v[116:119], v[68:71]
  ds_read_b128 v[108:111], v2 offset:33792
  s_waitcnt lgkmcnt(6)
  v_mfma_f32_16x16x32_bf16 v[64:67], v[160:163], v[116:119], v[64:67]
  ds_read_b64_tr_b16 a[74:75], v4 offset:36864
  v_mfma_f32_16x16x32_bf16 v[72:75], v[160:163], v[120:123], v[72:75]
  ds_read_b128 v[112:115], v2 offset:34816
  v_mfma_f32_16x16x32_bf16 v[76:79], v[164:167], v[120:123], v[76:79]
  buffer_load_dwordx4 v9, s[8:11], s67 offen offset:1024  lds
  v_mfma_f32_16x16x32_bf16 v[84:87], v[164:167], v[124:127], v[84:87]
  ds_read_b128 v[116:119], v2 offset:35840
  s_waitcnt lgkmcnt(6)
  v_mfma_f32_16x16x32_bf16 v[80:83], v[160:163], v[124:127], v[80:83]
  ds_read_b64_tr_b16 a[76:77], v6 offset:32768
  v_mfma_f32_16x16x32_bf16 v[88:91], v[160:163], v[128:131], v[88:91]
  ds_read_b128 v[120:123], v2 offset:36864
  v_mfma_f32_16x16x32_bf16 v[92:95], v[164:167], v[128:131], v[92:95]
  buffer_load_dwordx4 v10, s[8:11], s67 offen offset:2048  lds
  v_mfma_f32_16x16x32_bf16 v[100:103], v[164:167], v[132:135], v[100:103]
  ds_read_b128 v[124:127], v2 offset:37888
  s_waitcnt lgkmcnt(6)
  v_mfma_f32_16x16x32_bf16 v[96:99], v[160:163], v[132:135], v[96:99]
  ds_read_b64_tr_b16 a[78:79], v6 offset:36864
  v_mfma_f32_16x16x32_bf16 v[40:43], v[168:171], v[104:107], v[40:43]
  ds_read_b128 v[128:131], v2 offset:38912
  v_mfma_f32_16x16x32_bf16 v[44:47], v[172:175], v[104:107], v[44:47]
  buffer_load_dwordx4 v11, s[8:11], s67 offen offset:3072  lds
  v_mfma_f32_16x16x32_bf16 v[52:55], v[172:175], v[108:111], v[52:55]
  ds_read_b128 v[132:135], v2 offset:39936
  s_waitcnt lgkmcnt(6)
  v_mfma_f32_16x16x32_bf16 v[48:51], v[168:171], v[108:111], v[48:51]
  ds_read_b64_tr_b16 a[80:81], v5 offset:0
  v_mfma_f32_16x16x32_bf16 v[56:59], v[168:171], v[112:115], v[56:59]
  ds_read_b128 v[104:107], v3 offset:0
  s_add_u32 m0, s59, 0
  s_add_u32 s66, s60, 51200
  v_mfma_f32_16x16x32_bf16 v[60:63], v[172:175], v[112:115], v[60:63]
  buffer_load_dwordx4 v1, s[16:19], s66 offen offset:0 sc1 lds
  v_mfma_f32_16x16x32_bf16 v[68:71], v[172:175], v[116:119], v[68:71]
  ds_read_b128 v[108:111], v3 offset:1024
  s_waitcnt lgkmcnt(6)
  v_mfma_f32_16x16x32_bf16 v[64:67], v[168:171], v[116:119], v[64:67]
  ds_read_b64_tr_b16 a[82:83], v5 offset:4096
  v_mfma_f32_16x16x32_bf16 v[72:75], v[168:171], v[120:123], v[72:75]
  ds_read_b128 v[112:115], v3 offset:2048
  v_mfma_f32_16x16x32_bf16 v[76:79], v[172:175], v[120:123], v[76:79]
  buffer_load_dwordx4 v17, s[16:19], s66 offen offset:1024 sc1 lds
  v_mfma_f32_16x16x32_bf16 v[84:87], v[172:175], v[124:127], v[84:87]
  ds_read_b128 v[116:119], v3 offset:3072
  s_waitcnt lgkmcnt(6)
  v_mfma_f32_16x16x32_bf16 v[80:83], v[168:171], v[124:127], v[80:83]
  ds_read_b64_tr_b16 a[84:85], v7 offset:0
  v_mfma_f32_16x16x32_bf16 v[88:91], v[168:171], v[128:131], v[88:91]
  ds_read_b128 v[120:123], v3 offset:4096
  v_mfma_f32_16x16x32_bf16 v[92:95], v[172:175], v[128:131], v[92:95]
  buffer_load_dwordx4 v20, s[16:19], s66 offen offset:2048 sc1 lds
  v_mfma_f32_16x16x32_bf16 v[100:103], v[172:175], v[132:135], v[100:103]
  ds_read_b128 v[124:127], v3 offset:5120
  s_waitcnt lgkmcnt(6)
  v_mfma_f32_16x16x32_bf16 v[96:99], v[168:171], v[132:135], v[96:99]
  ds_read_b64_tr_b16 a[86:87], v7 offset:4096
  v_mfma_f32_16x16x32_bf16 v[40:43], v[176:179], v[104:107], v[40:43]
  ds_read_b128 v[128:131], v3 offset:6144
  v_mfma_f32_16x16x32_bf16 v[44:47], v[180:183], v[104:107], v[44:47]
  buffer_load_dwordx4 v21, s[16:19], s66 offen offset:3072 sc1 lds
  v_mfma_f32_16x16x32_bf16 v[52:55], v[180:183], v[108:111], v[52:55]
  ds_read_b128 v[132:135], v3 offset:7168
  s_waitcnt lgkmcnt(6)
  v_mfma_f32_16x16x32_bf16 v[48:51], v[176:179], v[108:111], v[48:51]
  s_waitcnt vmcnt(12)
  s_barrier
  ds_read_b64_tr_b16 a[88:89], v5 offset:8192
  v_mfma_f32_16x16x32_bf16 v[56:59], v[176:179], v[112:115], v[56:59]
  ds_read_b128 v[104:107], v3 offset:8192
  s_add_u32 m0, s58, 16384
  s_mov_b32 s67, 7340032
  v_mfma_f32_16x16x32_bf16 v[60:63], v[180:183], v[112:115], v[60:63]
  buffer_load_dwordx4 v8, s[8:11], s67 offen offset:0  lds
  v_mfma_f32_16x16x32_bf16 v[68:71], v[180:183], v[116:119], v[68:71]
  ds_read_b128 v[108:111], v3 offset:9216
  s_waitcnt lgkmcnt(6)
  v_mfma_f32_16x16x32_bf16 v[64:67], v[176:179], v[116:119], v[64:67]
  ds_read_b64_tr_b16 a[90:91], v5 offset:12288
  v_mfma_f32_16x16x32_bf16 v[72:75], v[176:179], v[120:123], v[72:75]
  ds_read_b128 v[112:115], v3 offset:10240
  v_mfma_f32_16x16x32_bf16 v[76:79], v[180:183], v[120:123], v[76:79]
  buffer_load_dwordx4 v9, s[8:11], s67 offen offset:1024  lds
  v_mfma_f32_16x16x32_bf16 v[84:87], v[180:183], v[124:127], v[84:87]
  ds_read_b128 v[116:119], v3 offset:11264
  s_waitcnt lgkmcnt(6)
  v_mfma_f32_16x16x32_bf16 v[80:83], v[176:179], v[124:127], v[80:83]
  ds_read_b64_tr_b16 a[92:93], v7 offset:8192
  v_mfma_f32_16x16x32_bf16 v[88:91], v[176:179], v[128:131], v[88:91]
  ds_read_b128 v[120:123], v3 offset:12288
  v_mfma_f32_16x16x32_bf16 v[92:95], v[180:183], v[128:131], v[92:95]
  buffer_load_dwordx4 v10, s[8:11], s67 offen offset:2048  lds
  v_mfma_f32_16x16x32_bf16 v[100:103], v[180:183], v[132:135], v[100:103]
  ds_read_b128 v[124:127], v3 offset:13312
  s_waitcnt lgkmcnt(6)
  v_mfma_f32_16x16x32_bf16 v[96:99], v[176:179], v[132:135], v[96:99]
  ds_read_b64_tr_b16 a[94:95], v7 offset:12288
  v_mfma_f32_16x16x32_bf16 v[40:43], v[184:187], v[104:107], v[40:43]
  ds_read_b128 v[128:131], v3 offset:14336
  v_mfma_f32_16x16x32_bf16 v[44:47], v[188:191], v[104:107], v[44:47]
  buffer_load_dwordx4 v11, s[8:11], s67 offen offset:3072  lds
  v_mfma_f32_16x16x32_bf16 v[52:55], v[188:191], v[108:111], v[52:55]
  ds_read_b128 v[132:135], v3 offset:15360
  s_waitcnt lgkmcnt(6)
  v_mfma_f32_16x16x32_bf16 v[48:51], v[184:187], v[108:111], v[48:51]
  ds_read_b64_tr_b16 a[96:97], v5 offset:16384
  v_mfma_f32_16x16x32_bf16 v[56:59], v[184:187], v[112:115], v[56:59]
  ds_read_b128 v[104:107], v3 offset:16384
  s_add_u32 m0, s59, 16384
  s_add_u32 s66, s60, 61440
  v_mfma_f32_16x16x32_bf16 v[60:63], v[188:191], v[112:115], v[60:63]
  buffer_load_dwordx4 v1, s[16:19], s66 offen offset:0 sc1 lds
  v_mfma_f32_16x16x32_bf16 v[68:71], v[188:191], v[116:119], v[68:71]
  ds_read_b128 v[108:111], v3 offset:17408
  s_waitcnt lgkmcnt(6)
  v_mfma_f32_16x16x32_bf16 v[64:67], v[184:187], v[116:119], v[64:67]
  ds_read_b64_tr_b16 a[98:99], v5 offset:20480
  v_mfma_f32_16x16x32_bf16 v[72:75], v[184:187], v[120:123], v[72:75]
  ds_read_b128 v[112:115], v3 offset:18432
  v_mfma_f32_16x16x32_bf16 v[76:79], v[188:191], v[120:123], v[76:79]
  buffer_load_dwordx4 v17, s[16:19], s66 offen offset:1024 sc1 lds
  v_mfma_f32_16x16x32_bf16 v[84:87], v[188:191], v[124:127], v[84:87]
  ds_read_b128 v[116:119], v3 offset:19456
  s_waitcnt lgkmcnt(6)
  v_mfma_f32_16x16x32_bf16 v[80:83], v[184:187], v[124:127], v[80:83]
  ds_read_b64_tr_b16 a[100:101], v7 offset:16384
  v_mfma_f32_16x16x32_bf16 v[88:91], v[184:187], v[128:131], v[88:91]
  ds_read_b128 v[120:123], v3 offset:20480
  v_mfma_f32_16x16x32_bf16 v[92:95], v[188:191], v[128:131], v[92:95]
  buffer_load_dwordx4 v20, s[16:19], s66 offen offset:2048 sc1 lds
  v_mfma_f32_16x16x32_bf16 v[100:103], v[188:191], v[132:135], v[100:103]
  ds_read_b128 v[124:127], v3 offset:21504
  s_waitcnt lgkmcnt(6)
  v_mfma_f32_16x16x32_bf16 v[96:99], v[184:187], v[132:135], v[96:99]
  ds_read_b64_tr_b16 a[102:103], v7 offset:20480
  v_mfma_f32_16x16x32_bf16 v[40:43], v[192:195], v[104:107], v[40:43]
  ds_read_b128 v[128:131], v3 offset:22528
  v_mfma_f32_16x16x32_bf16 v[44:47], v[196:199], v[104:107], v[44:47]
  buffer_load_dwordx4 v21, s[16:19], s66 offen offset:3072 sc1 lds
  v_mfma_f32_16x16x32_bf16 v[52:55], v[196:199], v[108:111], v[52:55]
  ds_read_b128 v[132:135], v3 offset:23552
  s_waitcnt lgkmcnt(6)
  v_mfma_f32_16x16x32_bf16 v[48:51], v[192:195], v[108:111], v[48:51]
  s_waitcnt vmcnt(16)
  s_barrier
  ds_read_b64_tr_b16 a[104:105], v5 offset:24576
  v_mfma_f32_16x16x32_bf16 v[56:59], v[192:195], v[112:115], v[56:59]
  ds_read_b128 v[104:107], v3 offset:24576
  s_add_u32 m0, s58, 32768
  s_mov_b32 s67, 7798784
  v_mfma_f32_16x16x32_bf16 v[60:63], v[196:199], v[112:115], v[60:63]
  buffer_load_dwordx4 v8, s[8:11], s67 offen offset:0  lds
  v_mfma_f32_16x16x32_bf16 v[68:71], v[196:199], v[116:119], v[68:71]
  ds_read_b128 v[108:111], v3 offset:25600
  s_waitcnt lgkmcnt(6)
  v_mfma_f32_16x16x32_bf16 v[64:67], v[192:195], v[116:119], v[64:67]
  ds_read_b64_tr_b16 a[106:107], v5 offset:28672
  v_mfma_f32_16x16x32_bf16 v[72:75], v[192:195], v[120:123], v[72:75]
  ds_read_b128 v[112:115], v3 offset:26624
  v_mfma_f32_16x16x32_bf16 v[76:79], v[196:199], v[120:123], v[76:79]
  buffer_load_dwordx4 v9, s[8:11], s67 offen offset:1024  lds
  v_mfma_f32_16x16x32_bf16 v[84:87], v[196:199], v[124:127], v[84:87]
  ds_read_b128 v[116:119], v3 offset:27648
  s_waitcnt lgkmcnt(6)
  v_mfma_f32_16x16x32_bf16 v[80:83], v[192:195], v[124:127], v[80:83]
  ds_read_b64_tr_b16 a[108:109], v7 offset:24576
  v_mfma_f32_16x16x32_bf16 v[88:91], v[192:195], v[128:131], v[88:91]
  ds_read_b128 v[120:123], v3 offset:28672
  v_mfma_f32_16x16x32_bf16 v[92:95], v[196:199], v[128:131], v[92:95]
  buffer_load_dwordx4 v10, s[8:11], s67 offen offset:2048  lds
  v_mfma_f32_16x16x32_bf16 v[100:103], v[196:199], v[132:135], v[100:103]
  ds_read_b128 v[124:127], v3 offset:29696
  s_waitcnt lgkmcnt(6)
  v_mfma_f32_16x16x32_bf16 v[96:99], v[192:195], v[132:135], v[96:99]
  ds_read_b64_tr_b16 a[110:111], v7 offset:28672
  v_mfma_f32_16x16x32_bf16 v[40:43], v[200:203], v[104:107], v[40:43]
  ds_read_b128 v[128:131], v3 offset:30720
  v_mfma_f32_16x16x32_bf16 v[44:47], v[204:207], v[104:107], v[44:47]
  buffer_load_dwordx4 v11, s[8:11], s67 offen offset:3072  lds
  v_mfma_f32_16x16x32_bf16 v[52:55], v[204:207], v[108:111], v[52:55]
  ds_read_b128 v[132:135], v3 offset:31744
  s_waitcnt lgkmcnt(6)
  v_mfma_f32_16x16x32_bf16 v[48:51], v[200:203], v[108:111], v[48:51]
  ds_read_b64_tr_b16 a[112:113], v5 offset:32768
  v_mfma_f32_16x16x32_bf16 v[56:59], v[200:203], v[112:115], v[56:59]
  ds_read_b128 v[104:107], v3 offset:32768
  s_add_u32 m0, s59, 32768
  s_add_u32 s66, s60, 71680
  v_mfma_f32_16x16x32_bf16 v[60:63], v[204:207], v[112:115], v[60:63]
  buffer_load_dwordx4 v1, s[16:19], s66 offen offset:0 sc1 lds
  v_mfma_f32_16x16x32_bf16 v[68:71], v[204:207], v[116:119], v[68:71]
  ds_read_b128 v[108:111], v3 offset:33792
  s_waitcnt lgkmcnt(6)
  v_mfma_f32_16x16x32_bf16 v[64:67], v[200:203], v[116:119], v[64:67]
  ds_read_b64_tr_b16 a[114:115], v5 offset:36864
  v_mfma_f32_16x16x32_bf16 v[72:75], v[200:203], v[120:123], v[72:75]
  ds_read_b128 v[112:115], v3 offset:34816
  v_mfma_f32_16x16x32_bf16 v[76:79], v[204:207], v[120:123], v[76:79]
  buffer_load_dwordx4 v17, s[16:19], s66 offen offset:1024 sc1 lds
  v_mfma_f32_16x16x32_bf16 v[84:87], v[204:207], v[124:127], v[84:87]
  ds_read_b128 v[116:119], v3 offset:35840
  s_waitcnt lgkmcnt(6)
  v_mfma_f32_16x16x32_bf16 v[80:83], v[200:203], v[124:127], v[80:83]
  ds_read_b64_tr_b16 a[116:117], v7 offset:32768
  v_mfma_f32_16x16x32_bf16 v[88:91], v[200:203], v[128:131], v[88:91]
  ds_read_b128 v[120:123], v3 offset:36864
  v_mfma_f32_16x16x32_bf16 v[92:95], v[204:207], v[128:131], v[92:95]
  buffer_load_dwordx4 v20, s[16:19], s66 offen offset:2048 sc1 lds
  v_mfma_f32_16x16x32_bf16 v[100:103], v[204:207], v[132:135], v[100:103]
  ds_read_b128 v[124:127], v3 offset:37888
  s_waitcnt lgkmcnt(6)
  v_mfma_f32_16x16x32_bf16 v[96:99], v[200:203], v[132:135], v[96:99]
  ds_read_b64_tr_b16 a[118:119], v7 offset:36864
  v_mfma_f32_16x16x32_bf16 v[40:43], v[208:211], v[104:107], v[40:43]
  ds_read_b128 v[128:131], v3 offset:38912
  v_mfma_f32_16x16x32_bf16 v[44:47], v[212:215], v[104:107], v[44:47]
  buffer_load_dwordx4 v21, s[16:19], s66 offen offset:3072 sc1 lds
  v_mfma_f32_16x16x32_bf16 v[52:55], v[212:215], v[108:111], v[52:55]
  ds_read_b128 v[132:135], v3 offset:39936
  s_waitcnt lgkmcnt(6)
  v_mfma_f32_16x16x32_bf16 v[48:51], v[208:211], v[108:111], v[48:51]
  s_waitcnt vmcnt(16)
  s_barrier
  ds_read_b64_tr_b16 a[120:121], v4 offset:0
  v_mfma_f32_16x16x32_bf16 v[56:59], v[208:211], v[112:115], v[56:59]
  ds_read_b128 v[104:107], v2 offset:0
  s_add_u32 m0, s58, 49152
  s_mov_b32 s67, 8257536
  v_mfma_f32_16x16x32_bf16 v[60:63], v[212:215], v[112:115], v[60:63]
  buffer_load_dwordx4 v8, s[8:11], s67 offen offset:0  lds
  v_mfma_f32_16x16x32_bf16 v[68:71], v[212:215], v[116:119], v[68:71]
  ds_read_b128 v[108:111], v2 offset:1024
  s_waitcnt lgkmcnt(6)
  v_mfma_f32_16x16x32_bf16 v[64:67], v[208:211], v[116:119], v[64:67]
  ds_read_b64_tr_b16 a[122:123], v4 offset:4096
  v_mfma_f32_16x16x32_bf16 v[72:75], v[208:211], v[120:123], v[72:75]
  ds_read_b128 v[112:115], v2 offset:2048
  v_mfma_f32_16x16x32_bf16 v[76:79], v[212:215], v[120:123], v[76:79]
  buffer_load_dwordx4 v9, s[8:11], s67 offen offset:1024  lds
  v_mfma_f32_16x16x32_bf16 v[84:87], v[212:215], v[124:127], v[84:87]
  ds_read_b128 v[116:119], v2 offset:3072
  s_waitcnt lgkmcnt(6)
  v_mfma_f32_16x16x32_bf16 v[80:83], v[208:211], v[124:127], v[80:83]
  ds_read_b64_tr_b16 a[124:125], v6 offset:0
  v_mfma_f32_16x16x32_bf16 v[88:91], v[208:211], v[128:131], v[88:91]
  ds_read_b128 v[120:123], v2 offset:4096
  v_mfma_f32_16x16x32_bf16 v[92:95], v[212:215], v[128:131], v[92:95]
  buffer_load_dwordx4 v10, s[8:11], s67 offen offset:2048  lds
  v_mfma_f32_16x16x32_bf16 v[100:103], v[212:215], v[132:135], v[100:103]
  ds_read_b128 v[124:127], v2 offset:5120
  s_waitcnt lgkmcnt(6)
  v_mfma_f32_16x16x32_bf16 v[96:99], v[208:211], v[132:135], v[96:99]
  ds_read_b64_tr_b16 a[126:127], v6 offset:4096
  v_mfma_f32_16x16x32_bf16 v[40:43], v[216:219], v[104:107], v[40:43]
  ds_read_b128 v[128:131], v2 offset:6144
  v_mfma_f32_16x16x32_bf16 v[44:47], v[220:223], v[104:107], v[44:47]
  buffer_load_dwordx4 v11, s[8:11], s67 offen offset:3072  lds
  v_mfma_f32_16x16x32_bf16 v[52:55], v[220:223], v[108:111], v[52:55]
  ds_read_b128 v[132:135], v2 offset:7168
  s_waitcnt lgkmcnt(6)
  v_mfma_f32_16x16x32_bf16 v[48:51], v[216:219], v[108:111], v[48:51]
  ds_read_b64_tr_b16 a[128:129], v4 offset:8192
  v_mfma_f32_16x16x32_bf16 v[56:59], v[216:219], v[112:115], v[56:59]
  ds_read_b128 v[104:107], v2 offset:8192
  s_add_u32 m0, s59, 49152
  s_add_u32 s66, s60, 81920
  v_mfma_f32_16x16x32_bf16 v[60:63], v[220:223], v[112:115], v[60:63]
  buffer_load_dwordx4 v1, s[16:19], s66 offen offset:0 sc1 lds
  v_mfma_f32_16x16x32_bf16 v[68:71], v[220:223], v[116:119], v[68:71]
  ds_read_b128 v[108:111], v2 offset:9216
  s_waitcnt lgkmcnt(6)
  v_mfma_f32_16x16x32_bf16 v[64:67], v[216:219], v[116:119], v[64:67]
  ds_read_b64_tr_b16 a[130:131], v4 offset:12288
  v_mfma_f32_16x16x32_bf16 v[72:75], v[216:219], v[120:123], v[72:75]
  ds_read_b128 v[112:115], v2 offset:10240
  v_mfma_f32_16x16x32_bf16 v[76:79], v[220:223], v[120:123], v[76:79]
  buffer_load_dwordx4 v17, s[16:19], s66 offen offset:1024 sc1 lds
  v_mfma_f32_16x16x32_bf16 v[84:87], v[220:223], v[124:127], v[84:87]
  ds_read_b128 v[116:119], v2 offset:11264
  s_waitcnt lgkmcnt(6)
  v_mfma_f32_16x16x32_bf16 v[80:83], v[216:219], v[124:127], v[80:83]
  ds_read_b64_tr_b16 a[132:133], v6 offset:8192
  v_mfma_f32_16x16x32_bf16 v[88:91], v[216:219], v[128:131], v[88:91]
  ds_read_b128 v[120:123], v2 offset:12288
  v_mfma_f32_16x16x32_bf16 v[92:95], v[220:223], v[128:131], v[92:95]
  buffer_load_dwordx4 v20, s[16:19], s66 offen offset:2048 sc1 lds
  v_mfma_f32_16x16x32_bf16 v[100:103], v[220:223], v[132:135], v[100:103]
  ds_read_b128 v[124:127], v2 offset:13312
  s_waitcnt lgkmcnt(6)
  v_mfma_f32_16x16x32_bf16 v[96:99], v[216:219], v[132:135], v[96:99]
  ds_read_b64_tr_b16 a[134:135], v6 offset:12288
  v_mfma_f32_16x16x32_bf16 v[40:43], v[224:227], v[104:107], v[40:43]
  ds_read_b128 v[128:131], v2 offset:14336
  v_mfma_f32_16x16x32_bf16 v[44:47], v[228:231], v[104:107], v[44:47]
  buffer_load_dwordx4 v21, s[16:19], s66 offen offset:3072 sc1 lds
  v_mfma_f32_16x16x32_bf16 v[52:55], v[228:231], v[108:111], v[52:55]
  ds_read_b128 v[132:135], v2 offset:15360
  s_waitcnt lgkmcnt(6)
  v_mfma_f32_16x16x32_bf16 v[48:51], v[224:227], v[108:111], v[48:51]
  s_waitcnt vmcnt(16)
  s_barrier
  ds_read_b64_tr_b16 a[136:137], v4 offset:16384
  v_mfma_f32_16x16x32_bf16 v[56:59], v[224:227], v[112:115], v[56:59]
  ds_read_b128 v[104:107], v2 offset:16384
  s_add_u32 m0, s58, 65536
  s_mov_b32 s67, 8716288
  v_mfma_f32_16x16x32_bf16 v[60:63], v[228:231], v[112:115], v[60:63]
  buffer_load_dwordx4 v8, s[8:11], s67 offen offset:0  lds
  v_mfma_f32_16x16x32_bf16 v[68:71], v[228:231], v[116:119], v[68:71]
  ds_read_b128 v[108:111], v2 offset:17408
  s_waitcnt lgkmcnt(6)
  v_mfma_f32_16x16x32_bf16 v[64:67], v[224:227], v[116:119], v[64:67]
  ds_read_b64_tr_b16 a[138:139], v4 offset:20480
  v_mfma_f32_16x16x32_bf16 v[72:75], v[224:227], v[120:123], v[72:75]
  ds_read_b128 v[112:115], v2 offset:18432
  v_mfma_f32_16x16x32_bf16 v[76:79], v[228:231], v[120:123], v[76:79]
  buffer_load_dwordx4 v9, s[8:11], s67 offen offset:1024  lds
  v_mfma_f32_16x16x32_bf16 v[84:87], v[228:231], v[124:127], v[84:87]
  ds_read_b128 v[116:119], v2 offset:19456
  s_waitcnt lgkmcnt(6)
  v_mfma_f32_16x16x32_bf16 v[80:83], v[224:227], v[124:127], v[80:83]
  ds_read_b64_tr_b16 a[140:141], v6 offset:16384
  v_mfma_f32_16x16x32_bf16 v[88:91], v[224:227], v[128:131], v[88:91]
  ds_read_b128 v[120:123], v2 offset:20480
  v_mfma_f32_16x16x32_bf16 v[92:95], v[228:231], v[128:131], v[92:95]
  buffer_load_dwordx4 v10, s[8:11], s67 offen offset:2048  lds
  v_mfma_f32_16x16x32_bf16 v[100:103], v[228:231], v[132:135], v[100:103]
  ds_read_b128 v[124:127], v2 offset:21504
  s_waitcnt lgkmcnt(6)
  v_mfma_f32_16x16x32_bf16 v[96:99], v[224:227], v[132:135], v[96:99]
  ds_read_b64_tr_b16 a[142:143], v6 offset:20480
  v_mfma_f32_16x16x32_bf16 v[40:43], v[232:235], v[104:107], v[40:43]
  ds_read_b128 v[128:131], v2 offset:22528
  v_mfma_f32_16x16x32_bf16 v[44:47], v[236:239], v[104:107], v[44:47]
  buffer_load_dwordx4 v11, s[8:11], s67 offen offset:3072  lds
  v_mfma_f32_16x16x32_bf16 v[52:55], v[236:239], v[108:111], v[52:55]
  ds_read_b128 v[132:135], v2 offset:23552
  s_waitcnt lgkmcnt(6)
  v_mfma_f32_16x16x32_bf16 v[48:51], v[232:235], v[108:111], v[48:51]
  ds_read_b64_tr_b16 a[144:145], v4 offset:24576
  v_mfma_f32_16x16x32_bf16 v[56:59], v[232:235], v[112:115], v[56:59]
  ds_read_b128 v[104:107], v2 offset:24576
  s_add_u32 m0, s59, 65536
  s_add_u32 s66, s60, 92160
  v_mfma_f32_16x16x32_bf16 v[60:63], v[236:239], v[112:115], v[60:63]
  buffer_load_dwordx4 v1, s[16:19], s66 offen offset:0 sc1 lds
  v_mfma_f32_16x16x32_bf16 v[68:71], v[236:239], v[116:119], v[68:71]
  ds_read_b128 v[108:111], v2 offset:25600
  s_waitcnt lgkmcnt(6)
  v_mfma_f32_16x16x32_bf16 v[64:67], v[232:235], v[116:119], v[64:67]
  ds_read_b64_tr_b16 a[146:147], v4 offset:28672
  v_mfma_f32_16x16x32_bf16 v[72:75], v[232:235], v[120:123], v[72:75]
  ds_read_b128 v[112:115], v2 offset:26624
  v_mfma_f32_16x16x32_bf16 v[76:79], v[236:239], v[120:123], v[76:79]
  buffer_load_dwordx4 v17, s[16:19], s66 offen offset:1024 sc1 lds
  v_mfma_f32_16x16x32_bf16 v[84:87], v[236:239], v[124:127], v[84:87]
  ds_read_b128 v[116:119], v2 offset:27648
  s_waitcnt lgkmcnt(6)
  v_mfma_f32_16x16x32_bf16 v[80:83], v[232:235], v[124:127], v[80:83]
  ds_read_b64_tr_b16 a[148:149], v6 offset:24576
  v_mfma_f32_16x16x32_bf16 v[88:91], v[232:235], v[128:131], v[88:91]
  ds_read_b128 v[120:123], v2 offset:28672
  v_mfma_f32_16x16x32_bf16 v[92:95], v[236:239], v[128:131], v[92:95]
  buffer_load_dwordx4 v20, s[16:19], s66 offen offset:2048 sc1 lds
  v_mfma_f32_16x16x32_bf16 v[100:103], v[236:239], v[132:135], v[100:103]
  ds_read_b128 v[124:127], v2 offset:29696
  s_waitcnt lgkmcnt(6)
  v_mfma_f32_16x16x32_bf16 v[96:99], v[232:235], v[132:135], v[96:99]
  ds_read_b64_tr_b16 a[150:151], v6 offset:28672
  v_mfma_f32_16x16x32_bf16 v[40:43], v[240:243], v[104:107], v[40:43]
  ds_read_b128 v[128:131], v2 offset:30720
  v_mfma_f32_16x16x32_bf16 v[44:47], v[244:247], v[104:107], v[44:47]
  buffer_load_dwordx4 v21, s[16:19], s66 offen offset:3072 sc1 lds
  v_mfma_f32_16x16x32_bf16 v[52:55], v[244:247], v[108:111], v[52:55]
  ds_read_b128 v[132:135], v2 offset:31744
  s_waitcnt lgkmcnt(6)
  v_mfma_f32_16x16x32_bf16 v[48:51], v[240:243], v[108:111], v[48:51]
  s_waitcnt vmcnt(16)
  s_barrier
  ds_read_b64_tr_b16 a[152:153], v4 offset:32768
  v_mfma_f32_16x16x32_bf16 v[56:59], v[240:243], v[112:115], v[56:59]
  ds_read_b128 v[104:107], v2 offset:32768
  s_add_u32 m0, s58, 0
  s_mov_b32 s67, 9175040
  v_mfma_f32_16x16x32_bf16 v[60:63], v[244:247], v[112:115], v[60:63]
  buffer_load_dwordx4 v8, s[8:11], s67 offen offset:0  lds
  v_mfma_f32_16x16x32_bf16 v[68:71], v[244:247], v[116:119], v[68:71]
  ds_read_b128 v[108:111], v2 offset:33792
  s_waitcnt lgkmcnt(6)
  v_mfma_f32_16x16x32_bf16 v[64:67], v[240:243], v[116:119], v[64:67]
  ds_read_b64_tr_b16 a[154:155], v4 offset:36864
  v_mfma_f32_16x16x32_bf16 v[72:75], v[240:243], v[120:123], v[72:75]
  ds_read_b128 v[112:115], v2 offset:34816
  v_mfma_f32_16x16x32_bf16 v[76:79], v[244:247], v[120:123], v[76:79]
  buffer_load_dwordx4 v9, s[8:11], s67 offen offset:1024  lds
  v_mfma_f32_16x16x32_bf16 v[84:87], v[244:247], v[124:127], v[84:87]
  ds_read_b128 v[116:119], v2 offset:35840
  s_waitcnt lgkmcnt(6)
  v_mfma_f32_16x16x32_bf16 v[80:83], v[240:243], v[124:127], v[80:83]
  ds_read_b64_tr_b16 a[156:157], v6 offset:32768
L_mark1:
  s_cbranch_execz L_mark5
  v_mfma_f32_16x16x32_bf16 v[88:91], v[240:243], v[128:131], v[88:91]
  ds_read_b128 v[120:123], v2 offset:36864
  v_mfma_f32_16x16x32_bf16 v[92:95], v[244:247], v[128:131], v[92:95]
  buffer_load_dwordx4 v10, s[8:11], s67 offen offset:2048  lds
  v_mfma_f32_16x16x32_bf16 v[100:103], v[244:247], v[132:135], v[100:103]
  ds_read_b128 v[124:127], v2 offset:37888
  s_waitcnt lgkmcnt(6)
  v_mfma_f32_16x16x32_bf16 v[96:99], v[240:243], v[132:135], v[96:99]
  ds_read_b64_tr_b16 a[158:159], v6 offset:36864
  v_mfma_f32_16x16x32_bf16 v[40:43], v[248:251], v[104:107], v[40:43]
  ds_read_b128 v[128:131], v2 offset:38912
  v_mfma_f32_16x16x32_bf16 v[44:47], v[252:255], v[104:107], v[44:47]
  buffer_load_dwordx4 v11, s[8:11], s67 offen offset:3072  lds
  v_mfma_f32_16x16x32_bf16 v[52:55], v[252:255], v[108:111], v[52:55]
  ds_read_b128 v[132:135], v2 offset:39936
  s_waitcnt lgkmcnt(6)
  v_mfma_f32_16x16x32_bf16 v[48:51], v[248:251], v[108:111], v[48:51]
  ds_read_b64_tr_b16 a[160:161], v5 offset:0
  v_mfma_f32_16x16x32_bf16 v[56:59], v[248:251], v[112:115], v[56:59]
  ds_read_b128 v[104:107], v3 offset:0
  s_add_u32 m0, s59, 0
  s_add_u32 s66, s60, 102400
  v_mfma_f32_16x16x32_bf16 v[60:63], v[252:255], v[112:115], v[60:63]
  buffer_load_dwordx4 v1, s[16:19], s66 offen offset:0 sc1 lds
  v_mfma_f32_16x16x32_bf16 v[68:71], v[252:255], v[116:119], v[68:71]
  ds_read_b128 v[108:111], v3 offset:1024
  s_waitcnt lgkmcnt(6)
  v_mfma_f32_16x16x32_bf16 v[64:67], v[248:251], v[116:119], v[64:67]
  ds_read_b64_tr_b16 a[162:163], v5 offset:4096
  v_mfma_f32_16x16x32_bf16 v[72:75], v[248:251], v[120:123], v[72:75]
  ds_read_b128 v[112:115], v3 offset:2048
  v_mfma_f32_16x16x32_bf16 v[76:79], v[252:255], v[120:123], v[76:79]
  buffer_load_dwordx4 v17, s[16:19], s66 offen offset:1024 sc1 lds
  v_mfma_f32_16x16x32_bf16 v[84:87], v[252:255], v[124:127], v[84:87]
  ds_read_b128 v[116:119], v3 offset:3072
  s_waitcnt lgkmcnt(6)
  v_mfma_f32_16x16x32_bf16 v[80:83], v[248:251], v[124:127], v[80:83]
  ds_read_b64_tr_b16 a[164:165], v7 offset:0
  v_mfma_f32_16x16x32_bf16 v[88:91], v[248:251], v[128:131], v[88:91]
  ds_read_b128 v[120:123], v3 offset:4096
  v_mfma_f32_16x16x32_bf16 v[92:95], v[252:255], v[128:131], v[92:95]
  buffer_load_dwordx4 v20, s[16:19], s66 offen offset:2048 sc1 lds
  v_mfma_f32_16x16x32_bf16 v[100:103], v[252:255], v[132:135], v[100:103]
  ds_read_b128 v[124:127], v3 offset:5120
  s_waitcnt lgkmcnt(6)
  v_mfma_f32_16x16x32_bf16 v[96:99], v[248:251], v[132:135], v[96:99]
  ds_read_b64_tr_b16 a[166:167], v7 offset:4096
  v_mfma_f32_16x16x32_bf16 v[40:43], a[0:3], v[104:107], v[40:43]
  ds_read_b128 v[128:131], v3 offset:6144
  v_mfma_f32_16x16x32_bf16 v[44:47], a[4:7], v[104:107], v[44:47]
  buffer_load_dwordx4 v21, s[16:19], s66 offen offset:3072 sc1 lds
  v_mfma_f32_16x16x32_bf16 v[52:55], a[4:7], v[108:111], v[52:55]
  ds_read_b128 v[132:135], v3 offset:7168
  s_waitcnt lgkmcnt(6)
  v_mfma_f32_16x16x32_bf16 v[48:51], a[0:3], v[108:111], v[48:51]
  s_waitcnt vmcnt(16)
  s_barrier
  ds_read_b64_tr_b16 a[168:169], v5 offset:8192
  v_mfma_f32_16x16x32_bf16 v[56:59], a[0:3], v[112:115], v[56:59]
  ds_read_b128 v[104:107], v3 offset:8192
  s_add_u32 m0, s58, 16384
  s_mov_b32 s67, 9633792
  v_mfma_f32_16x16x32_bf16 v[60:63], a[4:7], v[112:115], v[60:63]
  buffer_load_dwordx4 v8, s[8:11], s67 offen offset:0  lds
  v_mfma_f32_16x16x32_bf16 v[68:71], a[4:7], v[116:119], v[68:71]
  ds_read_b128 v[108:111], v3 offset:9216
  s_waitcnt lgkmcnt(6)
  v_mfma_f32_16x16x32_bf16 v[64:67], a[0:3], v[116:119], v[64:67]
  ds_read_b64_tr_b16 a[170:171], v5 offset:12288
  v_mfma_f32_16x16x32_bf16 v[72:75], a[0:3], v[120:123], v[72:75]
  ds_read_b128 v[112:115], v3 offset:10240
  v_mfma_f32_16x16x32_bf16 v[76:79], a[4:7], v[120:123], v[76:79]
  buffer_load_dwordx4 v9, s[8:11], s67 offen offset:1024  lds
  v_mfma_f32_16x16x32_bf16 v[84:87], a[4:7], v[124:127], v[84:87]
  ds_read_b128 v[116:119], v3 offset:11264
  s_waitcnt lgkmcnt(6)
  v_mfma_f32_16x16x32_bf16 v[80:83], a[0:3], v[124:127], v[80:83]
  ds_read_b64_tr_b16 a[172:173], v7 offset:8192
  v_mfma_f32_16x16x32_bf16 v[88:91], a[0:3], v[128:131], v[88:91]
  ds_read_b128 v[120:123], v3 offset:12288
  v_mfma_f32_16x16x32_bf16 v[92:95], a[4:7], v[128:131], v[92:95]
  buffer_load_dwordx4 v10, s[8:11], s67 offen offset:2048  lds
  v_mfma_f32_16x16x32_bf16 v[100:103], a[4:7], v[132:135], v[100:103]
  ds_read_b128 v[124:127], v3 offset:13312
  s_waitcnt lgkmcnt(6)
  v_mfma_f32_16x16x32_bf16 v[96:99], a[0:3], v[132:135], v[96:99]
  ds_read_b64_tr_b16 a[174:175], v7 offset:12288
  v_mfma_f32_16x16x32_bf16 v[40:43], a[8:11], v[104:107], v[40:43]
  ds_read_b128 v[128:131], v3 offset:14336
  v_mfma_f32_16x16x32_bf16 v[44:47], a[12:15], v[104:107], v[44:47]
  buffer_load_dwordx4 v11, s[8:11], s67 offen offset:3072  lds
  v_mfma_f32_16x16x32_bf16 v[52:55], a[12:15], v[108:111], v[52:55]
  ds_read_b128 v[132:135], v3 offset:15360
  s_waitcnt lgkmcnt(6)
  v_mfma_f32_16x16x32_bf16 v[48:51], a[8:11], v[108:111], v[48:51]
  ds_read_b64_tr_b16 a[176:177], v5 offset:16384
  v_mfma_f32_16x16x32_bf16 v[56:59], a[8:11], v[112:115], v[56:59]
  ds_read_b128 v[104:107], v3 offset:16384
  s_add_u32 m0, s59, 16384
  s_add_u32 s66, s60, 112640
  v_mfma_f32_16x16x32_bf16 v[60:63], a[12:15], v[112:115], v[60:63]
  buffer_load_dwordx4 v1, s[16:19], s66 offen offset:0 sc1 lds
  v_mfma_f32_16x16x32_bf16 v[68:71], a[12:15], v[116:119], v[68:71]
  ds_read_b128 v[108:111], v3 offset:17408
  s_waitcnt lgkmcnt(6)
  v_mfma_f32_16x16x32_bf16 v[64:67], a[8:11], v[116:119], v[64:67]
  ds_read_b64_tr_b16 a[178:179], v5 offset:20480
  v_mfma_f32_16x16x32_bf16 v[72:75], a[8:11], v[120:123], v[72:75]
  ds_read_b128 v[112:115], v3 offset:18432
  v_mfma_f32_16x16x32_bf16 v[76:79], a[12:15], v[120:123], v[76:79]
  buffer_load_dwordx4 v17, s[16:19], s66 offen offset:1024 sc1 lds
  v_mfma_f32_16x16x32_bf16 v[84:87], a[12:15], v[124:127], v[84:87]
  ds_read_b128 v[116:119], v3 offset:19456
  s_waitcnt lgkmcnt(6)
  v_mfma_f32_16x16x32_bf16 v[80:83], a[8:11], v[124:127], v[80:83]
  ds_read_b64_tr_b16 a[180:181], v7 offset:16384
  v_mfma_f32_16x16x32_bf16 v[88:91], a[8:11], v[128:131], v[88:91]
  ds_read_b128 v[120:123], v3 offset:20480
  v_mfma_f32_16x16x32_bf16 v[92:95], a[12:15], v[128:131], v[92:95]
  buffer_load_dwordx4 v20, s[16:19], s66 offen offset:2048 sc1 lds
  v_mfma_f32_16x16x32_bf16 v[100:103], a[12:15], v[132:135], v[100:103]
  ds_read_b128 v[124:127], v3 offset:21504
  s_waitcnt lgkmcnt(6)
  v_mfma_f32_16x16x32_bf16 v[96:99], a[8:11], v[132:135], v[96:99]
  ds_read_b64_tr_b16 a[182:183], v7 offset:20480
  v_mfma_f32_16x16x32_bf16 v[40:43], a[16:19], v[104:107], v[40:43]
  ds_read_b128 v[128:131], v3 offset:22528
  v_mfma_f32_16x16x32_bf16 v[44:47], a[20:23], v[104:107], v[44:47]
  buffer_load_dwordx4 v21, s[16:19], s66 offen offset:3072 sc1 lds
  v_mfma_f32_16x16x32_bf16 v[52:55], a[20:23], v[108:111], v[52:55]
  ds_read_b128 v[132:135], v3 offset:23552
  s_waitcnt lgkmcnt(6)
  v_mfma_f32_16x16x32_bf16 v[48:51], a[16:19], v[108:111], v[48:51]
  s_waitcnt vmcnt(16)
  s_barrier
  ds_read_b64_tr_b16 a[184:185], v5 offset:24576
  v_mfma_f32_16x16x32_bf16 v[56:59], a[16:19], v[112:115], v[56:59]
  ds_read_b128 v[104:107], v3 offset:24576
  s_add_u32 m0, s58, 32768
  s_mov_b32 s67, 10092544
  v_mfma_f32_16x16x32_bf16 v[60:63], a[20:23], v[112:115], v[60:63]
  buffer_load_dwordx4 v8, s[8:11], s67 offen offset:0  lds
  v_mfma_f32_16x16x32_bf16 v[68:71], a[20:23], v[116:119], v[68:71]
  ds_read_b128 v[108:111], v3 offset:25600
  s_waitcnt lgkmcnt(6)
  v_mfma_f32_16x16x32_bf16 v[64:67], a[16:19], v[116:119], v[64:67]
  ds_read_b64_tr_b16 a[186:187], v5 offset:28672
  v_mfma_f32_16x16x32_bf16 v[72:75], a[16:19], v[120:123], v[72:75]
  ds_read_b128 v[112:115], v3 offset:26624
  v_mfma_f32_16x16x32_bf16 v[76:79], a[20:23], v[120:123], v[76:79]
  buffer_load_dwordx4 v9, s[8:11], s67 offen offset:1024  lds
  v_mfma_f32_16x16x32_bf16 v[84:87], a[20:23], v[124:127], v[84:87]
  ds_read_b128 v[116:119], v3 offset:27648
  s_waitcnt lgkmcnt(6)
  v_mfma_f32_16x16x32_bf16 v[80:83], a[16:19], v[124:127], v[80:83]
  ds_read_b64_tr_b16 a[188:189], v7 offset:24576
  v_mfma_f32_16x16x32_bf16 v[88:91], a[16:19], v[128:131], v[88:91]
  ds_read_b128 v[120:123], v3 offset:28672
  v_mfma_f32_16x16x32_bf16 v[92:95], a[20:23], v[128:131], v[92:95]
  buffer_load_dwordx4 v10, s[8:11], s67 offen offset:2048  lds
  v_mfma_f32_16x16x32_bf16 v[100:103], a[20:23], v[132:135], v[100:103]
  ds_read_b128 v[124:127], v3 offset:29696
  s_waitcnt lgkmcnt(6)
  v_mfma_f32_16x16x32_bf16 v[96:99], a[16:19], v[132:135], v[96:99]
  ds_read_b64_tr_b16 a[190:191], v7 offset:28672
  v_mfma_f32_16x16x32_bf16 v[40:43], a[24:27], v[104:107], v[40:43]
  ds_read_b128 v[128:131], v3 offset:30720
  v_mfma_f32_16x16x32_bf16 v[44:47], a[28:31], v[104:107], v[44:47]
  buffer_load_dwordx4 v11, s[8:11], s67 offen offset:3072  lds
  v_mfma_f32_16x16x32_bf16 v[52:55], a[28:31], v[108:111], v[52:55]
  ds_read_b128 v[132:135], v3 offset:31744
  s_waitcnt lgkmcnt(6)
  v_mfma_f32_16x16x32_bf16 v[48:51], a[24:27], v[108:111], v[48:51]
  ds_read_b64_tr_b16 a[192:193], v5 offset:32768
  v_mfma_f32_16x16x32_bf16 v[56:59], a[24:27], v[112:115], v[56:59]
  ds_read_b128 v[104:107], v3 offset:32768
  s_add_u32 m0, s59, 32768
  s_add_u32 s66, s61, 122880
  v_mfma_f32_16x16x32_bf16 v[60:63], a[28:31], v[112:115], v[60:63]
  buffer_load_dwordx4 v1, s[16:19], s66 offen offset:0 sc1 lds
  v_mfma_f32_16x16x32_bf16 v[68:71], a[28:31], v[116:119], v[68:71]
  ds_read_b128 v[108:111], v3 offset:33792
  s_waitcnt lgkmcnt(6)
  v_mfma_f32_16x16x32_bf16 v[64:67], a[24:27], v[116:119], v[64:67]
  ds_read_b64_tr_b16 a[194:195], v5 offset:36864
  v_mfma_f32_16x16x32_bf16 v[72:75], a[24:27], v[120:123], v[72:75]
  ds_read_b128 v[112:115], v3 offset:34816
  v_mfma_f32_16x16x32_bf16 v[76:79], a[28:31], v[120:123], v[76:79]
  buffer_load_dwordx4 v17, s[16:19], s66 offen offset:1024 sc1 lds
  v_mfma_f32_16x16x32_bf16 v[84:87], a[28:31], v[124:127], v[84:87]
  ds_read_b128 v[116:119], v3 offset:35840
  s_waitcnt lgkmcnt(6)
  v_mfma_f32_16x16x32_bf16 v[80:83], a[24:27], v[124:127], v[80:83]
  ds_read_b64_tr_b16 a[196:197], v7 offset:32768
  v_mfma_f32_16x16x32_bf16 v[88:91], a[24:27], v[128:131], v[88:91]
  ds_read_b128 v[120:123], v3 offset:36864
  v_mfma_f32_16x16x32_bf16 v[92:95], a[28:31], v[128:131], v[92:95]
  buffer_load_dwordx4 v20, s[16:19], s66 offen offset:2048 sc1 lds
  v_mfma_f32_16x16x32_bf16 v[100:103], a[28:31], v[132:135], v[100:103]
  ds_read_b128 v[124:127], v3 offset:37888
  s_waitcnt lgkmcnt(6)
  v_mfma_f32_16x16x32_bf16 v[96:99], a[24:27], v[132:135], v[96:99]
  ds_read_b64_tr_b16 a[198:199], v7 offset:36864
  v_mfma_f32_16x16x32_bf16 v[40:43], a[32:35], v[104:107], v[40:43]
  ds_read_b128 v[128:131], v3 offset:38912
  v_mfma_f32_16x16x32_bf16 v[44:47], a[36:39], v[104:107], v[44:47]
  buffer_load_dwordx4 v21, s[16:19], s66 offen offset:3072 sc1 lds
  v_mfma_f32_16x16x32_bf16 v[52:55], a[36:39], v[108:111], v[52:55]
  ds_read_b128 v[132:135], v3 offset:39936
  s_waitcnt lgkmcnt(6)
  v_mfma_f32_16x16x32_bf16 v[48:51], a[32:35], v[108:111], v[48:51]
  s_waitcnt vmcnt(16)
  s_barrier
  ds_read_b64_tr_b16 a[200:201], v4 offset:0
  v_mfma_f32_16x16x32_bf16 v[56:59], a[32:35], v[112:115], v[56:59]
  ds_read_b128 v[104:107], v2 offset:0
  s_add_u32 m0, s58, 49152
  s_mov_b32 s67, 10551296
  v_mfma_f32_16x16x32_bf16 v[60:63], a[36:39], v[112:115], v[60:63]
  buffer_load_dwordx4 v8, s[8:11], s67 offen offset:0  lds
  v_mfma_f32_16x16x32_bf16 v[68:71], a[36:39], v[116:119], v[68:71]
  ds_read_b128 v[108:111], v2 offset:1024
  s_waitcnt lgkmcnt(6)
  v_mfma_f32_16x16x32_bf16 v[64:67], a[32:35], v[116:119], v[64:67]
  ds_read_b64_tr_b16 a[202:203], v4 offset:4096
  v_mfma_f32_16x16x32_bf16 v[72:75], a[32:35], v[120:123], v[72:75]
  ds_read_b128 v[112:115], v2 offset:2048
  v_mfma_f32_16x16x32_bf16 v[76:79], a[36:39], v[120:123], v[76:79]
  buffer_load_dwordx4 v9, s[8:11], s67 offen offset:1024  lds
  v_mfma_f32_16x16x32_bf16 v[84:87], a[36:39], v[124:127], v[84:87]
  ds_read_b128 v[116:119], v2 offset:3072
  s_waitcnt lgkmcnt(6)
  v_mfma_f32_16x16x32_bf16 v[80:83], a[32:35], v[124:127], v[80:83]
  ds_read_b64_tr_b16 a[204:205], v6 offset:0
  v_mfma_f32_16x16x32_bf16 v[88:91], a[32:35], v[128:131], v[88:91]
  ds_read_b128 v[120:123], v2 offset:4096
  v_mfma_f32_16x16x32_bf16 v[92:95], a[36:39], v[128:131], v[92:95]
  buffer_load_dwordx4 v10, s[8:11], s67 offen offset:2048  lds
  v_mfma_f32_16x16x32_bf16 v[100:103], a[36:39], v[132:135], v[100:103]
  ds_read_b128 v[124:127], v2 offset:5120
  s_waitcnt lgkmcnt(6)
  v_mfma_f32_16x16x32_bf16 v[96:99], a[32:35], v[132:135], v[96:99]
  ds_read_b64_tr_b16 a[206:207], v6 offset:4096
  v_mfma_f32_16x16x32_bf16 v[40:43], a[40:43], v[104:107], v[40:43]
  ds_read_b128 v[128:131], v2 offset:6144
  v_mfma_f32_16x16x32_bf16 v[44:47], a[44:47], v[104:107], v[44:47]
  buffer_load_dwordx4 v11, s[8:11], s67 offen offset:3072  lds
  v_mfma_f32_16x16x32_bf16 v[52:55], a[44:47], v[108:111], v[52:55]
  ds_read_b128 v[132:135], v2 offset:7168
  s_waitcnt lgkmcnt(6)
  v_mfma_f32_16x16x32_bf16 v[48:51], a[40:43], v[108:111], v[48:51]
  ds_read_b64_tr_b16 a[208:209], v4 offset:8192
  v_mfma_f32_16x16x32_bf16 v[56:59], a[40:43], v[112:115], v[56:59]
  ds_read_b128 v[104:107], v2 offset:8192
  s_add_u32 m0, s59, 49152
  s_add_u32 s66, s61, 143360
  v_mfma_f32_16x16x32_bf16 v[60:63], a[44:47], v[112:115], v[60:63]
  buffer_load_dwordx4 v1, s[16:19], s66 offen offset:0 sc1 lds
  v_mfma_f32_16x16x32_bf16 v[68:71], a[44:47], v[116:119], v[68:71]
  ds_read_b128 v[108:111], v2 offset:9216
  s_waitcnt lgkmcnt(6)
  v_mfma_f32_16x16x32_bf16 v[64:67], a[40:43], v[116:119], v[64:67]
  ds_read_b64_tr_b16 a[210:211], v4 offset:12288
  v_mfma_f32_16x16x32_bf16 v[72:75], a[40:43], v[120:123], v[72:75]
  ds_read_b128 v[112:115], v2 offset:10240
  v_mfma_f32_16x16x32_bf16 v[76:79], a[44:47], v[120:123], v[76:79]
  buffer_load_dwordx4 v17, s[16:19], s66 offen offset:1024 sc1 lds
  v_mfma_f32_16x16x32_bf16 v[84:87], a[44:47], v[124:127], v[84:87]
  ds_read_b128 v[116:119], v2 offset:11264
  s_waitcnt lgkmcnt(6)
  v_mfma_f32_16x16x32_bf16 v[80:83], a[40:43], v[124:127], v[80:83]
  ds_read_b64_tr_b16 a[212:213], v6 offset:8192
  v_mfma_f32_16x16x32_bf16 v[88:91], a[40:43], v[128:131], v[88:91]
  ds_read_b128 v[120:123], v2 offset:12288
  v_mfma_f32_16x16x32_bf16 v[92:95], a[44:47], v[128:131], v[92:95]
  buffer_load_dwordx4 v20, s[16:19], s66 offen offset:2048 sc1 lds
  v_mfma_f32_16x16x32_bf16 v[100:103], a[44:47], v[132:135], v[100:103]
  ds_read_b128 v[124:127], v2 offset:13312
  s_waitcnt lgkmcnt(6)
  v_mfma_f32_16x16x32_bf16 v[96:99], a[40:43], v[132:135], v[96:99]
  ds_read_b64_tr_b16 a[214:215], v6 offset:12288
  v_mfma_f32_16x16x32_bf16 v[40:43], a[48:51], v[104:107], v[40:43]
  ds_read_b128 v[128:131], v2 offset:14336
  v_mfma_f32_16x16x32_bf16 v[44:47], a[52:55], v[104:107], v[44:47]
  buffer_load_dwordx4 v21, s[16:19], s66 offen offset:3072 sc1 lds
  v_mfma_f32_16x16x32_bf16 v[52:55], a[52:55], v[108:111], v[52:55]
  ds_read_b128 v[132:135], v2 offset:15360
  s_waitcnt lgkmcnt(6)
  v_mfma_f32_16x16x32_bf16 v[48:51], a[48:51], v[108:111], v[48:51]
  s_waitcnt vmcnt(16)
  s_barrier
  ds_read_b64_tr_b16 a[216:217], v4 offset:16384
  v_mfma_f32_16x16x32_bf16 v[56:59], a[48:51], v[112:115], v[56:59]
  ds_read_b128 v[104:107], v2 offset:16384
  s_add_u32 m0, s58, 65536
  s_mov_b32 s67, 11010048
  v_mfma_f32_16x16x32_bf16 v[60:63], a[52:55], v[112:115], v[60:63]
  buffer_load_dwordx4 v8, s[8:11], s67 offen offset:0  lds
  v_mfma_f32_16x16x32_bf16 v[68:71], a[52:55], v[116:119], v[68:71]
  ds_read_b128 v[108:111], v2 offset:17408
  s_waitcnt lgkmcnt(6)
  v_mfma_f32_16x16x32_bf16 v[64:67], a[48:51], v[116:119], v[64:67]
  ds_read_b64_tr_b16 a[218:219], v4 offset:20480
  v_mfma_f32_16x16x32_bf16 v[72:75], a[48:51], v[120:123], v[72:75]
  ds_read_b128 v[112:115], v2 offset:18432
  v_mfma_f32_16x16x32_bf16 v[76:79], a[52:55], v[120:123], v[76:79]
  buffer_load_dwordx4 v9, s[8:11], s67 offen offset:1024  lds
  v_mfma_f32_16x16x32_bf16 v[84:87], a[52:55], v[124:127], v[84:87]
  ds_read_b128 v[116:119], v2 offset:19456
  s_waitcnt lgkmcnt(6)
  v_mfma_f32_16x16x32_bf16 v[80:83], a[48:51], v[124:127], v[80:83]
  ds_read_b64_tr_b16 a[220:221], v6 offset:16384
  v_mfma_f32_16x16x32_bf16 v[88:91], a[48:51], v[128:131], v[88:91]
  ds_read_b128 v[120:123], v2 offset:20480
  v_mfma_f32_16x16x32_bf16 v[92:95], a[52:55], v[128:131], v[92:95]
  buffer_load_dwordx4 v10, s[8:11], s67 offen offset:2048  lds
  v_mfma_f32_16x16x32_bf16 v[100:103], a[52:55], v[132:135], v[100:103]
  ds_read_b128 v[124:127], v2 offset:21504
  s_waitcnt lgkmcnt(6)
  v_mfma_f32_16x16x32_bf16 v[96:99], a[48:51], v[132:135], v[96:99]
  ds_read_b64_tr_b16 a[222:223], v6 offset:20480
  v_mfma_f32_16x16x32_bf16 v[40:43], a[56:59], v[104:107], v[40:43]
  ds_read_b128 v[128:131], v2 offset:22528
  v_mfma_f32_16x16x32_bf16 v[44:47], a[60:63], v[104:107], v[44:47]
  buffer_load_dwordx4 v11, s[8:11], s67 offen offset:3072  lds
  v_mfma_f32_16x16x32_bf16 v[52:55], a[60:63], v[108:111], v[52:55]
  ds_read_b128 v[132:135], v2 offset:23552
  s_waitcnt lgkmcnt(6)
  v_mfma_f32_16x16x32_bf16 v[48:51], a[56:59], v[108:111], v[48:51]
  ds_read_b64_tr_b16 a[224:225], v4 offset:24576
  v_mfma_f32_16x16x32_bf16 v[56:59], a[56:59], v[112:115], v[56:59]
  ds_read_b128 v[104:107], v2 offset:24576
  s_add_u32 m0, s59, 65536
  s_add_u32 s66, s61, 163840
  v_mfma_f32_16x16x32_bf16 v[60:63], a[60:63], v[112:115], v[60:63]
  buffer_load_dwordx4 v1, s[16:19], s66 offen offset:0 sc1 lds
  v_mfma_f32_16x16x32_bf16 v[68:71], a[60:63], v[116:119], v[68:71]
  ds_read_b128 v[108:111], v2 offset:25600
  s_waitcnt lgkmcnt(6)
  v_mfma_f32_16x16x32_bf16 v[64:67], a[56:59], v[116:119], v[64:67]
  ds_read_b64_tr_b16 a[226:227], v4 offset:28672
  v_mfma_f32_16x16x32_bf16 v[72:75], a[56:59], v[120:123], v[72:75]
  ds_read_b128 v[112:115], v2 offset:26624
  v_mfma_f32_16x16x32_bf16 v[76:79], a[60:63], v[120:123], v[76:79]
  buffer_load_dwordx4 v17, s[16:19], s66 offen offset:1024 sc1 lds
  v_mfma_f32_16x16x32_bf16 v[84:87], a[60:63], v[124:127], v[84:87]
  ds_read_b128 v[116:119], v2 offset:27648
  s_waitcnt lgkmcnt(6)
  v_mfma_f32_16x16x32_bf16 v[80:83], a[56:59], v[124:127], v[80:83]
  ds_read_b64_tr_b16 a[228:229], v6 offset:24576
  v_mfma_f32_16x16x32_bf16 v[88:91], a[56:59], v[128:131], v[88:91]
  ds_read_b128 v[120:123], v2 offset:28672
  v_mfma_f32_16x16x32_bf16 v[92:95], a[60:63], v[128:131], v[92:95]
  buffer_load_dwordx4 v20, s[16:19], s66 offen offset:2048 sc1 lds
  v_mfma_f32_16x16x32_bf16 v[100:103], a[60:63], v[132:135], v[100:103]
  ds_read_b128 v[124:127], v2 offset:29696
  s_waitcnt lgkmcnt(6)
  v_mfma_f32_16x16x32_bf16 v[96:99], a[56:59], v[132:135], v[96:99]
  ds_read_b64_tr_b16 a[230:231], v6 offset:28672
  v_mfma_f32_16x16x32_bf16 v[40:43], a[64:67], v[104:107], v[40:43]
  ds_read_b128 v[128:131], v2 offset:30720
  v_mfma_f32_16x16x32_bf16 v[44:47], a[68:71], v[104:107], v[44:47]
  buffer_load_dwordx4 v21, s[16:19], s66 offen offset:3072 sc1 lds
  v_mfma_f32_16x16x32_bf16 v[52:55], a[68:71], v[108:111], v[52:55]
  ds_read_b128 v[132:135], v2 offset:31744
  s_waitcnt lgkmcnt(6)
  v_mfma_f32_16x16x32_bf16 v[48:51], a[64:67], v[108:111], v[48:51]
  s_waitcnt vmcnt(16)
  s_barrier
  ds_read_b64_tr_b16 a[232:233], v4 offset:32768
  v_mfma_f32_16x16x32_bf16 v[56:59], a[64:67], v[112:115], v[56:59]
  ds_read_b128 v[104:107], v2 offset:32768
  s_add_u32 m0, s58, 0
  s_mov_b32 s67, 11468800
  v_mfma_f32_16x16x32_bf16 v[60:63], a[68:71], v[112:115], v[60:63]
  buffer_load_dwordx4 v8, s[8:11], s67 offen offset:0  lds
  v_mfma_f32_16x16x32_bf16 v[68:71], a[68:71], v[116:119], v[68:71]
  ds_read_b128 v[108:111], v2 offset:33792
  s_waitcnt lgkmcnt(6)
  v_mfma_f32_16x16x32_bf16 v[64:67], a[64:67], v[116:119], v[64:67]
  ds_read_b64_tr_b16 a[234:235], v4 offset:36864
  v_mfma_f32_16x16x32_bf16 v[72:75], a[64:67], v[120:123], v[72:75]
  ds_read_b128 v[112:115], v2 offset:34816
  v_mfma_f32_16x16x32_bf16 v[76:79], a[68:71], v[120:123], v[76:79]
  buffer_load_dwordx4 v9, s[8:11], s67 offen offset:1024  lds
  v_mfma_f32_16x16x32_bf16 v[84:87], a[68:71], v[124:127], v[84:87]
  ds_read_b128 v[116:119], v2 offset:35840
  s_waitcnt lgkmcnt(6)
  v_mfma_f32_16x16x32_bf16 v[80:83], a[64:67], v[124:127], v[80:83]
  ds_read_b64_tr_b16 a[236:237], v6 offset:32768
  v_mfma_f32_16x16x32_bf16 v[88:91], a[64:67], v[128:131], v[88:91]
  ds_read_b128 v[120:123], v2 offset:36864
  v_mfma_f32_16x16x32_bf16 v[92:95], a[68:71], v[128:131], v[92:95]
  buffer_load_dwordx4 v10, s[8:11], s67 offen offset:2048  lds
  v_mfma_f32_16x16x32_bf16 v[100:103], a[68:71], v[132:135], v[100:103]
  ds_read_b128 v[124:127], v2 offset:37888
  s_waitcnt lgkmcnt(6)
  v_mfma_f32_16x16x32_bf16 v[96:99], a[64:67], v[132:135], v[96:99]
  ds_read_b64_tr_b16 a[238:239], v6 offset:36864
  v_mfma_f32_16x16x32_bf16 v[40:43], a[72:75], v[104:107], v[40:43]
  ds_read_b128 v[128:131], v2 offset:38912
  v_mfma_f32_16x16x32_bf16 v[44:47], a[76:79], v[104:107], v[44:47]
  buffer_load_dwordx4 v11, s[8:11], s67 offen offset:3072  lds
  v_mfma_f32_16x16x32_bf16 v[52:55], a[76:79], v[108:111], v[52:55]
  ds_read_b128 v[132:135], v2 offset:39936
  s_waitcnt lgkmcnt(6)
  v_mfma_f32_16x16x32_bf16 v[48:51], a[72:75], v[108:111], v[48:51]
  ds_read_b64_tr_b16 a[240:241], v5 offset:0
  v_mfma_f32_16x16x32_bf16 v[56:59], a[72:75], v[112:115], v[56:59]
  ds_read_b128 v[104:107], v3 offset:0
  s_add_u32 m0, s59, 0
  s_add_u32 s66, s61, 184320
  v_mfma_f32_16x16x32_bf16 v[60:63], a[76:79], v[112:115], v[60:63]
  buffer_load_dwordx4 v1, s[16:19], s66 offen offset:0 sc1 lds
  v_mfma_f32_16x16x32_bf16 v[68:71], a[76:79], v[116:119], v[68:71]
  ds_read_b128 v[108:111], v3 offset:1024
  s_waitcnt lgkmcnt(6)
  v_mfma_f32_16x16x32_bf16 v[64:67], a[72:75], v[116:119], v[64:67]
  ds_read_b64_tr_b16 a[242:243], v5 offset:4096
  v_mfma_f32_16x16x32_bf16 v[40:43], a[80:83], v[120:123], v[40:43]
  ds_read_b128 v[112:115], v3 offset:2048
  v_mfma_f32_16x16x32_bf16 v[44:47], a[84:87], v[120:123], v[44:47]
  buffer_load_dwordx4 v17, s[16:19], s66 offen offset:1024 sc1 lds
  v_mfma_f32_16x16x32_bf16 v[52:55], a[84:87], v[124:127], v[52:55]
  ds_read_b128 v[116:119], v3 offset:3072
  s_waitcnt lgkmcnt(6)
  v_mfma_f32_16x16x32_bf16 v[48:51], a[80:83], v[124:127], v[48:51]
  ds_read_b64_tr_b16 a[244:245], v7 offset:0
  v_mfma_f32_16x16x32_bf16 v[56:59], a[80:83], v[128:131], v[56:59]
  ds_read_b128 v[120:123], v3 offset:4096
  v_mfma_f32_16x16x32_bf16 v[60:63], a[84:87], v[128:131], v[60:63]
  buffer_load_dwordx4 v20, s[16:19], s66 offen offset:2048 sc1 lds
  v_mfma_f32_16x16x32_bf16 v[68:71], a[84:87], v[132:135], v[68:71]
  ds_read_b128 v[124:127], v3 offset:5120
  s_waitcnt lgkmcnt(6)
  v_mfma_f32_16x16x32_bf16 v[64:67], a[80:83], v[132:135], v[64:67]
  ds_read_b64_tr_b16 a[246:247], v7 offset:4096
  v_mfma_f32_16x16x32_bf16 v[40:43], a[88:91], v[104:107], v[40:43]
  ds_read_b128 v[128:131], v3 offset:6144
  v_mfma_f32_16x16x32_bf16 v[44:47], a[92:95], v[104:107], v[44:47]
  buffer_load_dwordx4 v21, s[16:19], s66 offen offset:3072 sc1 lds
  v_mfma_f32_16x16x32_bf16 v[52:55], a[92:95], v[108:111], v[52:55]
  ds_read_b128 v[132:135], v3 offset:7168
  s_waitcnt lgkmcnt(6)
  v_mfma_f32_16x16x32_bf16 v[48:51], a[88:91], v[108:111], v[48:51]
  s_waitcnt vmcnt(16)
  s_barrier
  ds_read_b64_tr_b16 a[248:249], v5 offset:8192
  v_mfma_f32_16x16x32_bf16 v[56:59], a[88:91], v[112:115], v[56:59]
  ds_read_b128 v[104:107], v3 offset:8192
  s_add_u32 m0, s58, 16384
  s_mov_b32 s67, 11927552
  v_mfma_f32_16x16x32_bf16 v[60:63], a[92:95], v[112:115], v[60:63]
  buffer_load_dwordx4 v8, s[8:11], s67 offen offset:0  lds
  v_mfma_f32_16x16x32_bf16 v[68:71], a[92:95], v[116:119], v[68:71]
  ds_read_b128 v[108:111], v3 offset:9216
  s_waitcnt lgkmcnt(6)
  v_mfma_f32_16x16x32_bf16 v[64:67], a[88:91], v[116:119], v[64:67]
  ds_read_b64_tr_b16 a[250:251], v5 offset:12288
  v_mfma_f32_16x16x32_bf16 v[40:43], a[96:99], v[120:123], v[40:43]
  ds_read_b128 v[112:115], v3 offset:10240
  v_mfma_f32_16x16x32_bf16 v[44:47], a[100:103], v[120:123], v[44:47]
  buffer_load_dwordx4 v9, s[8:11], s67 offen offset:1024  lds
  v_mfma_f32_16x16x32_bf16 v[52:55], a[100:103], v[124:127], v[52:55]
  ds_read_b128 v[116:119], v3 offset:11264
  s_waitcnt lgkmcnt(6)
  v_mfma_f32_16x16x32_bf16 v[48:51], a[96:99], v[124:127], v[48:51]
  ds_read_b64_tr_b16 a[252:253], v7 offset:8192
  v_mfma_f32_16x16x32_bf16 v[56:59], a[96:99], v[128:131], v[56:59]
  ds_read_b128 v[120:123], v3 offset:12288
  v_mfma_f32_16x16x32_bf16 v[60:63], a[100:103], v[128:131], v[60:63]
  buffer_load_dwordx4 v10, s[8:11], s67 offen offset:2048  lds
  v_mfma_f32_16x16x32_bf16 v[68:71], a[100:103], v[132:135], v[68:71]
  ds_read_b128 v[124:127], v3 offset:13312
  s_waitcnt lgkmcnt(6)
  v_mfma_f32_16x16x32_bf16 v[64:67], a[96:99], v[132:135], v[64:67]
  ds_read_b64_tr_b16 a[254:255], v7 offset:12288
  v_mfma_f32_16x16x32_bf16 v[40:43], a[104:107], v[104:107], v[40:43]
  ds_read_b128 v[128:131], v3 offset:14336
  v_mfma_f32_16x16x32_bf16 v[44:47], a[108:111], v[104:107], v[44:47]
  buffer_load_dwordx4 v11, s[8:11], s67 offen offset:3072  lds
  v_mfma_f32_16x16x32_bf16 v[52:55], a[108:111], v[108:111], v[52:55]
  ds_read_b128 v[132:135], v3 offset:15360
  s_waitcnt lgkmcnt(6)
  v_mfma_f32_16x16x32_bf16 v[48:51], a[104:107], v[108:111], v[48:51]
  ds_read_b64_tr_b16 v[136:137], v5 offset:16384
  v_mfma_f32_16x16x32_bf16 v[56:59], a[104:107], v[112:115], v[56:59]
  ds_read_b128 v[104:107], v3 offset:16384
  s_add_u32 m0, s59, 16384
  s_add_u32 s66, s61, 204800
  v_mfma_f32_16x16x32_bf16 v[60:63], a[108:111], v[112:115], v[60:63]
  buffer_load_dwordx4 v1, s[16:19], s66 offen offset:0 sc1 lds
  v_mfma_f32_16x16x32_bf16 v[68:71], a[108:111], v[116:119], v[68:71]
  ds_read_b128 v[108:111], v3 offset:17408
  s_waitcnt lgkmcnt(6)
  v_mfma_f32_16x16x32_bf16 v[64:67], a[104:107], v[116:119], v[64:67]
  ds_read_b64_tr_b16 v[138:139], v5 offset:20480
  v_mfma_f32_16x16x32_bf16 v[40:43], a[112:115], v[120:123], v[40:43]
  ds_read_b128 v[112:115], v3 offset:18432
  v_mfma_f32_16x16x32_bf16 v[44:47], a[116:119], v[120:123], v[44:47]
  buffer_load_dwordx4 v17, s[16:19], s66 offen offset:1024 sc1 lds
  v_mfma_f32_16x16x32_bf16 v[52:55], a[116:119], v[124:127], v[52:55]
  ds_read_b128 v[116:119], v3 offset:19456
  s_waitcnt lgkmcnt(6)
  v_mfma_f32_16x16x32_bf16 v[48:51], a[112:115], v[124:127], v[48:51]
  ds_read_b64_tr_b16 v[140:141], v7 offset:16384
  v_mfma_f32_16x16x32_bf16 v[56:59], a[112:115], v[128:131], v[56:59]
  ds_read_b128 v[120:123], v3 offset:20480
  v_mfma_f32_16x16x32_bf16 v[60:63], a[116:119], v[128:131], v[60:63]
  buffer_load_dwordx4 v20, s[16:19], s66 offen offset:2048 sc1 lds
  v_mfma_f32_16x16x32_bf16 v[68:71], a[116:119], v[132:135], v[68:71]
  ds_read_b128 v[124:127], v3 offset:21504
  s_waitcnt lgkmcnt(6)
  v_mfma_f32_16x16x32_bf16 v[64:67], a[112:115], v[132:135], v[64:67]
  ds_read_b64_tr_b16 v[142:143], v7 offset:20480
  v_mfma_f32_16x16x32_bf16 v[40:43], a[120:123], v[104:107], v[40:43]
  ds_read_b128 v[128:131], v3 offset:22528
  v_mfma_f32_16x16x32_bf16 v[44:47], a[124:127], v[104:107], v[44:47]
  buffer_load_dwordx4 v21, s[16:19], s66 offen offset:3072 sc1 lds
  v_mfma_f32_16x16x32_bf16 v[52:55], a[124:127], v[108:111], v[52:55]
  ds_read_b128 v[132:135], v3 offset:23552
  s_waitcnt lgkmcnt(6)
  v_mfma_f32_16x16x32_bf16 v[48:51], a[120:123], v[108:111], v[48:51]
  s_waitcnt vmcnt(16)
  s_barrier
  ds_read_b64_tr_b16 v[144:145], v5 offset:24576
  v_mfma_f32_16x16x32_bf16 v[56:59], a[120:123], v[112:115], v[56:59]
  ds_read_b128 v[104:107], v3 offset:24576
  s_add_u32 m0, s58, 32768
  s_mov_b32 s67, 12386304
  v_mfma_f32_16x16x32_bf16 v[60:63], a[124:127], v[112:115], v[60:63]
  buffer_load_dwordx4 v8, s[8:11], s67 offen offset:0  lds
  v_mfma_f32_16x16x32_bf16 v[68:71], a[124:127], v[116:119], v[68:71]
  ds_read_b128 v[108:111], v3 offset:25600
  s_waitcnt lgkmcnt(6)
  v_mfma_f32_16x16x32_bf16 v[64:67], a[120:123], v[116:119], v[64:67]
  ds_read_b64_tr_b16 v[146:147], v5 offset:28672
  v_mfma_f32_16x16x32_bf16 v[40:43], a[128:131], v[120:123], v[40:43]
  ds_read_b128 v[112:115], v3 offset:26624
  v_mfma_f32_16x16x32_bf16 v[44:47], a[132:135], v[120:123], v[44:47]
  buffer_load_dwordx4 v9, s[8:11], s67 offen offset:1024  lds
  v_mfma_f32_16x16x32_bf16 v[52:55], a[132:135], v[124:127], v[52:55]
  ds_read_b128 v[116:119], v3 offset:27648
  s_waitcnt lgkmcnt(6)
  v_mfma_f32_16x16x32_bf16 v[48:51], a[128:131], v[124:127], v[48:51]
  ds_read_b64_tr_b16 v[148:149], v7 offset:24576
  v_mfma_f32_16x16x32_bf16 v[56:59], a[128:131], v[128:131], v[56:59]
  ds_read_b128 v[120:123], v3 offset:28672
L_mark2:
  s_cbranch_execz L_mark6
  v_mfma_f32_16x16x32_bf16 v[60:63], a[132:135], v[128:131], v[60:63]
  buffer_load_dwordx4 v10, s[8:11], s67 offen offset:2048  lds
  v_mfma_f32_16x16x32_bf16 v[68:71], a[132:135], v[132:135], v[68:71]
  ds_read_b128 v[124:127], v3 offset:29696
  s_waitcnt lgkmcnt(6)
  v_mfma_f32_16x16x32_bf16 v[64:67], a[128:131], v[132:135], v[64:67]
  ds_read_b64_tr_b16 v[150:151], v7 offset:28672
  v_mfma_f32_16x16x32_bf16 v[40:43], a[136:139], v[104:107], v[40:43]
  ds_read_b128 v[128:131], v3 offset:30720
  v_mfma_f32_16x16x32_bf16 v[44:47], a[140:143], v[104:107], v[44:47]
  buffer_load_dwordx4 v11, s[8:11], s67 offen offset:3072  lds
  v_mfma_f32_16x16x32_bf16 v[52:55], a[140:143], v[108:111], v[52:55]
  ds_read_b128 v[132:135], v3 offset:31744
  s_waitcnt lgkmcnt(6)
  v_mfma_f32_16x16x32_bf16 v[48:51], a[136:139], v[108:111], v[48:51]
  ds_read_b64_tr_b16 v[152:153], v5 offset:32768
  v_mfma_f32_16x16x32_bf16 v[56:59], a[136:139], v[112:115], v[56:59]
  ds_read_b128 v[104:107], v3 offset:32768
  s_add_u32 m0, s59, 32768
  s_add_u32 s66, s61, 225280
  v_mfma_f32_16x16x32_bf16 v[60:63], a[140:143], v[112:115], v[60:63]
  buffer_load_dwordx4 v1, s[16:19], s66 offen offset:0 sc1 lds
  v_mfma_f32_16x16x32_bf16 v[68:71], a[140:143], v[116:119], v[68:71]
  ds_read_b128 v[108:111], v3 offset:33792
  s_waitcnt lgkmcnt(6)
  v_mfma_f32_16x16x32_bf16 v[64:67], a[136:139], v[116:119], v[64:67]
  ds_read_b64_tr_b16 v[154:155], v5 offset:36864
  v_mfma_f32_16x16x32_bf16 v[40:43], a[144:147], v[120:123], v[40:43]
  ds_read_b128 v[112:115], v3 offset:34816
  v_mfma_f32_16x16x32_bf16 v[44:47], a[148:151], v[120:123], v[44:47]
  buffer_load_dwordx4 v17, s[16:19], s66 offen offset:1024 sc1 lds
  v_mfma_f32_16x16x32_bf16 v[52:55], a[148:151], v[124:127], v[52:55]
  ds_read_b128 v[116:119], v3 offset:35840
  s_waitcnt lgkmcnt(6)
  v_mfma_f32_16x16x32_bf16 v[48:51], a[144:147], v[124:127], v[48:51]
  ds_read_b64_tr_b16 v[156:157], v7 offset:32768
  v_mfma_f32_16x16x32_bf16 v[56:59], a[144:147], v[128:131], v[56:59]
  ds_read_b128 v[120:123], v3 offset:36864
  v_mfma_f32_16x16x32_bf16 v[60:63], a[148:151], v[128:131], v[60:63]
  buffer_load_dwordx4 v20, s[16:19], s66 offen offset:2048 sc1 lds
  v_mfma_f32_16x16x32_bf16 v[68:71], a[148:151], v[132:135], v[68:71]
  ds_read_b128 v[124:127], v3 offset:37888
  s_waitcnt lgkmcnt(6)
  v_mfma_f32_16x16x32_bf16 v[64:67], a[144:147], v[132:135], v[64:67]
  ds_read_b64_tr_b16 v[158:159], v7 offset:36864
  v_mfma_f32_16x16x32_bf16 v[40:43], a[152:155], v[104:107], v[40:43]
  ds_read_b128 v[128:131], v3 offset:38912
  v_mfma_f32_16x16x32_bf16 v[44:47], a[156:159], v[104:107], v[44:47]
  buffer_load_dwordx4 v21, s[16:19], s66 offen offset:3072 sc1 lds
  v_mfma_f32_16x16x32_bf16 v[52:55], a[156:159], v[108:111], v[52:55]
  ds_read_b128 v[132:135], v3 offset:39936
  s_waitcnt lgkmcnt(6)
  v_mfma_f32_16x16x32_bf16 v[48:51], a[152:155], v[108:111], v[48:51]
  s_waitcnt vmcnt(16)
  s_barrier
  ds_read_b64_tr_b16 v[160:161], v4 offset:0
  v_mfma_f32_16x16x32_bf16 v[56:59], a[152:155], v[112:115], v[56:59]
  ds_read_b128 v[104:107], v2 offset:0
  s_add_u32 m0, s58, 49152
  s_mov_b32 s67, 12845056
  v_mfma_f32_16x16x32_bf16 v[60:63], a[156:159], v[112:115], v[60:63]
  buffer_load_dwordx4 v8, s[8:11], s67 offen offset:0  lds
  v_mfma_f32_16x16x32_bf16 v[68:71], a[156:159], v[116:119], v[68:71]
  ds_read_b128 v[108:111], v2 offset:1024
  s_waitcnt lgkmcnt(6)
  v_mfma_f32_16x16x32_bf16 v[64:67], a[152:155], v[116:119], v[64:67]
  ds_read_b64_tr_b16 v[162:163], v4 offset:4096
  v_mfma_f32_16x16x32_bf16 v[40:43], a[160:163], v[120:123], v[40:43]
  ds_read_b128 v[112:115], v2 offset:2048
  v_mfma_f32_16x16x32_bf16 v[44:47], a[164:167], v[120:123], v[44:47]
  buffer_load_dwordx4 v9, s[8:11], s67 offen offset:1024  lds
  v_mfma_f32_16x16x32_bf16 v[52:55], a[164:167], v[124:127], v[52:55]
  ds_read_b128 v[116:119], v2 offset:3072
  s_waitcnt lgkmcnt(6)
  v_mfma_f32_16x16x32_bf16 v[48:51], a[160:163], v[124:127], v[48:51]
  ds_read_b64_tr_b16 v[164:165], v6 offset:0
  v_mfma_f32_16x16x32_bf16 v[56:59], a[160:163], v[128:131], v[56:59]
  ds_read_b128 v[120:123], v2 offset:4096
  v_mfma_f32_16x16x32_bf16 v[60:63], a[164:167], v[128:131], v[60:63]
  buffer_load_dwordx4 v10, s[8:11], s67 offen offset:2048  lds
  v_mfma_f32_16x16x32_bf16 v[68:71], a[164:167], v[132:135], v[68:71]
  ds_read_b128 v[124:127], v2 offset:5120
  s_waitcnt lgkmcnt(6)
  v_mfma_f32_16x16x32_bf16 v[64:67], a[160:163], v[132:135], v[64:67]
  ds_read_b64_tr_b16 v[166:167], v6 offset:4096
  v_mfma_f32_16x16x32_bf16 v[40:43], a[168:171], v[104:107], v[40:43]
  ds_read_b128 v[128:131], v2 offset:6144
  v_mfma_f32_16x16x32_bf16 v[44:47], a[172:175], v[104:107], v[44:47]
  buffer_load_dwordx4 v11, s[8:11], s67 offen offset:3072  lds
  v_mfma_f32_16x16x32_bf16 v[52:55], a[172:175], v[108:111], v[52:55]
  ds_read_b128 v[132:135], v2 offset:7168
  s_waitcnt lgkmcnt(6)
  v_mfma_f32_16x16x32_bf16 v[48:51], a[168:171], v[108:111], v[48:51]
  ds_read_b64_tr_b16 v[168:169], v4 offset:8192
  v_mfma_f32_16x16x32_bf16 v[56:59], a[168:171], v[112:115], v[56:59]
  ds_read_b128 v[104:107], v2 offset:8192
  s_add_u32 m0, s59, 49152
  s_add_u32 s66, s61, 245760
  v_mfma_f32_16x16x32_bf16 v[60:63], a[172:175], v[112:115], v[60:63]
  buffer_load_dwordx4 v1, s[16:19], s66 offen offset:0 sc1 lds
  v_mfma_f32_16x16x32_bf16 v[68:71], a[172:175], v[116:119], v[68:71]
  ds_read_b128 v[108:111], v2 offset:9216
  s_waitcnt lgkmcnt(6)
  v_mfma_f32_16x16x32_bf16 v[64:67], a[168:171], v[116:119], v[64:67]
  ds_read_b64_tr_b16 v[170:171], v4 offset:12288
  v_mfma_f32_16x16x32_bf16 v[40:43], a[176:179], v[120:123], v[40:43]
  ds_read_b128 v[112:115], v2 offset:10240
  v_mfma_f32_16x16x32_bf16 v[44:47], a[180:183], v[120:123], v[44:47]
  buffer_load_dwordx4 v17, s[16:19], s66 offen offset:1024 sc1 lds
  v_mfma_f32_16x16x32_bf16 v[52:55], a[180:183], v[124:127], v[52:55]
  ds_read_b128 v[116:119], v2 offset:11264
  s_waitcnt lgkmcnt(6)
  v_mfma_f32_16x16x32_bf16 v[48:51], a[176:179], v[124:127], v[48:51]
  ds_read_b64_tr_b16 v[172:173], v6 offset:8192
  v_mfma_f32_16x16x32_bf16 v[56:59], a[176:179], v[128:131], v[56:59]
  ds_read_b128 v[120:123], v2 offset:12288
  v_mfma_f32_16x16x32_bf16 v[60:63], a[180:183], v[128:131], v[60:63]
  buffer_load_dwordx4 v20, s[16:19], s66 offen offset:2048 sc1 lds
  v_mfma_f32_16x16x32_bf16 v[68:71], a[180:183], v[132:135], v[68:71]
  ds_read_b128 v[124:127], v2 offset:13312
  s_waitcnt lgkmcnt(6)
  v_mfma_f32_16x16x32_bf16 v[64:67], a[176:179], v[132:135], v[64:67]
  ds_read_b64_tr_b16 v[174:175], v6 offset:12288
  v_mfma_f32_16x16x32_bf16 v[40:43], a[184:187], v[104:107], v[40:43]
  ds_read_b128 v[128:131], v2 offset:14336
  v_mfma_f32_16x16x32_bf16 v[44:47], a[188:191], v[104:107], v[44:47]
  buffer_load_dwordx4 v21, s[16:19], s66 offen offset:3072 sc1 lds
  v_mfma_f32_16x16x32_bf16 v[52:55], a[188:191], v[108:111], v[52:55]
  ds_read_b128 v[132:135], v2 offset:15360
  s_waitcnt lgkmcnt(6)
  v_mfma_f32_16x16x32_bf16 v[48:51], a[184:187], v[108:111], v[48:51]
  s_waitcnt vmcnt(16)
  s_barrier
  ds_read_b64_tr_b16 v[176:177], v4 offset:16384
  v_mfma_f32_16x16x32_bf16 v[56:59], a[184:187], v[112:115], v[56:59]
  ds_read_b128 v[104:107], v2 offset:16384
  s_add_u32 m0, s58, 65536
  s_mov_b32 s67, 13303808
  v_mfma_f32_16x16x32_bf16 v[60:63], a[188:191], v[112:115], v[60:63]
  buffer_load_dwordx4 v8, s[8:11], s67 offen offset:0  lds
  v_mfma_f32_16x16x32_bf16 v[68:71], a[188:191], v[116:119], v[68:71]
  ds_read_b128 v[108:111], v2 offset:17408
  s_waitcnt lgkmcnt(6)
  v_mfma_f32_16x16x32_bf16 v[64:67], a[184:187], v[116:119], v[64:67]
  ds_read_b64_tr_b16 v[178:179], v4 offset:20480
  v_mfma_f32_16x16x32_bf16 v[40:43], a[192:195], v[120:123], v[40:43]
  ds_read_b128 v[112:115], v2 offset:18432
  v_mfma_f32_16x16x32_bf16 v[44:47], a[196:199], v[120:123], v[44:47]
  buffer_load_dwordx4 v9, s[8:11], s67 offen offset:1024  lds
  v_mfma_f32_16x16x32_bf16 v[52:55], a[196:199], v[124:127], v[52:55]
  ds_read_b128 v[116:119], v2 offset:19456
  s_waitcnt lgkmcnt(6)
  v_mfma_f32_16x16x32_bf16 v[48:51], a[192:195], v[124:127], v[48:51]
  ds_read_b64_tr_b16 v[180:181], v6 offset:16384
  v_mfma_f32_16x16x32_bf16 v[56:59], a[192:195], v[128:131], v[56:59]
  ds_read_b128 v[120:123], v2 offset:20480
  v_mfma_f32_16x16x32_bf16 v[60:63], a[196:199], v[128:131], v[60:63]
  buffer_load_dwordx4 v10, s[8:11], s67 offen offset:2048  lds
  v_mfma_f32_16x16x32_bf16 v[68:71], a[196:199], v[132:135], v[68:71]
  ds_read_b128 v[124:127], v2 offset:21504
  s_waitcnt lgkmcnt(6)
  v_mfma_f32_16x16x32_bf16 v[64:67], a[192:195], v[132:135], v[64:67]
  ds_read_b64_tr_b16 v[182:183], v6 offset:20480
  v_mfma_f32_16x16x32_bf16 v[40:43], a[200:203], v[104:107], v[40:43]
  ds_read_b128 v[128:131], v2 offset:22528
  v_mfma_f32_16x16x32_bf16 v[44:47], a[204:207], v[104:107], v[44:47]
  buffer_load_dwordx4 v11, s[8:11], s67 offen offset:3072  lds
  v_mfma_f32_16x16x32_bf16 v[52:55], a[204:207], v[108:111], v[52:55]
  ds_read_b128 v[132:135], v2 offset:23552
  s_waitcnt lgkmcnt(6)
  v_mfma_f32_16x16x32_bf16 v[48:51], a[200:203], v[108:111], v[48:51]
  ds_read_b64_tr_b16 v[184:185], v4 offset:24576
  v_mfma_f32_16x16x32_bf16 v[56:59], a[200:203], v[112:115], v[56:59]
  ds_read_b128 v[104:107], v2 offset:24576
  s_add_u32 m0, s59, 65536
  s_add_u32 s66, s61, 266240
  v_mfma_f32_16x16x32_bf16 v[60:63], a[204:207], v[112:115], v[60:63]
  buffer_load_dwordx4 v1, s[16:19], s66 offen offset:0 sc1 lds
  v_mfma_f32_16x16x32_bf16 v[68:71], a[204:207], v[116:119], v[68:71]
  ds_read_b128 v[108:111], v2 offset:25600
  s_waitcnt lgkmcnt(6)
  v_mfma_f32_16x16x32_bf16 v[64:67], a[200:203], v[116:119], v[64:67]
  ds_read_b64_tr_b16 v[186:187], v4 offset:28672
  v_mfma_f32_16x16x32_bf16 v[40:43], a[208:211], v[120:123], v[40:43]
  ds_read_b128 v[112:115], v2 offset:26624
  v_mfma_f32_16x16x32_bf16 v[44:47], a[212:215], v[120:123], v[44:47]
  buffer_load_dwordx4 v17, s[16:19], s66 offen offset:1024 sc1 lds
  v_mfma_f32_16x16x32_bf16 v[52:55], a[212:215], v[124:127], v[52:55]
  ds_read_b128 v[116:119], v2 offset:27648
  s_waitcnt lgkmcnt(6)
  v_mfma_f32_16x16x32_bf16 v[48:51], a[208:211], v[124:127], v[48:51]
  ds_read_b64_tr_b16 v[188:189], v6 offset:24576
  v_mfma_f32_16x16x32_bf16 v[56:59], a[208:211], v[128:131], v[56:59]
  ds_read_b128 v[120:123], v2 offset:28672
  v_mfma_f32_16x16x32_bf16 v[60:63], a[212:215], v[128:131], v[60:63]
  buffer_load_dwordx4 v20, s[16:19], s66 offen offset:2048 sc1 lds
  v_mfma_f32_16x16x32_bf16 v[68:71], a[212:215], v[132:135], v[68:71]
  ds_read_b128 v[124:127], v2 offset:29696
  s_waitcnt lgkmcnt(6)
  v_mfma_f32_16x16x32_bf16 v[64:67], a[208:211], v[132:135], v[64:67]
  ds_read_b64_tr_b16 v[190:191], v6 offset:28672
  v_mfma_f32_16x16x32_bf16 v[40:43], a[216:219], v[104:107], v[40:43]
  ds_read_b128 v[128:131], v2 offset:30720
  v_mfma_f32_16x16x32_bf16 v[44:47], a[220:223], v[104:107], v[44:47]
  buffer_load_dwordx4 v21, s[16:19], s66 offen offset:3072 sc1 lds
  v_mfma_f32_16x16x32_bf16 v[52:55], a[220:223], v[108:111], v[52:55]
  ds_read_b128 v[132:135], v2 offset:31744
  s_waitcnt lgkmcnt(6)
  v_mfma_f32_16x16x32_bf16 v[48:51], a[216:219], v[108:111], v[48:51]
  s_waitcnt vmcnt(16)
  s_barrier
  ds_read_b64_tr_b16 v[192:193], v4 offset:32768
  v_mfma_f32_16x16x32_bf16 v[56:59], a[216:219], v[112:115], v[56:59]
  ds_read_b128 v[104:107], v2 offset:32768
  s_add_u32 m0, s58, 0
  s_mov_b32 s67, 13762560
  v_mfma_f32_16x16x32_bf16 v[60:63], a[220:223], v[112:115], v[60:63]
  buffer_load_dwordx4 v8, s[8:11], s67 offen offset:0  lds
  v_mfma_f32_16x16x32_bf16 v[68:71], a[220:223], v[116:119], v[68:71]
  ds_read_b128 v[108:111], v2 offset:33792
  s_waitcnt lgkmcnt(6)
  v_mfma_f32_16x16x32_bf16 v[64:67], a[216:219], v[116:119], v[64:67]
  ds_read_b64_tr_b16 v[194:195], v4 offset:36864
  v_mfma_f32_16x16x32_bf16 v[40:43], a[224:227], v[120:123], v[40:43]
  ds_read_b128 v[112:115], v2 offset:34816
  v_mfma_f32_16x16x32_bf16 v[44:47], a[228:231], v[120:123], v[44:47]
  buffer_load_dwordx4 v9, s[8:11], s67 offen offset:1024  lds
  v_mfma_f32_16x16x32_bf16 v[52:55], a[228:231], v[124:127], v[52:55]
  ds_read_b128 v[116:119], v2 offset:35840
  s_waitcnt lgkmcnt(6)
  v_mfma_f32_16x16x32_bf16 v[48:51], a[224:227], v[124:127], v[48:51]
  ds_read_b64_tr_b16 v[196:197], v6 offset:32768
  v_mfma_f32_16x16x32_bf16 v[56:59], a[224:227], v[128:131], v[56:59]
  ds_read_b128 v[120:123], v2 offset:36864
  v_mfma_f32_16x16x32_bf16 v[60:63], a[228:231], v[128:131], v[60:63]
  buffer_load_dwordx4 v10, s[8:11], s67 offen offset:2048  lds
  v_mfma_f32_16x16x32_bf16 v[68:71], a[228:231], v[132:135], v[68:71]
  ds_read_b128 v[124:127], v2 offset:37888
  s_waitcnt lgkmcnt(6)
  v_mfma_f32_16x16x32_bf16 v[64:67], a[224:227], v[132:135], v[64:67]
  ds_read_b64_tr_b16 v[198:199], v6 offset:36864
  v_mfma_f32_16x16x32_bf16 v[40:43], a[232:235], v[104:107], v[40:43]
  ds_read_b128 v[128:131], v2 offset:38912
  v_mfma_f32_16x16x32_bf16 v[44:47], a[236:239], v[104:107], v[44:47]
  buffer_load_dwordx4 v11, s[8:11], s67 offen offset:3072  lds
  v_mfma_f32_16x16x32_bf16 v[52:55], a[236:239], v[108:111], v[52:55]
  ds_read_b128 v[132:135], v2 offset:39936
  s_waitcnt lgkmcnt(6)
  v_mfma_f32_16x16x32_bf16 v[48:51], a[232:235], v[108:111], v[48:51]
  ds_read_b64_tr_b16 v[200:201], v5 offset:0
  v_mfma_f32_16x16x32_bf16 v[56:59], a[232:235], v[112:115], v[56:59]
  ds_read_b128 v[104:107], v3 offset:0
  s_add_u32 m0, s59, 0
  s_add_u32 s66, s61, 286720
  v_mfma_f32_16x16x32_bf16 v[60:63], a[236:239], v[112:115], v[60:63]
  buffer_load_dwordx4 v1, s[16:19], s66 offen offset:0 sc1 lds
  v_mfma_f32_16x16x32_bf16 v[68:71], a[236:239], v[116:119], v[68:71]
  ds_read_b128 v[108:111], v3 offset:1024
  s_waitcnt lgkmcnt(6)
  v_mfma_f32_16x16x32_bf16 v[64:67], a[232:235], v[116:119], v[64:67]
  ds_read_b64_tr_b16 v[202:203], v5 offset:4096
  v_mfma_f32_16x16x32_bf16 v[40:43], a[240:243], v[120:123], v[40:43]
  ds_read_b128 v[112:115], v3 offset:2048
  v_mfma_f32_16x16x32_bf16 v[44:47], a[244:247], v[120:123], v[44:47]
  buffer_load_dwordx4 v17, s[16:19], s66 offen offset:1024 sc1 lds
  v_mfma_f32_16x16x32_bf16 v[52:55], a[244:247], v[124:127], v[52:55]
  ds_read_b128 v[116:119], v3 offset:3072
  s_waitcnt lgkmcnt(6)
  v_mfma_f32_16x16x32_bf16 v[48:51], a[240:243], v[124:127], v[48:51]
  ds_read_b64_tr_b16 v[204:205], v7 offset:0
  v_mfma_f32_16x16x32_bf16 v[56:59], a[240:243], v[128:131], v[56:59]
  ds_read_b128 v[120:123], v3 offset:4096
  v_mfma_f32_16x16x32_bf16 v[60:63], a[244:247], v[128:131], v[60:63]
  buffer_load_dwordx4 v20, s[16:19], s66 offen offset:2048 sc1 lds
  v_mfma_f32_16x16x32_bf16 v[68:71], a[244:247], v[132:135], v[68:71]
  ds_read_b128 v[124:127], v3 offset:5120
  s_waitcnt lgkmcnt(6)
  v_mfma_f32_16x16x32_bf16 v[64:67], a[240:243], v[132:135], v[64:67]
  ds_read_b64_tr_b16 v[206:207], v7 offset:4096
  v_mfma_f32_16x16x32_bf16 v[40:43], a[248:251], v[104:107], v[40:43]
  ds_read_b128 v[128:131], v3 offset:6144
  v_mfma_f32_16x16x32_bf16 v[44:47], a[252:255], v[104:107], v[44:47]
  buffer_load_dwordx4 v21, s[16:19], s66 offen offset:3072 sc1 lds
  v_mfma_f32_16x16x32_bf16 v[52:55], a[252:255], v[108:111], v[52:55]
  ds_read_b128 v[132:135], v3 offset:7168
  s_waitcnt lgkmcnt(6)
  v_mfma_f32_16x16x32_bf16 v[48:51], a[248:251], v[108:111], v[48:51]
  s_waitcnt vmcnt(16)
  s_barrier
  ds_read_b64_tr_b16 v[208:209], v5 offset:8192
  v_mfma_f32_16x16x32_bf16 v[56:59], a[248:251], v[112:115], v[56:59]
  ds_read_b128 v[104:107], v3 offset:8192
  s_add_u32 m0, s58, 16384
  s_mov_b32 s67, 14221312
  v_mfma_f32_16x16x32_bf16 v[60:63], a[252:255], v[112:115], v[60:63]
  buffer_load_dwordx4 v8, s[8:11], s67 offen offset:0  lds
  v_mfma_f32_16x16x32_bf16 v[68:71], a[252:255], v[116:119], v[68:71]
  ds_read_b128 v[108:111], v3 offset:9216
  s_waitcnt lgkmcnt(6)
  v_mfma_f32_16x16x32_bf16 v[64:67], a[248:251], v[116:119], v[64:67]
  ds_read_b64_tr_b16 v[210:211], v5 offset:12288
  v_mfma_f32_16x16x32_bf16 v[40:43], v[136:139], v[120:123], v[40:43]
  ds_read_b128 v[112:115], v3 offset:10240
  v_mfma_f32_16x16x32_bf16 v[44:47], v[140:143], v[120:123], v[44:47]
  buffer_load_dwordx4 v9, s[8:11], s67 offen offset:1024  lds
  v_mfma_f32_16x16x32_bf16 v[52:55], v[140:143], v[124:127], v[52:55]
  ds_read_b128 v[116:119], v3 offset:11264
  s_waitcnt lgkmcnt(6)
  v_mfma_f32_16x16x32_bf16 v[48:51], v[136:139], v[124:127], v[48:51]
  ds_read_b64_tr_b16 v[212:213], v7 offset:8192
  v_mfma_f32_16x16x32_bf16 v[56:59], v[136:139], v[128:131], v[56:59]
  ds_read_b128 v[120:123], v3 offset:12288
  v_mfma_f32_16x16x32_bf16 v[60:63], v[140:143], v[128:131], v[60:63]
  buffer_load_dwordx4 v10, s[8:11], s67 offen offset:2048  lds
  v_mfma_f32_16x16x32_bf16 v[68:71], v[140:143], v[132:135], v[68:71]
  ds_read_b128 v[124:127], v3 offset:13312
  s_waitcnt lgkmcnt(6)
  v_mfma_f32_16x16x32_bf16 v[64:67], v[136:139], v[132:135], v[64:67]
  ds_read_b64_tr_b16 v[214:215], v7 offset:12288
  v_mfma_f32_16x16x32_bf16 v[40:43], v[144:147], v[104:107], v[40:43]
  ds_read_b128 v[128:131], v3 offset:14336
  v_mfma_f32_16x16x32_bf16 v[44:47], v[148:151], v[104:107], v[44:47]
  buffer_load_dwordx4 v11, s[8:11], s67 offen offset:3072  lds
  v_mfma_f32_16x16x32_bf16 v[52:55], v[148:151], v[108:111], v[52:55]
  ds_read_b128 v[132:135], v3 offset:15360
  s_waitcnt lgkmcnt(6)
  v_mfma_f32_16x16x32_bf16 v[48:51], v[144:147], v[108:111], v[48:51]
  ds_read_b64_tr_b16 v[216:217], v5 offset:16384
  v_mfma_f32_16x16x32_bf16 v[56:59], v[144:147], v[112:115], v[56:59]
  ds_read_b128 v[104:107], v3 offset:16384
  s_add_u32 m0, s59, 16384
  s_add_u32 s66, s61, 307200
  v_mfma_f32_16x16x32_bf16 v[60:63], v[148:151], v[112:115], v[60:63]
  buffer_load_dwordx4 v1, s[16:19], s66 offen offset:0 sc1 lds
  v_mfma_f32_16x16x32_bf16 v[68:71], v[148:151], v[116:119], v[68:71]
  ds_read_b128 v[108:111], v3 offset:17408
  s_waitcnt lgkmcnt(6)
  v_mfma_f32_16x16x32_bf16 v[64:67], v[144:147], v[116:119], v[64:67]
  ds_read_b64_tr_b16 v[218:219], v5 offset:20480
  v_mfma_f32_16x16x32_bf16 v[40:43], v[152:155], v[120:123], v[40:43]
  ds_read_b128 v[112:115], v3 offset:18432
  v_mfma_f32_16x16x32_bf16 v[44:47], v[156:159], v[120:123], v[44:47]
  buffer_load_dwordx4 v17, s[16:19], s66 offen offset:1024 sc1 lds
  v_mfma_f32_16x16x32_bf16 v[52:55], v[156:159], v[124:127], v[52:55]
  ds_read_b128 v[116:119], v3 offset:19456
  s_waitcnt lgkmcnt(6)
  v_mfma_f32_16x16x32_bf16 v[48:51], v[152:155], v[124:127], v[48:51]
  ds_read_b64_tr_b16 v[220:221], v7 offset:16384
  v_mfma_f32_16x16x32_bf16 v[56:59], v[152:155], v[128:131], v[56:59]
  ds_read_b128 v[120:123], v3 offset:20480
  v_mfma_f32_16x16x32_bf16 v[60:63], v[156:159], v[128:131], v[60:63]
  buffer_load_dwordx4 v20, s[16:19], s66 offen offset:2048 sc1 lds
  v_mfma_f32_16x16x32_bf16 v[68:71], v[156:159], v[132:135], v[68:71]
  ds_read_b128 v[124:127], v3 offset:21504
  s_waitcnt lgkmcnt(6)
  v_mfma_f32_16x16x32_bf16 v[64:67], v[152:155], v[132:135], v[64:67]
  ds_read_b64_tr_b16 v[222:223], v7 offset:20480
  v_mfma_f32_16x16x32_bf16 v[40:43], v[160:163], v[104:107], v[40:43]
  ds_read_b128 v[128:131], v3 offset:22528
  v_mfma_f32_16x16x32_bf16 v[44:47], v[164:167], v[104:107], v[44:47]
  buffer_load_dwordx4 v21, s[16:19], s66 offen offset:3072 sc1 lds
  v_mfma_f32_16x16x32_bf16 v[52:55], v[164:167], v[108:111], v[52:55]
  ds_read_b128 v[132:135], v3 offset:23552
  s_waitcnt lgkmcnt(6)
  v_mfma_f32_16x16x32_bf16 v[48:51], v[160:163], v[108:111], v[48:51]
  s_waitcnt vmcnt(12)
  s_barrier
  ds_read_b64_tr_b16 v[224:225], v5 offset:24576
  v_mfma_f32_16x16x32_bf16 v[56:59], v[160:163], v[112:115], v[56:59]
  ds_read_b128 v[104:107], v3 offset:24576
  s_add_u32 m0, s58, 32768
  s_mov_b32 s67, 0
  v_mfma_f32_16x16x32_bf16 v[60:63], v[164:167], v[112:115], v[60:63]
  buffer_load_dwordx4 v12, s[12:15], s67 offen offset:0  lds
  v_mfma_f32_16x16x32_bf16 v[68:71], v[164:167], v[116:119], v[68:71]
  ds_read_b128 v[108:111], v3 offset:25600
  s_waitcnt lgkmcnt(6)
  v_mfma_f32_16x16x32_bf16 v[64:67], v[160:163], v[116:119], v[64:67]
  ds_read_b64_tr_b16 v[226:227], v5 offset:28672
  v_mfma_f32_16x16x32_bf16 v[40:43], v[168:171], v[120:123], v[40:43]
  ds_read_b128 v[112:115], v3 offset:26624
  v_mfma_f32_16x16x32_bf16 v[44:47], v[172:175], v[120:123], v[44:47]
  buffer_load_dwordx4 v13, s[12:15], s67 offen offset:1024  lds
  v_mfma_f32_16x16x32_bf16 v[52:55], v[172:175], v[124:127], v[52:55]
  ds_read_b128 v[116:119], v3 offset:27648
  s_waitcnt lgkmcnt(6)
  v_mfma_f32_16x16x32_bf16 v[48:51], v[168:171], v[124:127], v[48:51]
  ds_read_b64_tr_b16 v[228:229], v7 offset:24576
  v_mfma_f32_16x16x32_bf16 v[56:59], v[168:171], v[128:131], v[56:59]
  ds_read_b128 v[120:123], v3 offset:28672
  v_mfma_f32_16x16x32_bf16 v[60:63], v[172:175], v[128:131], v[60:63]
  buffer_load_dwordx4 v14, s[12:15], s67 offen offset:2048  lds
  v_mfma_f32_16x16x32_bf16 v[68:71], v[172:175], v[132:135], v[68:71]
  ds_read_b128 v[124:127], v3 offset:29696
  s_waitcnt lgkmcnt(6)
  v_mfma_f32_16x16x32_bf16 v[64:67], v[168:171], v[132:135], v[64:67]
  ds_read_b64_tr_b16 v[230:231], v7 offset:28672
  v_mfma_f32_16x16x32_bf16 v[40:43], v[176:179], v[104:107], v[40:43]
  ds_read_b128 v[128:131], v3 offset:30720
  v_mfma_f32_16x16x32_bf16 v[44:47], v[180:183], v[104:107], v[44:47]
  buffer_load_dwordx4 v15, s[12:15], s67 offen offset:3072  lds
  v_mfma_f32_16x16x32_bf16 v[52:55], v[180:183], v[108:111], v[52:55]
  ds_read_b128 v[132:135], v3 offset:31744
  s_waitcnt lgkmcnt(6)
  v_mfma_f32_16x16x32_bf16 v[48:51], v[176:179], v[108:111], v[48:51]
  ds_read_b64_tr_b16 v[232:233], v5 offset:32768
  v_mfma_f32_16x16x32_bf16 v[56:59], v[176:179], v[112:115], v[56:59]
  ds_read_b128 v[104:107], v3 offset:32768
  s_add_u32 m0, s59, 32768
  s_add_u32 s66, s62, 122880
  v_mfma_f32_16x16x32_bf16 v[60:63], v[180:183], v[112:115], v[60:63]
  buffer_load_dwordx4 v1, s[16:19], s66 offen offset:0 sc1 lds
  v_mfma_f32_16x16x32_bf16 v[68:71], v[180:183], v[116:119], v[68:71]
  ds_read_b128 v[108:111], v3 offset:33792
  s_waitcnt lgkmcnt(6)
  v_mfma_f32_16x16x32_bf16 v[64:67], v[176:179], v[116:119], v[64:67]
  ds_read_b64_tr_b16 v[234:235], v5 offset:36864
  v_mfma_f32_16x16x32_bf16 v[40:43], v[184:187], v[120:123], v[40:43]
  ds_read_b128 v[112:115], v3 offset:34816
  v_mfma_f32_16x16x32_bf16 v[44:47], v[188:191], v[120:123], v[44:47]
  buffer_load_dwordx4 v17, s[16:19], s66 offen offset:1024 sc1 lds
  v_mfma_f32_16x16x32_bf16 v[52:55], v[188:191], v[124:127], v[52:55]
  ds_read_b128 v[116:119], v3 offset:35840
  s_waitcnt lgkmcnt(6)
  v_mfma_f32_16x16x32_bf16 v[48:51], v[184:187], v[124:127], v[48:51]
  ds_read_b64_tr_b16 v[236:237], v7 offset:32768
  v_mfma_f32_16x16x32_bf16 v[56:59], v[184:187], v[128:131], v[56:59]
  ds_read_b128 v[120:123], v3 offset:36864
  v_mfma_f32_16x16x32_bf16 v[60:63], v[188:191], v[128:131], v[60:63]
  buffer_load_dwordx4 v20, s[16:19], s66 offen offset:2048 sc1 lds
  v_mfma_f32_16x16x32_bf16 v[68:71], v[188:191], v[132:135], v[68:71]
  ds_read_b128 v[124:127], v3 offset:37888
  s_waitcnt lgkmcnt(6)
  v_mfma_f32_16x16x32_bf16 v[64:67], v[184:187], v[132:135], v[64:67]
  ds_read_b64_tr_b16 v[238:239], v7 offset:36864
  v_mfma_f32_16x16x32_bf16 v[40:43], v[192:195], v[104:107], v[40:43]
  ds_read_b128 v[128:131], v3 offset:38912
  ds_read_b64_tr_b16 v[240:241], v4 offset:0
  v_mfma_f32_16x16x32_bf16 v[44:47], v[196:199], v[104:107], v[44:47]
  ds_read_b64_tr_b16 v[242:243], v4 offset:4096
  buffer_load_dwordx4 v21, s[16:19], s66 offen offset:3072 sc1 lds
  v_mfma_f32_16x16x32_bf16 v[52:55], v[196:199], v[108:111], v[52:55]
  ds_read_b128 v[132:135], v3 offset:39936
  ds_read_b64_tr_b16 v[244:245], v6 offset:0
  ds_read_b64_tr_b16 v[246:247], v6 offset:4096
  s_waitcnt lgkmcnt(10)
  v_mfma_f32_16x16x32_bf16 v[48:51], v[192:195], v[108:111], v[48:51]
  s_waitcnt vmcnt(12)
  s_barrier
  ds_read_b64_tr_b16 v[248:249], v4 offset:8192
  v_mfma_f32_16x16x32_bf16 v[56:59], v[192:195], v[112:115], v[56:59]
  ds_read_b128 v[104:107], v2 offset:0
  s_add_u32 m0, s58, 49152
  s_mov_b32 s67, 262144
  v_mfma_f32_16x16x32_bf16 v[60:63], v[196:199], v[112:115], v[60:63]
  buffer_load_dwordx4 v12, s[12:15], s67 offen offset:0  lds
  v_mfma_f32_16x16x32_bf16 v[68:71], v[196:199], v[116:119], v[68:71]
  ds_read_b128 v[108:111], v2 offset:1024
  s_waitcnt lgkmcnt(10)
  v_mfma_f32_16x16x32_bf16 v[64:67], v[192:195], v[116:119], v[64:67]
  ds_read_b64_tr_b16 v[250:251], v4 offset:12288
  v_mfma_f32_16x16x32_bf16 v[40:43], v[200:203], v[120:123], v[40:43]
  ds_read_b128 v[112:115], v2 offset:2048
  v_mfma_f32_16x16x32_bf16 v[44:47], v[204:207], v[120:123], v[44:47]
  buffer_load_dwordx4 v13, s[12:15], s67 offen offset:1024  lds
  v_mfma_f32_16x16x32_bf16 v[52:55], v[204:207], v[124:127], v[52:55]
  ds_read_b128 v[116:119], v2 offset:3072
  s_waitcnt lgkmcnt(6)
  v_mfma_f32_16x16x32_bf16 v[48:51], v[200:203], v[124:127], v[48:51]
  ds_read_b64_tr_b16 v[252:253], v6 offset:8192
  v_mfma_f32_16x16x32_bf16 v[56:59], v[200:203], v[128:131], v[56:59]
  ds_read_b128 v[120:123], v2 offset:4096
  v_mfma_f32_16x16x32_bf16 v[60:63], v[204:207], v[128:131], v[60:63]
  buffer_load_dwordx4 v14, s[12:15], s67 offen offset:2048  lds
  v_mfma_f32_16x16x32_bf16 v[68:71], v[204:207], v[132:135], v[68:71]
  ds_read_b128 v[124:127], v2 offset:5120
  s_waitcnt lgkmcnt(6)
  v_mfma_f32_16x16x32_bf16 v[64:67], v[200:203], v[132:135], v[64:67]
  ds_read_b64_tr_b16 v[254:255], v6 offset:12288
  v_mfma_f32_16x16x32_bf16 v[40:43], v[208:211], v[104:107], v[40:43]
  ds_read_b128 v[128:131], v2 offset:6144
  v_mfma_f32_16x16x32_bf16 v[44:47], v[212:215], v[104:107], v[44:47]
  buffer_load_dwordx4 v15, s[12:15], s67 offen offset:3072  lds
  v_mfma_f32_16x16x32_bf16 v[52:55], v[212:215], v[108:111], v[52:55]
  ds_read_b128 v[132:135], v2 offset:7168
  s_waitcnt lgkmcnt(6)
  v_mfma_f32_16x16x32_bf16 v[48:51], v[208:211], v[108:111], v[48:51]
  ds_read_b64_tr_b16 a[0:1], v4 offset:16384
  v_mfma_f32_16x16x32_bf16 v[56:59], v[208:211], v[112:115], v[56:59]
  ds_read_b128 v[104:107], v2 offset:8192
  s_add_u32 m0, s59, 49152
  s_add_u32 s66, s62, 143360
  v_mfma_f32_16x16x32_bf16 v[60:63], v[212:215], v[112:115], v[60:63]
  buffer_load_dwordx4 v1, s[16:19], s66 offen offset:0 sc1 lds
  v_mfma_f32_16x16x32_bf16 v[68:71], v[212:215], v[116:119], v[68:71]
  ds_read_b128 v[108:111], v2 offset:9216
  s_waitcnt lgkmcnt(6)
  v_mfma_f32_16x16x32_bf16 v[64:67], v[208:211], v[116:119], v[64:67]
  ds_read_b64_tr_b16 a[2:3], v4 offset:20480
  v_mfma_f32_16x16x32_bf16 v[40:43], v[216:219], v[120:123], v[40:43]
  ds_read_b128 v[112:115], v2 offset:10240
  v_mfma_f32_16x16x32_bf16 v[44:47], v[220:223], v[120:123], v[44:47]
  buffer_load_dwordx4 v17, s[16:19], s66 offen offset:1024 sc1 lds
  v_mfma_f32_16x16x32_bf16 v[52:55], v[220:223], v[124:127], v[52:55]
  ds_read_b128 v[116:119], v2 offset:11264
  s_waitcnt lgkmcnt(6)
  v_mfma_f32_16x16x32_bf16 v[48:51], v[216:219], v[124:127], v[48:51]
  ds_read_b64_tr_b16 a[4:5], v6 offset:16384
  v_mfma_f32_16x16x32_bf16 v[56:59], v[216:219], v[128:131], v[56:59]
  ds_read_b128 v[120:123], v2 offset:12288
  v_mfma_f32_16x16x32_bf16 v[60:63], v[220:223], v[128:131], v[60:63]
  buffer_load_dwordx4 v20, s[16:19], s66 offen offset:2048 sc1 lds
  v_mfma_f32_16x16x32_bf16 v[68:71], v[220:223], v[132:135], v[68:71]
  ds_read_b128 v[124:127], v2 offset:13312
  s_waitcnt lgkmcnt(6)
  v_mfma_f32_16x16x32_bf16 v[64:67], v[216:219], v[132:135], v[64:67]
  ds_read_b64_tr_b16 a[6:7], v6 offset:20480
  v_mfma_f32_16x16x32_bf16 v[40:43], v[224:227], v[104:107], v[40:43]
  ds_read_b128 v[128:131], v2 offset:14336
  ds_read_b64_tr_b16 a[8:9], v4 offset:24576
  v_mfma_f32_16x16x32_bf16 v[44:47], v[228:231], v[104:107], v[44:47]
  ds_read_b64_tr_b16 a[10:11], v4 offset:28672
  buffer_load_dwordx4 v21, s[16:19], s66 offen offset:3072 sc1 lds
  v_mfma_f32_16x16x32_bf16 v[52:55], v[228:231], v[108:111], v[52:55]
  ds_read_b128 v[132:135], v2 offset:15360
  ds_read_b64_tr_b16 a[12:13], v6 offset:24576
  ds_read_b64_tr_b16 a[14:15], v6 offset:28672
  s_waitcnt lgkmcnt(10)
  v_mfma_f32_16x16x32_bf16 v[48:51], v[224:227], v[108:111], v[48:51]
  s_waitcnt vmcnt(12)
  s_barrier
  ds_read_b64_tr_b16 a[16:17], v4 offset:32768
  v_mfma_f32_16x16x32_bf16 v[56:59], v[224:227], v[112:115], v[56:59]
  ds_read_b128 v[104:107], v2 offset:16384
  s_add_u32 m0, s58, 65536
  s_mov_b32 s67, 524288
  v_mfma_f32_16x16x32_bf16 v[60:63], v[228:231], v[112:115], v[60:63]
  buffer_load_dwordx4 v12, s[12:15], s67 offen offset:0  lds
  v_mfma_f32_16x16x32_bf16 v[68:71], v[228:231], v[116:119], v[68:71]
  ds_read_b128 v[108:111], v2 offset:17408
  s_waitcnt lgkmcnt(10)
  v_mfma_f32_16x16x32_bf16 v[64:67], v[224:227], v[116:119], v[64:67]
  ds_read_b64_tr_b16 a[18:19], v4 offset:36864
  v_mfma_f32_16x16x32_bf16 v[40:43], v[232:235], v[120:123], v[40:43]
  ds_read_b128 v[112:115], v2 offset:18432
  v_mfma_f32_16x16x32_bf16 v[44:47], v[236:239], v[120:123], v[44:47]
  buffer_load_dwordx4 v13, s[12:15], s67 offen offset:1024  lds
  v_mfma_f32_16x16x32_bf16 v[52:55], v[236:239], v[124:127], v[52:55]
L_mark3:
  s_cbranch_execz L_mark7
  ds_read_b128 v[116:119], v2 offset:19456
  s_waitcnt lgkmcnt(6)
  v_mfma_f32_16x16x32_bf16 v[48:51], v[232:235], v[124:127], v[48:51]
  ds_read_b64_tr_b16 a[20:21], v6 offset:32768
  v_mfma_f32_16x16x32_bf16 v[56:59], v[232:235], v[128:131], v[56:59]
  ds_read_b128 v[120:123], v2 offset:20480
  v_mfma_f32_16x16x32_bf16 v[60:63], v[236:239], v[128:131], v[60:63]
  buffer_load_dwordx4 v14, s[12:15], s67 offen offset:2048  lds
  v_mfma_f32_16x16x32_bf16 v[68:71], v[236:239], v[132:135], v[68:71]
  ds_read_b128 v[124:127], v2 offset:21504
  s_waitcnt lgkmcnt(6)
  v_mfma_f32_16x16x32_bf16 v[64:67], v[232:235], v[132:135], v[64:67]
  ds_read_b64_tr_b16 a[22:23], v6 offset:36864
  v_mfma_f32_16x16x32_bf16 v[40:43], v[240:243], v[104:107], v[40:43]
  ds_read_b128 v[128:131], v2 offset:22528
  v_mfma_f32_16x16x32_bf16 v[44:47], v[244:247], v[104:107], v[44:47]
  buffer_load_dwordx4 v15, s[12:15], s67 offen offset:3072  lds
  v_mfma_f32_16x16x32_bf16 v[52:55], v[244:247], v[108:111], v[52:55]
  ds_read_b128 v[132:135], v2 offset:23552
  s_waitcnt lgkmcnt(6)
  v_mfma_f32_16x16x32_bf16 v[48:51], v[240:243], v[108:111], v[48:51]
  ds_read_b64_tr_b16 a[24:25], v5 offset:0
  v_mfma_f32_16x16x32_bf16 v[56:59], v[240:243], v[112:115], v[56:59]
  ds_read_b128 v[104:107], v2 offset:24576
  s_add_u32 m0, s59, 65536
  s_add_u32 s66, s62, 163840
  v_mfma_f32_16x16x32_bf16 v[60:63], v[244:247], v[112:115], v[60:63]
  buffer_load_dwordx4 v1, s[16:19], s66 offen offset:0 sc1 lds
  v_mfma_f32_16x16x32_bf16 v[68:71], v[244:247], v[116:119], v[68:71]
  ds_read_b128 v[108:111], v2 offset:25600
  s_waitcnt lgkmcnt(6)
  v_mfma_f32_16x16x32_bf16 v[64:67], v[240:243], v[116:119], v[64:67]
  ds_read_b64_tr_b16 a[26:27], v5 offset:4096
  v_mfma_f32_16x16x32_bf16 v[40:43], v[248:251], v[120:123], v[40:43]
  ds_read_b128 v[112:115], v2 offset:26624
  v_mfma_f32_16x16x32_bf16 v[44:47], v[252:255], v[120:123], v[44:47]
  buffer_load_dwordx4 v17, s[16:19], s66 offen offset:1024 sc1 lds
  v_mfma_f32_16x16x32_bf16 v[52:55], v[252:255], v[124:127], v[52:55]
  ds_read_b128 v[116:119], v2 offset:27648
  s_waitcnt lgkmcnt(6)
  v_mfma_f32_16x16x32_bf16 v[48:51], v[248:251], v[124:127], v[48:51]
  ds_read_b64_tr_b16 a[28:29], v7 offset:0
  v_mfma_f32_16x16x32_bf16 v[56:59], v[248:251], v[128:131], v[56:59]
  ds_read_b128 v[120:123], v2 offset:28672
  v_mfma_f32_16x16x32_bf16 v[60:63], v[252:255], v[128:131], v[60:63]
  buffer_load_dwordx4 v20, s[16:19], s66 offen offset:2048 sc1 lds
  v_mfma_f32_16x16x32_bf16 v[68:71], v[252:255], v[132:135], v[68:71]
  ds_read_b128 v[124:127], v2 offset:29696
  s_waitcnt lgkmcnt(6)
  v_mfma_f32_16x16x32_bf16 v[64:67], v[248:251], v[132:135], v[64:67]
  ds_read_b64_tr_b16 a[30:31], v7 offset:4096
  v_mfma_f32_16x16x32_bf16 v[40:43], a[0:3], v[104:107], v[40:43]
  ds_read_b128 v[128:131], v2 offset:30720
  v_mfma_f32_16x16x32_bf16 v[44:47], a[4:7], v[104:107], v[44:47]
  buffer_load_dwordx4 v21, s[16:19], s66 offen offset:3072 sc1 lds
  v_mfma_f32_16x16x32_bf16 v[52:55], a[4:7], v[108:111], v[52:55]
  ds_read_b128 v[132:135], v2 offset:31744
  s_waitcnt lgkmcnt(6)
  v_mfma_f32_16x16x32_bf16 v[48:51], a[0:3], v[108:111], v[48:51]
  s_waitcnt vmcnt(12)
  s_barrier
  ds_read_b64_tr_b16 a[32:33], v5 offset:8192
  v_mfma_f32_16x16x32_bf16 v[56:59], a[0:3], v[112:115], v[56:59]
  ds_read_b128 v[104:107], v2 offset:32768
  s_add_u32 m0, s58, 0
  s_mov_b32 s67, 786432
  v_mfma_f32_16x16x32_bf16 v[60:63], a[4:7], v[112:115], v[60:63]
  buffer_load_dwordx4 v12, s[12:15], s67 offen offset:0  lds
  v_mfma_f32_16x16x32_bf16 v[68:71], a[4:7], v[116:119], v[68:71]
  ds_read_b128 v[108:111], v2 offset:33792
  s_waitcnt lgkmcnt(6)
  v_mfma_f32_16x16x32_bf16 v[64:67], a[0:3], v[116:119], v[64:67]
  ds_read_b64_tr_b16 a[34:35], v5 offset:12288
  v_mfma_f32_16x16x32_bf16 v[40:43], a[8:11], v[120:123], v[40:43]
  ds_read_b128 v[112:115], v2 offset:34816
  v_mfma_f32_16x16x32_bf16 v[44:47], a[12:15], v[120:123], v[44:47]
  buffer_load_dwordx4 v13, s[12:15], s67 offen offset:1024  lds
  v_mfma_f32_16x16x32_bf16 v[52:55], a[12:15], v[124:127], v[52:55]
  ds_read_b128 v[116:119], v2 offset:35840
  s_waitcnt lgkmcnt(6)
  v_mfma_f32_16x16x32_bf16 v[48:51], a[8:11], v[124:127], v[48:51]
  ds_read_b64_tr_b16 a[36:37], v7 offset:8192
  v_mfma_f32_16x16x32_bf16 v[56:59], a[8:11], v[128:131], v[56:59]
  ds_read_b128 v[120:123], v2 offset:36864
  v_mfma_f32_16x16x32_bf16 v[60:63], a[12:15], v[128:131], v[60:63]
  buffer_load_dwordx4 v14, s[12:15], s67 offen offset:2048  lds
  v_mfma_f32_16x16x32_bf16 v[68:71], a[12:15], v[132:135], v[68:71]
  ds_read_b128 v[124:127], v2 offset:37888
  s_waitcnt lgkmcnt(6)
  v_mfma_f32_16x16x32_bf16 v[64:67], a[8:11], v[132:135], v[64:67]
  ds_read_b64_tr_b16 a[38:39], v7 offset:12288
  v_mfma_f32_16x16x32_bf16 v[72:75], a[72:75], v[104:107], v[72:75]
  ds_read_b128 v[128:131], v2 offset:38912
  v_mfma_f32_16x16x32_bf16 v[76:79], a[76:79], v[104:107], v[76:79]
  buffer_load_dwordx4 v15, s[12:15], s67 offen offset:3072  lds
  v_mfma_f32_16x16x32_bf16 v[84:87], a[76:79], v[108:111], v[84:87]
  ds_read_b128 v[132:135], v2 offset:39936
  s_waitcnt lgkmcnt(6)
  v_mfma_f32_16x16x32_bf16 v[80:83], a[72:75], v[108:111], v[80:83]
  ds_read_b64_tr_b16 a[40:41], v5 offset:16384
  s_add_u32 m0, s59, 0
  s_add_u32 s66, s62, 184320
  buffer_load_dwordx4 v1, s[16:19], s66 offen offset:0 sc1 lds
  v_pk_mul_f32 v[24:25], v[40:41], v[40:41]
  v_pk_mul_f32 v[26:27], v[42:43], v[42:43]
  v_pk_mul_f32 v[28:29], v[44:45], v[44:45]
  v_pk_mul_f32 v[30:31], v[46:47], v[46:47]
  v_pk_fma_f32 v[24:25], v[24:25], s[84:85], v[22:23] op_sel:[0,0,1] op_sel_hi:[1,0,1]
  v_pk_fma_f32 v[26:27], v[26:27], s[84:85], v[22:23] op_sel:[0,0,1] op_sel_hi:[1,0,1]
  v_pk_fma_f32 v[28:29], v[28:29], s[84:85], v[22:23] op_sel:[0,0,1] op_sel_hi:[1,0,1]
  v_pk_fma_f32 v[30:31], v[30:31], s[84:85], v[22:23] op_sel:[0,0,1] op_sel_hi:[1,0,1]
  v_pk_mul_f32 v[24:25], v[24:25], v[40:41]
  v_pk_mul_f32 v[26:27], v[26:27], v[42:43]
  v_pk_mul_f32 v[28:29], v[28:29], v[44:45]
  v_pk_mul_f32 v[30:31], v[30:31], v[46:47]
  v_exp_f32 v24, v24
  v_exp_f32 v25, v25
  v_exp_f32 v26, v26
  v_exp_f32 v27, v27
  v_exp_f32 v28, v28
  v_exp_f32 v29, v29
  v_exp_f32 v30, v30
  v_exp_f32 v31, v31
  buffer_load_dwordx4 v17, s[16:19], s66 offen offset:1024 sc1 lds
  v_pk_add_f32 v[24:25], v[24:25], 1.0 op_sel_hi:[1,0]
  v_pk_add_f32 v[26:27], v[26:27], 1.0 op_sel_hi:[1,0]
  v_pk_add_f32 v[28:29], v[28:29], 1.0 op_sel_hi:[1,0]
  v_pk_add_f32 v[30:31], v[30:31], 1.0 op_sel_hi:[1,0]
  v_rcp_f32 v24, v24
  v_rcp_f32 v25, v25
  v_rcp_f32 v26, v26
  v_rcp_f32 v27, v27
  v_rcp_f32 v28, v28
  v_rcp_f32 v29, v29
  v_rcp_f32 v30, v30
  v_rcp_f32 v31, v31
  v_pk_mul_f32 v[24:25], v[24:25], v[40:41]
  v_pk_mul_f32 v[26:27], v[26:27], v[42:43]
  v_pk_mul_f32 v[28:29], v[28:29], v[44:45]
  v_pk_mul_f32 v[30:31], v[30:31], v[46:47]
  v_cvt_pk_bf16_f32 v32, v24, v25
  v_cvt_pk_bf16_f32 v33, v26, v27
  v_cvt_pk_bf16_f32 v34, v28, v29
  v_cvt_pk_bf16_f32 v35, v30, v31
  buffer_store_dwordx4 v[32:35], v1, s[20:23], s68 offen offset:0 sc1
  buffer_load_dwordx4 v20, s[16:19], s66 offen offset:2048 sc1 lds
  v_pk_mul_f32 v[24:25], v[48:49], v[48:49]
  v_pk_mul_f32 v[26:27], v[50:51], v[50:51]
  v_pk_mul_f32 v[28:29], v[52:53], v[52:53]
  v_pk_mul_f32 v[30:31], v[54:55], v[54:55]
  v_pk_fma_f32 v[24:25], v[24:25], s[84:85], v[22:23] op_sel:[0,0,1] op_sel_hi:[1,0,1]
  v_pk_fma_f32 v[26:27], v[26:27], s[84:85], v[22:23] op_sel:[0,0,1] op_sel_hi:[1,0,1]
  v_pk_fma_f32 v[28:29], v[28:29], s[84:85], v[22:23] op_sel:[0,0,1] op_sel_hi:[1,0,1]
  v_pk_fma_f32 v[30:31], v[30:31], s[84:85], v[22:23] op_sel:[0,0,1] op_sel_hi:[1,0,1]
  v_pk_mul_f32 v[24:25], v[24:25], v[48:49]
  v_pk_mul_f32 v[26:27], v[26:27], v[50:51]
  v_pk_mul_f32 v[28:29], v[28:29], v[52:53]
  v_pk_mul_f32 v[30:31], v[30:31], v[54:55]
  v_exp_f32 v24, v24
  v_exp_f32 v25, v25
  v_exp_f32 v26, v26
  v_exp_f32 v27, v27
  v_exp_f32 v28, v28
  v_exp_f32 v29, v29
  v_exp_f32 v30, v30
  v_exp_f32 v31, v31
  buffer_load_dwordx4 v21, s[16:19], s66 offen offset:3072 sc1 lds
  v_pk_add_f32 v[24:25], v[24:25], 1.0 op_sel_hi:[1,0]
  v_pk_add_f32 v[26:27], v[26:27], 1.0 op_sel_hi:[1,0]
  v_pk_add_f32 v[28:29], v[28:29], 1.0 op_sel_hi:[1,0]
  v_pk_add_f32 v[30:31], v[30:31], 1.0 op_sel_hi:[1,0]
  v_rcp_f32 v24, v24
  v_rcp_f32 v25, v25
  v_rcp_f32 v26, v26
  v_rcp_f32 v27, v27
  v_rcp_f32 v28, v28
  v_rcp_f32 v29, v29
  v_rcp_f32 v30, v30
  v_rcp_f32 v31, v31
  v_pk_mul_f32 v[24:25], v[24:25], v[48:49]
  v_pk_mul_f32 v[26:27], v[26:27], v[50:51]
  v_pk_mul_f32 v[28:29], v[28:29], v[52:53]
  v_pk_mul_f32 v[30:31], v[30:31], v[54:55]
  v_cvt_pk_bf16_f32 v36, v24, v25
  v_cvt_pk_bf16_f32 v37, v26, v27
  v_cvt_pk_bf16_f32 v38, v28, v29
  v_cvt_pk_bf16_f32 v39, v30, v31
  buffer_store_dwordx4 v[36:39], v17, s[20:23], s68 offen offset:1024 sc1
  s_add_u32 m0, s58, 16384
  s_mov_b32 s67, 1048576
  buffer_load_dwordx4 v12, s[12:15], s67 offen offset:0  lds
  v_pk_mul_f32 v[24:25], v[56:57], v[56:57]
  v_pk_mul_f32 v[26:27], v[58:59], v[58:59]
  v_pk_mul_f32 v[28:29], v[60:61], v[60:61]
  v_pk_mul_f32 v[30:31], v[62:63], v[62:63]
  v_pk_fma_f32 v[24:25], v[24:25], s[84:85], v[22:23] op_sel:[0,0,1] op_sel_hi:[1,0,1]
  v_pk_fma_f32 v[26:27], v[26:27], s[84:85], v[22:23] op_sel:[0,0,1] op_sel_hi:[1,0,1]
  v_pk_fma_f32 v[28:29], v[28:29], s[84:85], v[22:23] op_sel:[0,0,1] op_sel_hi:[1,0,1]
  v_pk_fma_f32 v[30:31], v[30:31], s[84:85], v[22:23] op_sel:[0,0,1] op_sel_hi:[1,0,1]
  v_pk_mul_f32 v[24:25], v[24:25], v[56:57]
  v_pk_mul_f32 v[26:27], v[26:27], v[58:59]
  v_pk_mul_f32 v[28:29], v[28:29], v[60:61]
  v_pk_mul_f32 v[30:31], v[30:31], v[62:63]
  v_exp_f32 v24, v24
  v_exp_f32 v25, v25
  v_exp_f32 v26, v26
  v_exp_f32 v27, v27
  v_exp_f32 v28, v28
  v_exp_f32 v29, v29
  v_exp_f32 v30, v30
  v_exp_f32 v31, v31
  buffer_load_dwordx4 v13, s[12:15], s67 offen offset:1024  lds
  v_pk_add_f32 v[24:25], v[24:25], 1.0 op_sel_hi:[1,0]
  v_pk_add_f32 v[26:27], v[26:27], 1.0 op_sel_hi:[1,0]
  v_pk_add_f32 v[28:29], v[28:29], 1.0 op_sel_hi:[1,0]
  v_pk_add_f32 v[30:31], v[30:31], 1.0 op_sel_hi:[1,0]
  v_rcp_f32 v24, v24
  v_rcp_f32 v25, v25
  v_rcp_f32 v26, v26
  v_rcp_f32 v27, v27
  v_rcp_f32 v28, v28
  v_rcp_f32 v29, v29
  v_rcp_f32 v30, v30
  v_rcp_f32 v31, v31
  v_pk_mul_f32 v[24:25], v[24:25], v[56:57]
  v_pk_mul_f32 v[26:27], v[26:27], v[58:59]
  v_pk_mul_f32 v[28:29], v[28:29], v[60:61]
  v_pk_mul_f32 v[30:31], v[30:31], v[62:63]
  v_cvt_pk_bf16_f32 v32, v24, v25
  v_cvt_pk_bf16_f32 v33, v26, v27
  v_cvt_pk_bf16_f32 v34, v28, v29
  v_cvt_pk_bf16_f32 v35, v30, v31
  buffer_store_dwordx4 v[32:35], v20, s[20:23], s68 offen offset:2048 sc1
  buffer_load_dwordx4 v14, s[12:15], s67 offen offset:2048  lds
  v_pk_mul_f32 v[24:25], v[64:65], v[64:65]
  v_pk_mul_f32 v[26:27], v[66:67], v[66:67]
  v_pk_mul_f32 v[28:29], v[68:69], v[68:69]
  v_pk_mul_f32 v[30:31], v[70:71], v[70:71]
  v_pk_fma_f32 v[24:25], v[24:25], s[84:85], v[22:23] op_sel:[0,0,1] op_sel_hi:[1,0,1]
  v_pk_fma_f32 v[26:27], v[26:27], s[84:85], v[22:23] op_sel:[0,0,1] op_sel_hi:[1,0,1]
  v_pk_fma_f32 v[28:29], v[28:29], s[84:85], v[22:23] op_sel:[0,0,1] op_sel_hi:[1,0,1]
  v_pk_fma_f32 v[30:31], v[30:31], s[84:85], v[22:23] op_sel:[0,0,1] op_sel_hi:[1,0,1]
  v_pk_mul_f32 v[24:25], v[24:25], v[64:65]
  v_pk_mul_f32 v[26:27], v[26:27], v[66:67]
  v_pk_mul_f32 v[28:29], v[28:29], v[68:69]
  v_pk_mul_f32 v[30:31], v[30:31], v[70:71]
  v_exp_f32 v24, v24
  v_exp_f32 v25, v25
  v_exp_f32 v26, v26
  v_exp_f32 v27, v27
  v_exp_f32 v28, v28
  v_exp_f32 v29, v29
  v_exp_f32 v30, v30
  v_exp_f32 v31, v31
  buffer_load_dwordx4 v15, s[12:15], s67 offen offset:3072  lds
  v_pk_add_f32 v[24:25], v[24:25], 1.0 op_sel_hi:[1,0]
  v_pk_add_f32 v[26:27], v[26:27], 1.0 op_sel_hi:[1,0]
  v_pk_add_f32 v[28:29], v[28:29], 1.0 op_sel_hi:[1,0]
  v_pk_add_f32 v[30:31], v[30:31], 1.0 op_sel_hi:[1,0]
  v_rcp_f32 v24, v24
  v_rcp_f32 v25, v25
  v_rcp_f32 v26, v26
  v_rcp_f32 v27, v27
  v_rcp_f32 v28, v28
  v_rcp_f32 v29, v29
  v_rcp_f32 v30, v30
  v_rcp_f32 v31, v31
  v_pk_mul_f32 v[24:25], v[24:25], v[64:65]
  v_pk_mul_f32 v[26:27], v[26:27], v[66:67]
  v_pk_mul_f32 v[28:29], v[28:29], v[68:69]
  v_pk_mul_f32 v[30:31], v[30:31], v[70:71]
  v_cvt_pk_bf16_f32 v36, v24, v25
  v_cvt_pk_bf16_f32 v37, v26, v27
  v_cvt_pk_bf16_f32 v38, v28, v29
  v_cvt_pk_bf16_f32 v39, v30, v31
  buffer_store_dwordx4 v[36:39], v21, s[20:23], s68 offen offset:3072 sc1
  v_mfma_f32_16x16x32_bf16 v[88:91], a[72:75], v[112:115], v[88:91]
  ds_read_b128 v[104:107], v3 offset:0
  v_mfma_f32_16x16x32_bf16 v[92:95], a[76:79], v[112:115], v[92:95]
  v_mfma_f32_16x16x32_bf16 v[100:103], a[76:79], v[116:119], v[100:103]
  ds_read_b128 v[108:111], v3 offset:1024
  s_waitcnt lgkmcnt(6)
  v_mfma_f32_16x16x32_bf16 v[96:99], a[72:75], v[116:119], v[96:99]
  ds_read_b64_tr_b16 a[42:43], v5 offset:20480
  v_mfma_f32_16x16x32_bf16 v[72:75], a[80:83], v[120:123], v[72:75]
  ds_read_b128 v[112:115], v3 offset:2048
  v_mfma_f32_16x16x32_bf16 v[76:79], a[84:87], v[120:123], v[76:79]
  v_mfma_f32_16x16x32_bf16 v[84:87], a[84:87], v[124:127], v[84:87]
  ds_read_b128 v[116:119], v3 offset:3072
  s_waitcnt lgkmcnt(6)
  v_mfma_f32_16x16x32_bf16 v[80:83], a[80:83], v[124:127], v[80:83]
  ds_read_b64_tr_b16 a[44:45], v7 offset:16384
  v_mfma_f32_16x16x32_bf16 v[88:91], a[80:83], v[128:131], v[88:91]
  ds_read_b128 v[120:123], v3 offset:4096
  v_mfma_f32_16x16x32_bf16 v[92:95], a[84:87], v[128:131], v[92:95]
  v_mfma_f32_16x16x32_bf16 v[100:103], a[84:87], v[132:135], v[100:103]
  ds_read_b128 v[124:127], v3 offset:5120
  s_waitcnt lgkmcnt(6)
  v_mfma_f32_16x16x32_bf16 v[96:99], a[80:83], v[132:135], v[96:99]
  ds_read_b64_tr_b16 a[46:47], v7 offset:20480
  v_mfma_f32_16x16x32_bf16 v[72:75], a[88:91], v[104:107], v[72:75]
  ds_read_b128 v[128:131], v3 offset:6144
  v_mfma_f32_16x16x32_bf16 v[76:79], a[92:95], v[104:107], v[76:79]
  v_mfma_f32_16x16x32_bf16 v[84:87], a[92:95], v[108:111], v[84:87]
  ds_read_b128 v[132:135], v3 offset:7168
  s_waitcnt lgkmcnt(6)
  v_mfma_f32_16x16x32_bf16 v[80:83], a[88:91], v[108:111], v[80:83]
  s_waitcnt vmcnt(20)
  s_barrier
  ds_read_b64_tr_b16 a[48:49], v5 offset:24576
  v_mfma_f32_16x16x32_bf16 v[88:91], a[88:91], v[112:115], v[88:91]
  ds_read_b128 v[104:107], v3 offset:8192
  s_add_u32 m0, s58, 32768
  s_mov_b32 s67, 1310720
  v_mfma_f32_16x16x32_bf16 v[92:95], a[92:95], v[112:115], v[92:95]
  buffer_load_dwordx4 v12, s[12:15], s67 offen offset:0  lds
  v_mfma_f32_16x16x32_bf16 v[100:103], a[92:95], v[116:119], v[100:103]
  ds_read_b128 v[108:111], v3 offset:9216
  s_waitcnt lgkmcnt(6)
  v_mfma_f32_16x16x32_bf16 v[96:99], a[88:91], v[116:119], v[96:99]
  ds_read_b64_tr_b16 a[50:51], v5 offset:28672
  v_mfma_f32_16x16x32_bf16 v[72:75], a[96:99], v[120:123], v[72:75]
  ds_read_b128 v[112:115], v3 offset:10240
  v_mfma_f32_16x16x32_bf16 v[76:79], a[100:103], v[120:123], v[76:79]
  buffer_load_dwordx4 v13, s[12:15], s67 offen offset:1024  lds
  v_mfma_f32_16x16x32_bf16 v[84:87], a[100:103], v[124:127], v[84:87]
  ds_read_b128 v[116:119], v3 offset:11264
  s_waitcnt lgkmcnt(6)
  v_mfma_f32_16x16x32_bf16 v[80:83], a[96:99], v[124:127], v[80:83]
  ds_read_b64_tr_b16 a[52:53], v7 offset:24576
  v_mfma_f32_16x16x32_bf16 v[88:91], a[96:99], v[128:131], v[88:91]
  ds_read_b128 v[120:123], v3 offset:12288
  v_mfma_f32_16x16x32_bf16 v[92:95], a[100:103], v[128:131], v[92:95]
  buffer_load_dwordx4 v14, s[12:15], s67 offen offset:2048  lds
  v_mfma_f32_16x16x32_bf16 v[100:103], a[100:103], v[132:135], v[100:103]
  ds_read_b128 v[124:127], v3 offset:13312
  s_waitcnt lgkmcnt(6)
  v_mfma_f32_16x16x32_bf16 v[96:99], a[96:99], v[132:135], v[96:99]
  ds_read_b64_tr_b16 a[54:55], v7 offset:28672
  v_mfma_f32_16x16x32_bf16 v[72:75], a[104:107], v[104:107], v[72:75]
  ds_read_b128 v[128:131], v3 offset:14336
  v_mfma_f32_16x16x32_bf16 v[76:79], a[108:111], v[104:107], v[76:79]
  buffer_load_dwordx4 v15, s[12:15], s67 offen offset:3072  lds
  v_mfma_f32_16x16x32_bf16 v[84:87], a[108:111], v[108:111], v[84:87]
  ds_read_b128 v[132:135], v3 offset:15360
  s_waitcnt lgkmcnt(6)
  v_mfma_f32_16x16x32_bf16 v[80:83], a[104:107], v[108:111], v[80:83]
  ds_read_b64_tr_b16 a[56:57], v5 offset:32768
  v_mfma_f32_16x16x32_bf16 v[88:91], a[104:107], v[112:115], v[88:91]
  ds_read_b128 v[104:107], v3 offset:16384
  s_add_u32 m0, s59, 16384
  s_add_u32 s66, s62, 204800
  v_mfma_f32_16x16x32_bf16 v[92:95], a[108:111], v[112:115], v[92:95]
  buffer_load_dwordx4 v1, s[16:19], s66 offen offset:0 sc1 lds
  v_mfma_f32_16x16x32_bf16 v[100:103], a[108:111], v[116:119], v[100:103]
  ds_read_b128 v[108:111], v3 offset:17408
  s_waitcnt lgkmcnt(6)
  v_mfma_f32_16x16x32_bf16 v[96:99], a[104:107], v[116:119], v[96:99]
  ds_read_b64_tr_b16 a[58:59], v5 offset:36864
  v_mfma_f32_16x16x32_bf16 v[72:75], a[112:115], v[120:123], v[72:75]
  ds_read_b128 v[112:115], v3 offset:18432
  v_mfma_f32_16x16x32_bf16 v[76:79], a[116:119], v[120:123], v[76:79]
  buffer_load_dwordx4 v17, s[16:19], s66 offen offset:1024 sc1 lds
  v_mfma_f32_16x16x32_bf16 v[84:87], a[116:119], v[124:127], v[84:87]
  ds_read_b128 v[116:119], v3 offset:19456
  s_waitcnt lgkmcnt(6)
  v_mfma_f32_16x16x32_bf16 v[80:83], a[112:115], v[124:127], v[80:83]
  ds_read_b64_tr_b16 a[60:61], v7 offset:32768
  v_mfma_f32_16x16x32_bf16 v[88:91], a[112:115], v[128:131], v[88:91]
  ds_read_b128 v[120:123], v3 offset:20480
  v_mfma_f32_16x16x32_bf16 v[92:95], a[116:119], v[128:131], v[92:95]
  buffer_load_dwordx4 v20, s[16:19], s66 offen offset:2048 sc1 lds
  v_mfma_f32_16x16x32_bf16 v[100:103], a[116:119], v[132:135], v[100:103]
  ds_read_b128 v[124:127], v3 offset:21504
  s_waitcnt lgkmcnt(6)
  v_mfma_f32_16x16x32_bf16 v[96:99], a[112:115], v[132:135], v[96:99]
  ds_read_b64_tr_b16 a[62:63], v7 offset:36864
  v_mfma_f32_16x16x32_bf16 v[72:75], a[120:123], v[104:107], v[72:75]
  ds_read_b128 v[128:131], v3 offset:22528
  v_mfma_f32_16x16x32_bf16 v[76:79], a[124:127], v[104:107], v[76:79]
  buffer_load_dwordx4 v21, s[16:19], s66 offen offset:3072 sc1 lds
  v_mfma_f32_16x16x32_bf16 v[84:87], a[124:127], v[108:111], v[84:87]
  ds_read_b128 v[132:135], v3 offset:23552
  s_waitcnt lgkmcnt(6)
  v_mfma_f32_16x16x32_bf16 v[80:83], a[120:123], v[108:111], v[80:83]
  s_waitcnt vmcnt(20)
  s_barrier
  ds_read_b64_tr_b16 a[64:65], v4 offset:0
  s_waitcnt vmcnt(8)
  v_mov_b32 v38, s57
  buffer_store_dword v38, v22, s[20:23], s70 offen sc1
  v_mfma_f32_16x16x32_bf16 v[88:91], a[120:123], v[112:115], v[88:91]
  ds_read_b128 v[104:107], v3 offset:24576
  s_add_u32 m0, s58, 49152
  s_mov_b32 s67, 1572864
  v_mfma_f32_16x16x32_bf16 v[92:95], a[124:127], v[112:115], v[92:95]
  buffer_load_dwordx4 v12, s[12:15], s67 offen offset:0  lds
  v_mfma_f32_16x16x32_bf16 v[100:103], a[124:127], v[116:119], v[100:103]
  ds_read_b128 v[108:111], v3 offset:25600
  s_waitcnt lgkmcnt(6)
  v_mfma_f32_16x16x32_bf16 v[96:99], a[120:123], v[116:119], v[96:99]
  ds_read_b64_tr_b16 a[66:67], v4 offset:4096
  v_mfma_f32_16x16x32_bf16 v[72:75], a[128:131], v[120:123], v[72:75]
  ds_read_b128 v[112:115], v3 offset:26624
  v_mfma_f32_16x16x32_bf16 v[76:79], a[132:135], v[120:123], v[76:79]
  buffer_load_dwordx4 v13, s[12:15], s67 offen offset:1024  lds
  v_mfma_f32_16x16x32_bf16 v[84:87], a[132:135], v[124:127], v[84:87]
  ds_read_b128 v[116:119], v3 offset:27648
  s_waitcnt lgkmcnt(6)
  v_mfma_f32_16x16x32_bf16 v[80:83], a[128:131], v[124:127], v[80:83]
  ds_read_b64_tr_b16 a[68:69], v6 offset:0
  v_mfma_f32_16x16x32_bf16 v[88:91], a[128:131], v[128:131], v[88:91]
  ds_read_b128 v[120:123], v3 offset:28672
  v_mfma_f32_16x16x32_bf16 v[92:95], a[132:135], v[128:131], v[92:95]
  buffer_load_dwordx4 v14, s[12:15], s67 offen offset:2048  lds
  v_mfma_f32_16x16x32_bf16 v[100:103], a[132:135], v[132:135], v[100:103]
  ds_read_b128 v[124:127], v3 offset:29696
  s_waitcnt lgkmcnt(6)
  v_mfma_f32_16x16x32_bf16 v[96:99], a[128:131], v[132:135], v[96:99]
  ds_read_b64_tr_b16 a[70:71], v6 offset:4096
  v_mfma_f32_16x16x32_bf16 v[72:75], a[136:139], v[104:107], v[72:75]
  ds_read_b128 v[128:131], v3 offset:30720
  v_mfma_f32_16x16x32_bf16 v[76:79], a[140:143], v[104:107], v[76:79]
  buffer_load_dwordx4 v15, s[12:15], s67 offen offset:3072  lds
  v_mfma_f32_16x16x32_bf16 v[84:87], a[140:143], v[108:111], v[84:87]
  ds_read_b128 v[132:135], v3 offset:31744
  s_waitcnt lgkmcnt(6)
  v_mfma_f32_16x16x32_bf16 v[80:83], a[136:139], v[108:111], v[80:83]
  ds_read_b64_tr_b16 a[72:73], v4 offset:8192
  v_mfma_f32_16x16x32_bf16 v[88:91], a[136:139], v[112:115], v[88:91]
  ds_read_b128 v[104:107], v3 offset:32768
  s_add_u32 m0, s59, 32768
  s_add_u32 s66, s62, 225280
  v_mfma_f32_16x16x32_bf16 v[92:95], a[140:143], v[112:115], v[92:95]
  buffer_load_dwordx4 v1, s[16:19], s66 offen offset:0 sc1 lds
  v_mfma_f32_16x16x32_bf16 v[100:103], a[140:143], v[116:119], v[100:103]
  ds_read_b128 v[108:111], v3 offset:33792
  s_waitcnt lgkmcnt(6)
  v_mfma_f32_16x16x32_bf16 v[96:99], a[136:139], v[116:119], v[96:99]
  ds_read_b64_tr_b16 a[74:75], v4 offset:12288
  v_mfma_f32_16x16x32_bf16 v[72:75], a[144:147], v[120:123], v[72:75]
  ds_read_b128 v[112:115], v3 offset:34816
  v_mfma_f32_16x16x32_bf16 v[76:79], a[148:151], v[120:123], v[76:79]
  buffer_load_dwordx4 v17, s[16:19], s66 offen offset:1024 sc1 lds
  v_mfma_f32_16x16x32_bf16 v[84:87], a[148:151], v[124:127], v[84:87]
  ds_read_b128 v[116:119], v3 offset:35840
  s_waitcnt lgkmcnt(6)
  v_mfma_f32_16x16x32_bf16 v[80:83], a[144:147], v[124:127], v[80:83]
  ds_read_b64_tr_b16 a[76:77], v6 offset:8192
  v_mfma_f32_16x16x32_bf16 v[88:91], a[144:147], v[128:131], v[88:91]
  ds_read_b128 v[120:123], v3 offset:36864
  v_mfma_f32_16x16x32_bf16 v[92:95], a[148:151], v[128:131], v[92:95]
  buffer_load_dwordx4 v20, s[16:19], s66 offen offset:2048 sc1 lds
  v_mfma_f32_16x16x32_bf16 v[100:103], a[148:151], v[132:135], v[100:103]
  ds_read_b128 v[124:127], v3 offset:37888
  s_waitcnt lgkmcnt(6)
  v_mfma_f32_16x16x32_bf16 v[96:99], a[144:147], v[132:135], v[96:99]
  ds_read_b64_tr_b16 a[78:79], v6 offset:12288
  v_mfma_f32_16x16x32_bf16 v[72:75], a[152:155], v[104:107], v[72:75]
  ds_read_b128 v[128:131], v3 offset:38912
  v_mfma_f32_16x16x32_bf16 v[76:79], a[156:159], v[104:107], v[76:79]
  buffer_load_dwordx4 v21, s[16:19], s66 offen offset:3072 sc1 lds
  v_mfma_f32_16x16x32_bf16 v[84:87], a[156:159], v[108:111], v[84:87]
  ds_read_b128 v[132:135], v3 offset:39936
  s_waitcnt lgkmcnt(6)
  v_mfma_f32_16x16x32_bf16 v[80:83], a[152:155], v[108:111], v[80:83]
  s_barrier
  ds_read_b64_tr_b16 a[80:81], v4 offset:16384
  v_mfma_f32_16x16x32_bf16 v[88:91], a[152:155], v[112:115], v[88:91]
  ds_read_b128 v[104:107], v2 offset:0
  s_add_u32 m0, s58, 65536
  s_mov_b32 s67, 1835008
  v_mfma_f32_16x16x32_bf16 v[92:95], a[156:159], v[112:115], v[92:95]
  buffer_load_dwordx4 v12, s[12:15], s67 offen offset:0  lds
  v_mfma_f32_16x16x32_bf16 v[100:103], a[156:159], v[116:119], v[100:103]
  ds_read_b128 v[108:111], v2 offset:1024
  s_waitcnt lgkmcnt(6)
  v_mfma_f32_16x16x32_bf16 v[96:99], a[152:155], v[116:119], v[96:99]
  ds_read_b64_tr_b16 a[82:83], v4 offset:20480
  v_mfma_f32_16x16x32_bf16 v[72:75], a[160:163], v[120:123], v[72:75]
  ds_read_b128 v[112:115], v2 offset:2048
  v_mfma_f32_16x16x32_bf16 v[76:79], a[164:167], v[120:123], v[76:79]
  buffer_load_dwordx4 v13, s[12:15], s67 offen offset:1024  lds
  v_mfma_f32_16x16x32_bf16 v[84:87], a[164:167], v[124:127], v[84:87]
  ds_read_b128 v[116:119], v2 offset:3072
  s_waitcnt lgkmcnt(6)
  v_mfma_f32_16x16x32_bf16 v[80:83], a[160:163], v[124:127], v[80:83]
  ds_read_b64_tr_b16 a[84:85], v6 offset:16384
  v_mfma_f32_16x16x32_bf16 v[88:91], a[160:163], v[128:131], v[88:91]
  ds_read_b128 v[120:123], v2 offset:4096
  v_mfma_f32_16x16x32_bf16 v[92:95], a[164:167], v[128:131], v[92:95]
  buffer_load_dwordx4 v14, s[12:15], s67 offen offset:2048  lds
  v_mfma_f32_16x16x32_bf16 v[100:103], a[164:167], v[132:135], v[100:103]
  ds_read_b128 v[124:127], v2 offset:5120
  s_waitcnt lgkmcnt(6)
  v_mfma_f32_16x16x32_bf16 v[96:99], a[160:163], v[132:135], v[96:99]
  ds_read_b64_tr_b16 a[86:87], v6 offset:20480
  v_mfma_f32_16x16x32_bf16 v[72:75], a[168:171], v[104:107], v[72:75]
  ds_read_b128 v[128:131], v2 offset:6144
  v_mfma_f32_16x16x32_bf16 v[76:79], a[172:175], v[104:107], v[76:79]
  buffer_load_dwordx4 v15, s[12:15], s67 offen offset:3072  lds
  v_mfma_f32_16x16x32_bf16 v[84:87], a[172:175], v[108:111], v[84:87]
  ds_read_b128 v[132:135], v2 offset:7168
  s_waitcnt lgkmcnt(6)
  v_mfma_f32_16x16x32_bf16 v[80:83], a[168:171], v[108:111], v[80:83]
  ds_read_b64_tr_b16 a[88:89], v4 offset:24576
  v_mfma_f32_16x16x32_bf16 v[88:91], a[168:171], v[112:115], v[88:91]
  ds_read_b128 v[104:107], v2 offset:8192
  s_add_u32 m0, s59, 49152
  s_add_u32 s66, s62, 245760
  v_mfma_f32_16x16x32_bf16 v[92:95], a[172:175], v[112:115], v[92:95]
  buffer_load_dwordx4 v1, s[16:19], s66 offen offset:0 sc1 lds
  v_mfma_f32_16x16x32_bf16 v[100:103], a[172:175], v[116:119], v[100:103]
  ds_read_b128 v[108:111], v2 offset:9216
  s_waitcnt lgkmcnt(6)
  v_mfma_f32_16x16x32_bf16 v[96:99], a[168:171], v[116:119], v[96:99]
  ds_read_b64_tr_b16 a[90:91], v4 offset:28672
  v_mfma_f32_16x16x32_bf16 v[72:75], a[176:179], v[120:123], v[72:75]
  ds_read_b128 v[112:115], v2 offset:10240
  v_mfma_f32_16x16x32_bf16 v[76:79], a[180:183], v[120:123], v[76:79]
  buffer_load_dwordx4 v17, s[16:19], s66 offen offset:1024 sc1 lds
  v_mfma_f32_16x16x32_bf16 v[84:87], a[180:183], v[124:127], v[84:87]
  ds_read_b128 v[116:119], v2 offset:11264
  s_waitcnt lgkmcnt(6)
  v_mfma_f32_16x16x32_bf16 v[80:83], a[176:179], v[124:127], v[80:83]
  ds_read_b64_tr_b16 a[92:93], v6 offset:24576
  v_mfma_f32_16x16x32_bf16 v[88:91], a[176:179], v[128:131], v[88:91]
  ds_read_b128 v[120:123], v2 offset:12288
  v_mfma_f32_16x16x32_bf16 v[92:95], a[180:183], v[128:131], v[92:95]
  buffer_load_dwordx4 v20, s[16:19], s66 offen offset:2048 sc1 lds
  v_mfma_f32_16x16x32_bf16 v[100:103], a[180:183], v[132:135], v[100:103]
  ds_read_b128 v[124:127], v2 offset:13312
  s_waitcnt lgkmcnt(6)
  v_mfma_f32_16x16x32_bf16 v[96:99], a[176:179], v[132:135], v[96:99]
  ds_read_b64_tr_b16 a[94:95], v6 offset:28672
  v_mfma_f32_16x16x32_bf16 v[72:75], a[184:187], v[104:107], v[72:75]
  ds_read_b128 v[128:131], v2 offset:14336
  v_mfma_f32_16x16x32_bf16 v[76:79], a[188:191], v[104:107], v[76:79]
  buffer_load_dwordx4 v21, s[16:19], s66 offen offset:3072 sc1 lds
  v_mfma_f32_16x16x32_bf16 v[84:87], a[188:191], v[108:111], v[84:87]
  ds_read_b128 v[132:135], v2 offset:15360
  s_waitcnt lgkmcnt(6)
  v_mfma_f32_16x16x32_bf16 v[80:83], a[184:187], v[108:111], v[80:83]
  s_waitcnt vmcnt(17)
  s_barrier
  ds_read_b64_tr_b16 a[96:97], v4 offset:32768
  v_mfma_f32_16x16x32_bf16 v[88:91], a[184:187], v[112:115], v[88:91]
  ds_read_b128 v[104:107], v2 offset:16384
  s_add_u32 m0, s58, 0
  s_mov_b32 s67, 2097152
  v_mfma_f32_16x16x32_bf16 v[92:95], a[188:191], v[112:115], v[92:95]
  buffer_load_dwordx4 v12, s[12:15], s67 offen offset:0  lds
  v_mfma_f32_16x16x32_bf16 v[100:103], a[188:191], v[116:119], v[100:103]
  ds_read_b128 v[108:111], v2 offset:17408
  s_waitcnt lgkmcnt(6)
  v_mfma_f32_16x16x32_bf16 v[96:99], a[184:187], v[116:119], v[96:99]
  ds_read_b64_tr_b16 a[98:99], v4 offset:36864
  v_mfma_f32_16x16x32_bf16 v[72:75], a[192:195], v[120:123], v[72:75]
  ds_read_b128 v[112:115], v2 offset:18432
  v_mfma_f32_16x16x32_bf16 v[76:79], a[196:199], v[120:123], v[76:79]
  buffer_load_dwordx4 v13, s[12:15], s67 offen offset:1024  lds
  v_mfma_f32_16x16x32_bf16 v[84:87], a[196:199], v[124:127], v[84:87]
  ds_read_b128 v[116:119], v2 offset:19456
  s_waitcnt lgkmcnt(6)
  v_mfma_f32_16x16x32_bf16 v[80:83], a[192:195], v[124:127], v[80:83]
  ds_read_b64_tr_b16 a[100:101], v6 offset:32768
  v_mfma_f32_16x16x32_bf16 v[88:91], a[192:195], v[128:131], v[88:91]
  ds_read_b128 v[120:123], v2 offset:20480
  v_mfma_f32_16x16x32_bf16 v[92:95], a[196:199], v[128:131], v[92:95]
  buffer_load_dwordx4 v14, s[12:15], s67 offen offset:2048  lds
  v_mfma_f32_16x16x32_bf16 v[100:103], a[196:199], v[132:135], v[100:103]
L_mark4:
  s_cbranch_execz L_mark8
  ds_read_b128 v[124:127], v2 offset:21504
  s_waitcnt lgkmcnt(6)
  v_mfma_f32_16x16x32_bf16 v[96:99], a[192:195], v[132:135], v[96:99]
  ds_read_b64_tr_b16 a[102:103], v6 offset:36864
  v_mfma_f32_16x16x32_bf16 v[72:75], a[200:203], v[104:107], v[72:75]
  ds_read_b128 v[128:131], v2 offset:22528
  v_mfma_f32_16x16x32_bf16 v[76:79], a[204:207], v[104:107], v[76:79]
  buffer_load_dwordx4 v15, s[12:15], s67 offen offset:3072  lds
  v_mfma_f32_16x16x32_bf16 v[84:87], a[204:207], v[108:111], v[84:87]
  ds_read_b128 v[132:135], v2 offset:23552
  s_waitcnt lgkmcnt(6)
  v_mfma_f32_16x16x32_bf16 v[80:83], a[200:203], v[108:111], v[80:83]
  ds_read_b64_tr_b16 a[104:105], v5 offset:0
  v_mfma_f32_16x16x32_bf16 v[88:91], a[200:203], v[112:115], v[88:91]
  ds_read_b128 v[104:107], v2 offset:24576
  s_add_u32 m0, s59, 65536
  s_add_u32 s66, s62, 266240
  v_mfma_f32_16x16x32_bf16 v[92:95], a[204:207], v[112:115], v[92:95]
  buffer_load_dwordx4 v1, s[16:19], s66 offen offset:0 sc1 lds
  v_mfma_f32_16x16x32_bf16 v[100:103], a[204:207], v[116:119], v[100:103]
  ds_read_b128 v[108:111], v2 offset:25600
  s_waitcnt lgkmcnt(6)
  v_mfma_f32_16x16x32_bf16 v[96:99], a[200:203], v[116:119], v[96:99]
  ds_read_b64_tr_b16 a[106:107], v5 offset:4096
  v_mfma_f32_16x16x32_bf16 v[72:75], a[208:211], v[120:123], v[72:75]
  ds_read_b128 v[112:115], v2 offset:26624
  v_mfma_f32_16x16x32_bf16 v[76:79], a[212:215], v[120:123], v[76:79]
  buffer_load_dwordx4 v17, s[16:19], s66 offen offset:1024 sc1 lds
  v_mfma_f32_16x16x32_bf16 v[84:87], a[212:215], v[124:127], v[84:87]
  ds_read_b128 v[116:119], v2 offset:27648
  s_waitcnt lgkmcnt(6)
  v_mfma_f32_16x16x32_bf16 v[80:83], a[208:211], v[124:127], v[80:83]
  ds_read_b64_tr_b16 a[108:109], v7 offset:0
  v_mfma_f32_16x16x32_bf16 v[88:91], a[208:211], v[128:131], v[88:91]
  ds_read_b128 v[120:123], v2 offset:28672
  v_mfma_f32_16x16x32_bf16 v[92:95], a[212:215], v[128:131], v[92:95]
  buffer_load_dwordx4 v20, s[16:19], s66 offen offset:2048 sc1 lds
  v_mfma_f32_16x16x32_bf16 v[100:103], a[212:215], v[132:135], v[100:103]
  ds_read_b128 v[124:127], v2 offset:29696
  s_waitcnt lgkmcnt(6)
  v_mfma_f32_16x16x32_bf16 v[96:99], a[208:211], v[132:135], v[96:99]
  ds_read_b64_tr_b16 a[110:111], v7 offset:4096
  v_mfma_f32_16x16x32_bf16 v[72:75], a[216:219], v[104:107], v[72:75]
  ds_read_b128 v[128:131], v2 offset:30720
  v_mfma_f32_16x16x32_bf16 v[76:79], a[220:223], v[104:107], v[76:79]
  buffer_load_dwordx4 v21, s[16:19], s66 offen offset:3072 sc1 lds
  v_mfma_f32_16x16x32_bf16 v[84:87], a[220:223], v[108:111], v[84:87]
  ds_read_b128 v[132:135], v2 offset:31744
  buffer_load_dword v19, v16, s[32:35], s3 offen
  s_waitcnt lgkmcnt(6)
  v_mfma_f32_16x16x32_bf16 v[80:83], a[216:219], v[108:111], v[80:83]
  s_waitcnt vmcnt(17)
  s_barrier
  ds_read_b64_tr_b16 a[112:113], v5 offset:8192
  v_mfma_f32_16x16x32_bf16 v[88:91], a[216:219], v[112:115], v[88:91]
  ds_read_b128 v[104:107], v2 offset:32768
  s_add_u32 m0, s58, 16384
  s_mov_b32 s67, 2359296
  v_mfma_f32_16x16x32_bf16 v[92:95], a[220:223], v[112:115], v[92:95]
  buffer_load_dwordx4 v12, s[12:15], s67 offen offset:0  lds
  v_mfma_f32_16x16x32_bf16 v[100:103], a[220:223], v[116:119], v[100:103]
  ds_read_b128 v[108:111], v2 offset:33792
  s_waitcnt lgkmcnt(6)
  v_mfma_f32_16x16x32_bf16 v[96:99], a[216:219], v[116:119], v[96:99]
  ds_read_b64_tr_b16 a[114:115], v5 offset:12288
  v_mfma_f32_16x16x32_bf16 v[72:75], a[224:227], v[120:123], v[72:75]
  ds_read_b128 v[112:115], v2 offset:34816
  v_mfma_f32_16x16x32_bf16 v[76:79], a[228:231], v[120:123], v[76:79]
  buffer_load_dwordx4 v13, s[12:15], s67 offen offset:1024  lds
  v_mfma_f32_16x16x32_bf16 v[84:87], a[228:231], v[124:127], v[84:87]
  ds_read_b128 v[116:119], v2 offset:35840
  s_waitcnt lgkmcnt(6)
  v_mfma_f32_16x16x32_bf16 v[80:83], a[224:227], v[124:127], v[80:83]
  ds_read_b64_tr_b16 a[116:117], v7 offset:8192
  v_mfma_f32_16x16x32_bf16 v[88:91], a[224:227], v[128:131], v[88:91]
  ds_read_b128 v[120:123], v2 offset:36864
  v_mfma_f32_16x16x32_bf16 v[92:95], a[228:231], v[128:131], v[92:95]
  buffer_load_dwordx4 v14, s[12:15], s67 offen offset:2048  lds
  v_mfma_f32_16x16x32_bf16 v[100:103], a[228:231], v[132:135], v[100:103]
  ds_read_b128 v[124:127], v2 offset:37888
  s_waitcnt lgkmcnt(6)
  v_mfma_f32_16x16x32_bf16 v[96:99], a[224:227], v[132:135], v[96:99]
  ds_read_b64_tr_b16 a[118:119], v7 offset:12288
  v_mfma_f32_16x16x32_bf16 v[72:75], a[232:235], v[104:107], v[72:75]
  ds_read_b128 v[128:131], v2 offset:38912
  v_mfma_f32_16x16x32_bf16 v[76:79], a[236:239], v[104:107], v[76:79]
  buffer_load_dwordx4 v15, s[12:15], s67 offen offset:3072  lds
  v_mfma_f32_16x16x32_bf16 v[84:87], a[236:239], v[108:111], v[84:87]
  ds_read_b128 v[132:135], v2 offset:39936
  s_waitcnt lgkmcnt(6)
  v_mfma_f32_16x16x32_bf16 v[80:83], a[232:235], v[108:111], v[80:83]
  ds_read_b64_tr_b16 a[120:121], v5 offset:16384
  v_mfma_f32_16x16x32_bf16 v[88:91], a[232:235], v[112:115], v[88:91]
  ds_read_b128 v[104:107], v3 offset:0
  s_add_u32 m0, s59, 0
  s_add_u32 s66, s62, 286720
  v_mfma_f32_16x16x32_bf16 v[92:95], a[236:239], v[112:115], v[92:95]
  buffer_load_dwordx4 v1, s[16:19], s66 offen offset:0 sc1 lds
  v_mfma_f32_16x16x32_bf16 v[100:103], a[236:239], v[116:119], v[100:103]
  ds_read_b128 v[108:111], v3 offset:1024
  s_waitcnt lgkmcnt(6)
  v_mfma_f32_16x16x32_bf16 v[96:99], a[232:235], v[116:119], v[96:99]
  ds_read_b64_tr_b16 a[122:123], v5 offset:20480
  v_mfma_f32_16x16x32_bf16 v[72:75], a[240:243], v[120:123], v[72:75]
  ds_read_b128 v[112:115], v3 offset:2048
  v_mfma_f32_16x16x32_bf16 v[76:79], a[244:247], v[120:123], v[76:79]
  buffer_load_dwordx4 v17, s[16:19], s66 offen offset:1024 sc1 lds
  v_mfma_f32_16x16x32_bf16 v[84:87], a[244:247], v[124:127], v[84:87]
  ds_read_b128 v[116:119], v3 offset:3072
  s_waitcnt lgkmcnt(6)
  v_mfma_f32_16x16x32_bf16 v[80:83], a[240:243], v[124:127], v[80:83]
  ds_read_b64_tr_b16 a[124:125], v7 offset:16384
  v_mfma_f32_16x16x32_bf16 v[88:91], a[240:243], v[128:131], v[88:91]
  ds_read_b128 v[120:123], v3 offset:4096
  v_mfma_f32_16x16x32_bf16 v[92:95], a[244:247], v[128:131], v[92:95]
  buffer_load_dwordx4 v20, s[16:19], s66 offen offset:2048 sc1 lds
  v_mfma_f32_16x16x32_bf16 v[100:103], a[244:247], v[132:135], v[100:103]
  ds_read_b128 v[124:127], v3 offset:5120
  s_waitcnt lgkmcnt(6)
  v_mfma_f32_16x16x32_bf16 v[96:99], a[240:243], v[132:135], v[96:99]
  ds_read_b64_tr_b16 a[126:127], v7 offset:20480
  v_mfma_f32_16x16x32_bf16 v[72:75], a[248:251], v[104:107], v[72:75]
  ds_read_b128 v[128:131], v3 offset:6144
  v_mfma_f32_16x16x32_bf16 v[76:79], a[252:255], v[104:107], v[76:79]
  buffer_load_dwordx4 v21, s[16:19], s66 offen offset:3072 sc1 lds
  v_mfma_f32_16x16x32_bf16 v[84:87], a[252:255], v[108:111], v[84:87]
  ds_read_b128 v[132:135], v3 offset:7168
  s_waitcnt lgkmcnt(6)
  v_mfma_f32_16x16x32_bf16 v[80:83], a[248:251], v[108:111], v[80:83]
  s_waitcnt vmcnt(17)
  s_barrier
  ds_read_b64_tr_b16 a[128:129], v5 offset:24576
  v_mfma_f32_16x16x32_bf16 v[88:91], a[248:251], v[112:115], v[88:91]
  ds_read_b128 v[104:107], v3 offset:8192
  s_add_u32 m0, s58, 32768
  s_mov_b32 s67, 2621440
  v_mfma_f32_16x16x32_bf16 v[92:95], a[252:255], v[112:115], v[92:95]
  buffer_load_dwordx4 v12, s[12:15], s67 offen offset:0  lds
  v_mfma_f32_16x16x32_bf16 v[100:103], a[252:255], v[116:119], v[100:103]
  ds_read_b128 v[108:111], v3 offset:9216
  s_waitcnt lgkmcnt(6)
  v_mfma_f32_16x16x32_bf16 v[96:99], a[248:251], v[116:119], v[96:99]
  ds_read_b64_tr_b16 a[130:131], v5 offset:28672
  v_mfma_f32_16x16x32_bf16 v[72:75], v[136:139], v[120:123], v[72:75]
  ds_read_b128 v[112:115], v3 offset:10240
  v_mfma_f32_16x16x32_bf16 v[76:79], v[140:143], v[120:123], v[76:79]
  buffer_load_dwordx4 v13, s[12:15], s67 offen offset:1024  lds
  v_mfma_f32_16x16x32_bf16 v[84:87], v[140:143], v[124:127], v[84:87]
  ds_read_b128 v[116:119], v3 offset:11264
  s_waitcnt lgkmcnt(6)
  v_mfma_f32_16x16x32_bf16 v[80:83], v[136:139], v[124:127], v[80:83]
  ds_read_b64_tr_b16 a[132:133], v7 offset:24576
  v_mfma_f32_16x16x32_bf16 v[88:91], v[136:139], v[128:131], v[88:91]
  ds_read_b128 v[120:123], v3 offset:12288
  v_mfma_f32_16x16x32_bf16 v[92:95], v[140:143], v[128:131], v[92:95]
  buffer_load_dwordx4 v14, s[12:15], s67 offen offset:2048  lds
  v_mfma_f32_16x16x32_bf16 v[100:103], v[140:143], v[132:135], v[100:103]
  ds_read_b128 v[124:127], v3 offset:13312
  s_waitcnt lgkmcnt(6)
  v_mfma_f32_16x16x32_bf16 v[96:99], v[136:139], v[132:135], v[96:99]
  ds_read_b64_tr_b16 a[134:135], v7 offset:28672
  v_mfma_f32_16x16x32_bf16 v[72:75], v[144:147], v[104:107], v[72:75]
  ds_read_b128 v[128:131], v3 offset:14336
  v_mfma_f32_16x16x32_bf16 v[76:79], v[148:151], v[104:107], v[76:79]
  buffer_load_dwordx4 v15, s[12:15], s67 offen offset:3072  lds
  v_mfma_f32_16x16x32_bf16 v[84:87], v[148:151], v[108:111], v[84:87]
  ds_read_b128 v[132:135], v3 offset:15360
  s_waitcnt lgkmcnt(6)
  v_mfma_f32_16x16x32_bf16 v[80:83], v[144:147], v[108:111], v[80:83]
  ds_read_b64_tr_b16 a[136:137], v5 offset:32768
  v_mfma_f32_16x16x32_bf16 v[88:91], v[144:147], v[112:115], v[88:91]
  ds_read_b128 v[104:107], v3 offset:16384
  s_add_u32 m0, s59, 16384
  s_add_u32 s66, s62, 307200
  v_mfma_f32_16x16x32_bf16 v[92:95], v[148:151], v[112:115], v[92:95]
  buffer_load_dwordx4 v1, s[16:19], s66 offen offset:0 sc1 lds
  v_mfma_f32_16x16x32_bf16 v[100:103], v[148:151], v[116:119], v[100:103]
  ds_read_b128 v[108:111], v3 offset:17408
  s_waitcnt lgkmcnt(6)
  v_mfma_f32_16x16x32_bf16 v[96:99], v[144:147], v[116:119], v[96:99]
  ds_read_b64_tr_b16 a[138:139], v5 offset:36864
  v_mfma_f32_16x16x32_bf16 v[72:75], v[152:155], v[120:123], v[72:75]
  ds_read_b128 v[112:115], v3 offset:18432
  v_mfma_f32_16x16x32_bf16 v[76:79], v[156:159], v[120:123], v[76:79]
  buffer_load_dwordx4 v17, s[16:19], s66 offen offset:1024 sc1 lds
  v_mfma_f32_16x16x32_bf16 v[84:87], v[156:159], v[124:127], v[84:87]
  ds_read_b128 v[116:119], v3 offset:19456
  s_waitcnt lgkmcnt(6)
  v_mfma_f32_16x16x32_bf16 v[80:83], v[152:155], v[124:127], v[80:83]
  ds_read_b64_tr_b16 a[140:141], v7 offset:32768
  v_mfma_f32_16x16x32_bf16 v[88:91], v[152:155], v[128:131], v[88:91]
  ds_read_b128 v[120:123], v3 offset:20480
  v_mfma_f32_16x16x32_bf16 v[92:95], v[156:159], v[128:131], v[92:95]
  buffer_load_dwordx4 v20, s[16:19], s66 offen offset:2048 sc1 lds
  v_mfma_f32_16x16x32_bf16 v[100:103], v[156:159], v[132:135], v[100:103]
  ds_read_b128 v[124:127], v3 offset:21504
  s_waitcnt lgkmcnt(6)
  v_mfma_f32_16x16x32_bf16 v[96:99], v[152:155], v[132:135], v[96:99]
  ds_read_b64_tr_b16 a[142:143], v7 offset:36864
  v_mfma_f32_16x16x32_bf16 v[72:75], v[160:163], v[104:107], v[72:75]
  ds_read_b128 v[128:131], v3 offset:22528
  v_mfma_f32_16x16x32_bf16 v[76:79], v[164:167], v[104:107], v[76:79]
  buffer_load_dwordx4 v21, s[16:19], s66 offen offset:3072 sc1 lds
  v_mfma_f32_16x16x32_bf16 v[84:87], v[164:167], v[108:111], v[84:87]
  ds_read_b128 v[132:135], v3 offset:23552
  s_waitcnt lgkmcnt(6)
  v_mfma_f32_16x16x32_bf16 v[80:83], v[160:163], v[108:111], v[80:83]
  s_waitcnt vmcnt(17)
  s_barrier
  ds_read_b64_tr_b16 a[144:145], v4 offset:0
  v_mfma_f32_16x16x32_bf16 v[88:91], v[160:163], v[112:115], v[88:91]
  ds_read_b128 v[104:107], v3 offset:24576
  s_add_u32 m0, s58, 49152
  s_mov_b32 s67, 2883584
  v_mfma_f32_16x16x32_bf16 v[92:95], v[164:167], v[112:115], v[92:95]
  buffer_load_dwordx4 v12, s[12:15], s67 offen offset:0  lds
  v_subrev_u32 v37, 81920, v2
  v_mfma_f32_16x16x32_bf16 v[100:103], v[164:167], v[116:119], v[100:103]
  ds_read_b128 v[108:111], v3 offset:25600
  v_min_u32 v37, 880, v37
  s_waitcnt lgkmcnt(6)
  v_mfma_f32_16x16x32_bf16 v[96:99], v[160:163], v[116:119], v[96:99]
  ds_read_b64_tr_b16 a[146:147], v4 offset:4096
  v_lshlrev_b32 v37, 1, v37
  v_mfma_f32_16x16x32_bf16 v[72:75], v[168:171], v[120:123], v[72:75]
  ds_read_b128 v[112:115], v3 offset:26624
  buffer_load_dword v39, v37, s[16:19], s72 offen sc1
  v_mfma_f32_16x16x32_bf16 v[76:79], v[172:175], v[120:123], v[76:79]
  buffer_load_dwordx4 v13, s[12:15], s67 offen offset:1024  lds
  v_mfma_f32_16x16x32_bf16 v[84:87], v[172:175], v[124:127], v[84:87]
  ds_read_b128 v[116:119], v3 offset:27648
  s_waitcnt lgkmcnt(6)
  v_mfma_f32_16x16x32_bf16 v[80:83], v[168:171], v[124:127], v[80:83]
  ds_read_b64_tr_b16 a[148:149], v6 offset:0
  v_mfma_f32_16x16x32_bf16 v[88:91], v[168:171], v[128:131], v[88:91]
  ds_read_b128 v[120:123], v3 offset:28672
  v_mfma_f32_16x16x32_bf16 v[92:95], v[172:175], v[128:131], v[92:95]
  buffer_load_dwordx4 v14, s[12:15], s67 offen offset:2048  lds
  v_mfma_f32_16x16x32_bf16 v[100:103], v[172:175], v[132:135], v[100:103]
  ds_read_b128 v[124:127], v3 offset:29696
  s_waitcnt lgkmcnt(6)
  v_mfma_f32_16x16x32_bf16 v[96:99], v[168:171], v[132:135], v[96:99]
  ds_read_b64_tr_b16 a[150:151], v6 offset:4096
  v_mfma_f32_16x16x32_bf16 v[72:75], v[176:179], v[104:107], v[72:75]
  ds_read_b128 v[128:131], v3 offset:30720
  v_mfma_f32_16x16x32_bf16 v[76:79], v[180:183], v[104:107], v[76:79]
  buffer_load_dwordx4 v15, s[12:15], s67 offen offset:3072  lds
  v_mfma_f32_16x16x32_bf16 v[84:87], v[180:183], v[108:111], v[84:87]
  ds_read_b128 v[132:135], v3 offset:31744
  s_waitcnt lgkmcnt(6)
  v_mfma_f32_16x16x32_bf16 v[80:83], v[176:179], v[108:111], v[80:83]
  ds_read_b64_tr_b16 a[152:153], v4 offset:8192
  v_mfma_f32_16x16x32_bf16 v[88:91], v[176:179], v[112:115], v[88:91]
  ds_read_b128 v[104:107], v3 offset:32768
  v_mfma_f32_16x16x32_bf16 v[92:95], v[180:183], v[112:115], v[92:95]
  v_mfma_f32_16x16x32_bf16 v[100:103], v[180:183], v[116:119], v[100:103]
  ds_read_b128 v[108:111], v3 offset:33792
  s_waitcnt lgkmcnt(6)
  v_mfma_f32_16x16x32_bf16 v[96:99], v[176:179], v[116:119], v[96:99]
  ds_read_b64_tr_b16 a[154:155], v4 offset:12288
  v_mfma_f32_16x16x32_bf16 v[72:75], v[184:187], v[120:123], v[72:75]
  ds_read_b128 v[112:115], v3 offset:34816
  v_mfma_f32_16x16x32_bf16 v[76:79], v[188:191], v[120:123], v[76:79]
  v_mfma_f32_16x16x32_bf16 v[84:87], v[188:191], v[124:127], v[84:87]
  ds_read_b128 v[116:119], v3 offset:35840
  s_waitcnt lgkmcnt(6)
  v_mfma_f32_16x16x32_bf16 v[80:83], v[184:187], v[124:127], v[80:83]
  ds_read_b64_tr_b16 a[156:157], v6 offset:8192
  v_mfma_f32_16x16x32_bf16 v[88:91], v[184:187], v[128:131], v[88:91]
  ds_read_b128 v[120:123], v3 offset:36864
  v_mfma_f32_16x16x32_bf16 v[92:95], v[188:191], v[128:131], v[92:95]
  v_mfma_f32_16x16x32_bf16 v[100:103], v[188:191], v[132:135], v[100:103]
  ds_read_b128 v[124:127], v3 offset:37888
  s_waitcnt lgkmcnt(6)
  v_mfma_f32_16x16x32_bf16 v[96:99], v[184:187], v[132:135], v[96:99]
  ds_read_b64_tr_b16 a[158:159], v6 offset:12288
  v_mfma_f32_16x16x32_bf16 v[72:75], v[192:195], v[104:107], v[72:75]
  ds_read_b128 v[128:131], v3 offset:38912
  v_mfma_f32_16x16x32_bf16 v[76:79], v[196:199], v[104:107], v[76:79]
  v_mfma_f32_16x16x32_bf16 v[84:87], v[196:199], v[108:111], v[84:87]
  ds_read_b128 v[132:135], v3 offset:39936
  s_waitcnt lgkmcnt(6)
  v_mfma_f32_16x16x32_bf16 v[80:83], v[192:195], v[108:111], v[80:83]
  s_waitcnt vmcnt(13)
  s_barrier
  ds_read_b64_tr_b16 a[160:161], v4 offset:16384
  v_mfma_f32_16x16x32_bf16 v[88:91], v[192:195], v[112:115], v[88:91]
  ds_read_b128 v[104:107], v2 offset:0
  s_add_u32 m0, s58, 65536
  s_mov_b32 s67, 3145728
  v_mfma_f32_16x16x32_bf16 v[92:95], v[196:199], v[112:115], v[92:95]
  buffer_load_dwordx4 v12, s[12:15], s67 offen offset:0  lds
  v_mfma_f32_16x16x32_bf16 v[100:103], v[196:199], v[116:119], v[100:103]
  ds_read_b128 v[108:111], v2 offset:1024
  s_waitcnt lgkmcnt(6)
  v_mfma_f32_16x16x32_bf16 v[96:99], v[192:195], v[116:119], v[96:99]
  ds_read_b64_tr_b16 a[162:163], v4 offset:20480
  v_mfma_f32_16x16x32_bf16 v[72:75], v[200:203], v[120:123], v[72:75]
  ds_read_b128 v[112:115], v2 offset:2048
  v_mfma_f32_16x16x32_bf16 v[76:79], v[204:207], v[120:123], v[76:79]
  buffer_load_dwordx4 v13, s[12:15], s67 offen offset:1024  lds
  v_mfma_f32_16x16x32_bf16 v[84:87], v[204:207], v[124:127], v[84:87]
  ds_read_b128 v[116:119], v2 offset:3072
  s_waitcnt lgkmcnt(6)
  v_mfma_f32_16x16x32_bf16 v[80:83], v[200:203], v[124:127], v[80:83]
  ds_read_b64_tr_b16 a[164:165], v6 offset:16384
  v_mfma_f32_16x16x32_bf16 v[88:91], v[200:203], v[128:131], v[88:91]
  ds_read_b128 v[120:123], v2 offset:4096
  v_mfma_f32_16x16x32_bf16 v[92:95], v[204:207], v[128:131], v[92:95]
  buffer_load_dwordx4 v14, s[12:15], s67 offen offset:2048  lds
  v_mfma_f32_16x16x32_bf16 v[100:103], v[204:207], v[132:135], v[100:103]
  ds_read_b128 v[124:127], v2 offset:5120
  s_waitcnt lgkmcnt(6)
  v_mfma_f32_16x16x32_bf16 v[96:99], v[200:203], v[132:135], v[96:99]
  ds_read_b64_tr_b16 a[166:167], v6 offset:20480
  v_mfma_f32_16x16x32_bf16 v[72:75], v[208:211], v[104:107], v[72:75]
  ds_read_b128 v[128:131], v2 offset:6144
  v_mfma_f32_16x16x32_bf16 v[76:79], v[212:215], v[104:107], v[76:79]
  buffer_load_dwordx4 v15, s[12:15], s67 offen offset:3072  lds
  v_mfma_f32_16x16x32_bf16 v[84:87], v[212:215], v[108:111], v[84:87]
  ds_read_b128 v[132:135], v2 offset:7168
  s_waitcnt lgkmcnt(6)
  v_mfma_f32_16x16x32_bf16 v[80:83], v[208:211], v[108:111], v[80:83]
  ds_read_b64_tr_b16 a[168:169], v4 offset:24576
  v_mfma_f32_16x16x32_bf16 v[88:91], v[208:211], v[112:115], v[88:91]
  ds_read_b128 v[104:107], v2 offset:8192
  v_mfma_f32_16x16x32_bf16 v[92:95], v[212:215], v[112:115], v[92:95]
  v_mfma_f32_16x16x32_bf16 v[100:103], v[212:215], v[116:119], v[100:103]
  ds_read_b128 v[108:111], v2 offset:9216
  s_waitcnt lgkmcnt(6)
  v_mfma_f32_16x16x32_bf16 v[96:99], v[208:211], v[116:119], v[96:99]
  ds_read_b64_tr_b16 a[170:171], v4 offset:28672
  v_mfma_f32_16x16x32_bf16 v[72:75], v[216:219], v[120:123], v[72:75]
  ds_read_b128 v[112:115], v2 offset:10240
  s_waitcnt vmcnt(7)
  v_cmp_ne_u32 vcc, s57, v39
  s_cbranch_vccnz L_spin_x
L_ret_x:
  s_add_u32 m0, s59, 32768
  s_add_u32 s66, s64, 0
  v_mfma_f32_16x16x32_bf16 v[76:79], v[220:223], v[120:123], v[76:79]
  buffer_load_dwordx4 v1, s[16:19], s66 offen offset:0 sc1 lds
  v_mfma_f32_16x16x32_bf16 v[84:87], v[220:223], v[124:127], v[84:87]
  ds_read_b128 v[116:119], v2 offset:11264
  s_waitcnt lgkmcnt(6)
  v_mfma_f32_16x16x32_bf16 v[80:83], v[216:219], v[124:127], v[80:83]
  ds_read_b64_tr_b16 a[172:173], v6 offset:24576
  v_mfma_f32_16x16x32_bf16 v[88:91], v[216:219], v[128:131], v[88:91]
  ds_read_b128 v[120:123], v2 offset:12288
  v_mfma_f32_16x16x32_bf16 v[92:95], v[220:223], v[128:131], v[92:95]
  buffer_load_dwordx4 v17, s[16:19], s66 offen offset:1024 sc1 lds
  v_mfma_f32_16x16x32_bf16 v[100:103], v[220:223], v[132:135], v[100:103]
  ds_read_b128 v[124:127], v2 offset:13312
  s_waitcnt lgkmcnt(6)
  v_mfma_f32_16x16x32_bf16 v[96:99], v[216:219], v[132:135], v[96:99]
  ds_read_b64_tr_b16 a[174:175], v6 offset:28672
  v_mfma_f32_16x16x32_bf16 v[72:75], v[224:227], v[104:107], v[72:75]
  ds_read_b128 v[128:131], v2 offset:14336
  v_mfma_f32_16x16x32_bf16 v[76:79], v[228:231], v[104:107], v[76:79]
  buffer_load_dwordx4 v20, s[16:19], s66 offen offset:2048 sc1 lds
  v_mfma_f32_16x16x32_bf16 v[84:87], v[228:231], v[108:111], v[84:87]
  ds_read_b128 v[132:135], v2 offset:15360
  s_waitcnt lgkmcnt(6)
  v_mfma_f32_16x16x32_bf16 v[80:83], v[224:227], v[108:111], v[80:83]
L_join:
  s_barrier
  ds_read_b64_tr_b16 a[176:177], v4 offset:32768
  v_mfma_f32_16x16x32_bf16 v[88:91], v[224:227], v[112:115], v[88:91]
  ds_read_b128 v[104:107], v2 offset:16384
  v_mfma_f32_16x16x32_bf16 v[92:95], v[228:231], v[112:115], v[92:95]
  buffer_load_dwordx4 v21, s[16:19], s66 offen offset:3072 sc1 lds
  v_mfma_f32_16x16x32_bf16 v[100:103], v[228:231], v[116:119], v[100:103]
  ds_read_b128 v[108:111], v2 offset:17408
  s_waitcnt lgkmcnt(6)
  v_mfma_f32_16x16x32_bf16 v[96:99], v[224:227], v[116:119], v[96:99]
  ds_read_b64_tr_b16 a[178:179], v4 offset:36864
  v_mfma_f32_16x16x32_bf16 v[72:75], v[232:235], v[120:123], v[72:75]
  ds_read_b128 v[112:115], v2 offset:18432
  s_add_u32 m0, s59, 49152
  s_add_u32 s66, s64, 20480
  v_mfma_f32_16x16x32_bf16 v[76:79], v[236:239], v[120:123], v[76:79]
  buffer_load_dwordx4 v1, s[16:19], s66 offen offset:0 sc1 lds
  v_mfma_f32_16x16x32_bf16 v[84:87], v[236:239], v[124:127], v[84:87]
  ds_read_b128 v[116:119], v2 offset:19456
  s_waitcnt lgkmcnt(6)
  v_mfma_f32_16x16x32_bf16 v[80:83], v[232:235], v[124:127], v[80:83]
  ds_read_b64_tr_b16 a[180:181], v6 offset:32768
  v_mfma_f32_16x16x32_bf16 v[88:91], v[232:235], v[128:131], v[88:91]
  ds_read_b128 v[120:123], v2 offset:20480
  v_mfma_f32_16x16x32_bf16 v[92:95], v[236:239], v[128:131], v[92:95]
  buffer_load_dwordx4 v17, s[16:19], s66 offen offset:1024 sc1 lds
  v_mfma_f32_16x16x32_bf16 v[100:103], v[236:239], v[132:135], v[100:103]
  ds_read_b128 v[124:127], v2 offset:21504
  s_waitcnt lgkmcnt(6)
  v_mfma_f32_16x16x32_bf16 v[96:99], v[232:235], v[132:135], v[96:99]
  ds_read_b64_tr_b16 a[182:183], v6 offset:36864
  v_mfma_f32_16x16x32_bf16 v[72:75], v[240:243], v[104:107], v[72:75]
  ds_read_b128 v[128:131], v2 offset:22528
  v_mfma_f32_16x16x32_bf16 v[76:79], v[244:247], v[104:107], v[76:79]
  buffer_load_dwordx4 v20, s[16:19], s66 offen offset:2048 sc1 lds
  v_mfma_f32_16x16x32_bf16 v[84:87], v[244:247], v[108:111], v[84:87]
  ds_read_b128 v[132:135], v2 offset:23552
  s_waitcnt lgkmcnt(6)
  v_mfma_f32_16x16x32_bf16 v[80:83], v[240:243], v[108:111], v[80:83]
  ds_read_b64_tr_b16 a[184:185], v5 offset:0
  v_mfma_f32_16x16x32_bf16 v[88:91], v[240:243], v[112:115], v[88:91]
  ds_read_b128 v[104:107], v2 offset:24576
  v_mfma_f32_16x16x32_bf16 v[92:95], v[244:247], v[112:115], v[92:95]
  buffer_load_dwordx4 v21, s[16:19], s66 offen offset:3072 sc1 lds
  v_mfma_f32_16x16x32_bf16 v[100:103], v[244:247], v[116:119], v[100:103]
  ds_read_b128 v[108:111], v2 offset:25600
  s_waitcnt lgkmcnt(6)
  v_mfma_f32_16x16x32_bf16 v[96:99], v[240:243], v[116:119], v[96:99]
  ds_read_b64_tr_b16 a[186:187], v5 offset:4096
  v_mfma_f32_16x16x32_bf16 v[72:75], v[248:251], v[120:123], v[72:75]
  ds_read_b128 v[112:115], v2 offset:26624
  s_add_u32 m0, s59, 65536
  s_add_u32 s66, s64, 40960
  v_mfma_f32_16x16x32_bf16 v[76:79], v[252:255], v[120:123], v[76:79]
  buffer_load_dwordx4 v1, s[16:19], s66 offen offset:0 sc1 lds
  v_mfma_f32_16x16x32_bf16 v[84:87], v[252:255], v[124:127], v[84:87]
  ds_read_b128 v[116:119], v2 offset:27648
  s_waitcnt lgkmcnt(6)
  v_mfma_f32_16x16x32_bf16 v[80:83], v[248:251], v[124:127], v[80:83]
  ds_read_b64_tr_b16 a[188:189], v7 offset:0
  v_mfma_f32_16x16x32_bf16 v[88:91], v[248:251], v[128:131], v[88:91]
  ds_read_b128 v[120:123], v2 offset:28672
  v_mfma_f32_16x16x32_bf16 v[92:95], v[252:255], v[128:131], v[92:95]
  buffer_load_dwordx4 v17, s[16:19], s66 offen offset:1024 sc1 lds
  v_mfma_f32_16x16x32_bf16 v[100:103], v[252:255], v[132:135], v[100:103]
  ds_read_b128 v[124:127], v2 offset:29696
  s_waitcnt lgkmcnt(6)
  v_mfma_f32_16x16x32_bf16 v[96:99], v[248:251], v[132:135], v[96:99]
  ds_read_b64_tr_b16 a[190:191], v7 offset:4096
  v_mfma_f32_16x16x32_bf16 v[72:75], a[0:3], v[104:107], v[72:75]
  ds_read_b128 v[128:131], v2 offset:30720
  v_mfma_f32_16x16x32_bf16 v[76:79], a[4:7], v[104:107], v[76:79]
  buffer_load_dwordx4 v20, s[16:19], s66 offen offset:2048 sc1 lds
  v_mfma_f32_16x16x32_bf16 v[84:87], a[4:7], v[108:111], v[84:87]
  ds_read_b128 v[132:135], v2 offset:31744
  s_waitcnt lgkmcnt(6)
  v_mfma_f32_16x16x32_bf16 v[80:83], a[0:3], v[108:111], v[80:83]
  s_waitcnt vmcnt(7)
  s_barrier
  ds_read_b64_tr_b16 a[192:193], v5 offset:8192
  v_mfma_f32_16x16x32_bf16 v[88:91], a[0:3], v[112:115], v[88:91]
  ds_read_b128 v[104:107], v2 offset:32768
  v_mfma_f32_16x16x32_bf16 v[92:95], a[4:7], v[112:115], v[92:95]
  buffer_load_dwordx4 v21, s[16:19], s66 offen offset:3072 sc1 lds
  v_mfma_f32_16x16x32_bf16 v[100:103], a[4:7], v[116:119], v[100:103]
  ds_read_b128 v[108:111], v2 offset:33792
  s_waitcnt lgkmcnt(6)
  v_mfma_f32_16x16x32_bf16 v[96:99], a[0:3], v[116:119], v[96:99]
  ds_read_b64_tr_b16 a[194:195], v5 offset:12288
  v_mfma_f32_16x16x32_bf16 v[72:75], a[8:11], v[120:123], v[72:75]
  ds_read_b128 v[112:115], v2 offset:34816
  v_mfma_f32_16x16x32_bf16 v[76:79], a[12:15], v[120:123], v[76:79]
  v_mfma_f32_16x16x32_bf16 v[84:87], a[12:15], v[124:127], v[84:87]
  ds_read_b128 v[116:119], v2 offset:35840
  s_waitcnt lgkmcnt(6)
  v_mfma_f32_16x16x32_bf16 v[80:83], a[8:11], v[124:127], v[80:83]
  ds_read_b64_tr_b16 a[196:197], v7 offset:8192
  v_mfma_f32_16x16x32_bf16 v[88:91], a[8:11], v[128:131], v[88:91]
  ds_read_b128 v[120:123], v2 offset:36864
  v_mfma_f32_16x16x32_bf16 v[92:95], a[12:15], v[128:131], v[92:95]
  v_mfma_f32_16x16x32_bf16 v[100:103], a[12:15], v[132:135], v[100:103]
  ds_read_b128 v[124:127], v2 offset:37888
  s_waitcnt lgkmcnt(6)
  v_mfma_f32_16x16x32_bf16 v[96:99], a[8:11], v[132:135], v[96:99]
  ds_read_b64_tr_b16 a[198:199], v7 offset:12288
  v_mfma_f32_16x16x32_bf16 v[40:43], v[104:107], a[16:19], 0
  ds_read_b128 v[128:131], v2 offset:38912
  v_mfma_f32_16x16x32_bf16 v[44:47], v[104:107], a[20:23], 0
  s_cmp_lg_u32 s86, 0
  s_cselect_b64 vcc, -1, 0
  v_mfma_f32_16x16x32_bf16 v[52:55], v[108:111], a[20:23], 0
  ds_read_b128 v[132:135], v2 offset:39936
  s_waitcnt lgkmcnt(6)
  v_mfma_f32_16x16x32_bf16 v[48:51], v[108:111], a[16:19], 0
  ds_read_b64_tr_b16 a[200:201], v5 offset:16384
  s_add_u32 m0, s59, 0
  s_add_u32 s66, s64, 61440
  buffer_load_dwordx4 v1, s[16:19], s66 offen offset:0 sc1 lds
  s_cbranch_vccnz L_skipB170
  v_pk_mul_f32 v[24:25], v[72:73], v[72:73]
  v_pk_mul_f32 v[26:27], v[74:75], v[74:75]
  v_pk_mul_f32 v[28:29], v[76:77], v[76:77]
  v_pk_mul_f32 v[30:31], v[78:79], v[78:79]
  v_pk_fma_f32 v[24:25], v[24:25], s[84:85], v[22:23] op_sel:[0,0,1] op_sel_hi:[1,0,1]
  v_pk_fma_f32 v[26:27], v[26:27], s[84:85], v[22:23] op_sel:[0,0,1] op_sel_hi:[1,0,1]
  v_pk_fma_f32 v[28:29], v[28:29], s[84:85], v[22:23] op_sel:[0,0,1] op_sel_hi:[1,0,1]
  v_pk_fma_f32 v[30:31], v[30:31], s[84:85], v[22:23] op_sel:[0,0,1] op_sel_hi:[1,0,1]
  v_pk_mul_f32 v[24:25], v[24:25], v[72:73]
  v_pk_mul_f32 v[26:27], v[26:27], v[74:75]
  v_pk_mul_f32 v[28:29], v[28:29], v[76:77]
  v_pk_mul_f32 v[30:31], v[30:31], v[78:79]
  v_exp_f32 v24, v24
  v_exp_f32 v25, v25
  v_exp_f32 v26, v26
  v_exp_f32 v27, v27
  v_exp_f32 v28, v28
  v_exp_f32 v29, v29
  v_exp_f32 v30, v30
  v_exp_f32 v31, v31
L_skipB170:
  buffer_load_dwordx4 v17, s[16:19], s66 offen offset:1024 sc1 lds
  s_cbranch_vccnz L_skipB149
  v_pk_add_f32 v[24:25], v[24:25], 1.0 op_sel_hi:[1,0]
  v_pk_add_f32 v[26:27], v[26:27], 1.0 op_sel_hi:[1,0]
  v_pk_add_f32 v[28:29], v[28:29], 1.0 op_sel_hi:[1,0]
  v_pk_add_f32 v[30:31], v[30:31], 1.0 op_sel_hi:[1,0]
  v_rcp_f32 v24, v24
  v_rcp_f32 v25, v25
  v_rcp_f32 v26, v26
  v_rcp_f32 v27, v27
  v_rcp_f32 v28, v28
  v_rcp_f32 v29, v29
  v_rcp_f32 v30, v30
  v_rcp_f32 v31, v31
  v_pk_mul_f32 v[24:25], v[24:25], v[72:73]
  v_pk_mul_f32 v[26:27], v[26:27], v[74:75]
  v_pk_mul_f32 v[28:29], v[28:29], v[76:77]
  v_pk_mul_f32 v[30:31], v[30:31], v[78:79]
  v_cvt_pk_bf16_f32 v32, v24, v25
  v_cvt_pk_bf16_f32 v33, v26, v27
  v_cvt_pk_bf16_f32 v34, v28, v29
  v_cvt_pk_bf16_f32 v35, v30, v31
L_skipB149:
  buffer_store_dwordx4 v[32:35], v1, s[20:23], s69 offen offset:0 sc1
  buffer_load_dwordx4 v20, s[16:19], s66 offen offset:2048 sc1 lds
  s_cbranch_vccnz L_skipB127
  v_pk_mul_f32 v[24:25], v[80:81], v[80:81]
  v_pk_mul_f32 v[26:27], v[82:83], v[82:83]
  v_pk_mul_f32 v[28:29], v[84:85], v[84:85]
  v_pk_mul_f32 v[30:31], v[86:87], v[86:87]
  v_pk_fma_f32 v[24:25], v[24:25], s[84:85], v[22:23] op_sel:[0,0,1] op_sel_hi:[1,0,1]
  v_pk_fma_f32 v[26:27], v[26:27], s[84:85], v[22:23] op_sel:[0,0,1] op_sel_hi:[1,0,1]
  v_pk_fma_f32 v[28:29], v[28:29], s[84:85], v[22:23] op_sel:[0,0,1] op_sel_hi:[1,0,1]
  v_pk_fma_f32 v[30:31], v[30:31], s[84:85], v[22:23] op_sel:[0,0,1] op_sel_hi:[1,0,1]
  v_pk_mul_f32 v[24:25], v[24:25], v[80:81]
  v_pk_mul_f32 v[26:27], v[26:27], v[82:83]
  v_pk_mul_f32 v[28:29], v[28:29], v[84:85]
  v_pk_mul_f32 v[30:31], v[30:31], v[86:87]
  v_exp_f32 v24, v24
  v_exp_f32 v25, v25
  v_exp_f32 v26, v26
  v_exp_f32 v27, v27
  v_exp_f32 v28, v28
  v_exp_f32 v29, v29
  v_exp_f32 v30, v30
  v_exp_f32 v31, v31
L_skipB127:
  buffer_load_dwordx4 v21, s[16:19], s66 offen offset:3072 sc1 lds
  s_cbranch_vccnz L_skipB106
  v_pk_add_f32 v[24:25], v[24:25], 1.0 op_sel_hi:[1,0]
  v_pk_add_f32 v[26:27], v[26:27], 1.0 op_sel_hi:[1,0]
  v_pk_add_f32 v[28:29], v[28:29], 1.0 op_sel_hi:[1,0]
  v_pk_add_f32 v[30:31], v[30:31], 1.0 op_sel_hi:[1,0]
  v_rcp_f32 v24, v24
  v_rcp_f32 v25, v25
  v_rcp_f32 v26, v26
  v_rcp_f32 v27, v27
  v_rcp_f32 v28, v28
  v_rcp_f32 v29, v29
  v_rcp_f32 v30, v30
  v_rcp_f32 v31, v31
  v_pk_mul_f32 v[24:25], v[24:25], v[80:81]
  v_pk_mul_f32 v[26:27], v[26:27], v[82:83]
  v_pk_mul_f32 v[28:29], v[28:29], v[84:85]
L_mark5:
  s_cbranch_execz L_touched
  v_pk_mul_f32 v[30:31], v[30:31], v[86:87]
  v_cvt_pk_bf16_f32 v36, v24, v25
  v_cvt_pk_bf16_f32 v37, v26, v27
  v_cvt_pk_bf16_f32 v38, v28, v29
  v_cvt_pk_bf16_f32 v39, v30, v31
L_skipB106:
  buffer_store_dwordx4 v[36:39], v17, s[20:23], s69 offen offset:1024 sc1
  s_add_u32 m0, s58, 0
  s_mov_b32 s67, 3407872
  buffer_load_dwordx4 v12, s[12:15], s67 offen offset:0  lds
  s_cbranch_vccnz L_skipB84
  v_pk_mul_f32 v[24:25], v[88:89], v[88:89]
  v_pk_mul_f32 v[26:27], v[90:91], v[90:91]
  v_pk_mul_f32 v[28:29], v[92:93], v[92:93]
  v_pk_mul_f32 v[30:31], v[94:95], v[94:95]
  v_pk_fma_f32 v[24:25], v[24:25], s[84:85], v[22:23] op_sel:[0,0,1] op_sel_hi:[1,0,1]
  v_pk_fma_f32 v[26:27], v[26:27], s[84:85], v[22:23] op_sel:[0,0,1] op_sel_hi:[1,0,1]
  v_pk_fma_f32 v[28:29], v[28:29], s[84:85], v[22:23] op_sel:[0,0,1] op_sel_hi:[1,0,1]
  v_pk_fma_f32 v[30:31], v[30:31], s[84:85], v[22:23] op_sel:[0,0,1] op_sel_hi:[1,0,1]
  v_pk_mul_f32 v[24:25], v[24:25], v[88:89]
  v_pk_mul_f32 v[26:27], v[26:27], v[90:91]
  v_pk_mul_f32 v[28:29], v[28:29], v[92:93]
  v_pk_mul_f32 v[30:31], v[30:31], v[94:95]
  v_exp_f32 v24, v24
  v_exp_f32 v25, v25
  v_exp_f32 v26, v26
  v_exp_f32 v27, v27
  v_exp_f32 v28, v28
  v_exp_f32 v29, v29
  v_exp_f32 v30, v30
  v_exp_f32 v31, v31
L_skipB84:
  buffer_load_dwordx4 v13, s[12:15], s67 offen offset:1024  lds
  s_cbranch_vccnz L_skipB63
  v_pk_add_f32 v[24:25], v[24:25], 1.0 op_sel_hi:[1,0]
  v_pk_add_f32 v[26:27], v[26:27], 1.0 op_sel_hi:[1,0]
  v_pk_add_f32 v[28:29], v[28:29], 1.0 op_sel_hi:[1,0]
  v_pk_add_f32 v[30:31], v[30:31], 1.0 op_sel_hi:[1,0]
  v_rcp_f32 v24, v24
  v_rcp_f32 v25, v25
  v_rcp_f32 v26, v26
  v_rcp_f32 v27, v27
  v_rcp_f32 v28, v28
  v_rcp_f32 v29, v29
  v_rcp_f32 v30, v30
  v_rcp_f32 v31, v31
  v_pk_mul_f32 v[24:25], v[24:25], v[88:89]
  v_pk_mul_f32 v[26:27], v[26:27], v[90:91]
  v_pk_mul_f32 v[28:29], v[28:29], v[92:93]
  v_pk_mul_f32 v[30:31], v[30:31], v[94:95]
  v_cvt_pk_bf16_f32 v32, v24, v25
  v_cvt_pk_bf16_f32 v33, v26, v27
  v_cvt_pk_bf16_f32 v34, v28, v29
  v_cvt_pk_bf16_f32 v35, v30, v31
L_skipB63:
  buffer_store_dwordx4 v[32:35], v20, s[20:23], s69 offen offset:2048 sc1
  buffer_load_dwordx4 v14, s[12:15], s67 offen offset:2048  lds
  s_cbranch_vccnz L_skipB41
  v_pk_mul_f32 v[24:25], v[96:97], v[96:97]
  v_pk_mul_f32 v[26:27], v[98:99], v[98:99]
  v_pk_mul_f32 v[28:29], v[100:101], v[100:101]
  v_pk_mul_f32 v[30:31], v[102:103], v[102:103]
  v_pk_fma_f32 v[24:25], v[24:25], s[84:85], v[22:23] op_sel:[0,0,1] op_sel_hi:[1,0,1]
  v_pk_fma_f32 v[26:27], v[26:27], s[84:85], v[22:23] op_sel:[0,0,1] op_sel_hi:[1,0,1]
  v_pk_fma_f32 v[28:29], v[28:29], s[84:85], v[22:23] op_sel:[0,0,1] op_sel_hi:[1,0,1]
  v_pk_fma_f32 v[30:31], v[30:31], s[84:85], v[22:23] op_sel:[0,0,1] op_sel_hi:[1,0,1]
  v_pk_mul_f32 v[24:25], v[24:25], v[96:97]
  v_pk_mul_f32 v[26:27], v[26:27], v[98:99]
  v_pk_mul_f32 v[28:29], v[28:29], v[100:101]
  v_pk_mul_f32 v[30:31], v[30:31], v[102:103]
  v_exp_f32 v24, v24
  v_exp_f32 v25, v25
  v_exp_f32 v26, v26
  v_exp_f32 v27, v27
  v_exp_f32 v28, v28
  v_exp_f32 v29, v29
  v_exp_f32 v30, v30
  v_exp_f32 v31, v31
L_skipB41:
  buffer_load_dwordx4 v15, s[12:15], s67 offen offset:3072  lds
  s_cbranch_vccnz L_skipB20
  v_pk_add_f32 v[24:25], v[24:25], 1.0 op_sel_hi:[1,0]
  v_pk_add_f32 v[26:27], v[26:27], 1.0 op_sel_hi:[1,0]
  v_pk_add_f32 v[28:29], v[28:29], 1.0 op_sel_hi:[1,0]
  v_pk_add_f32 v[30:31], v[30:31], 1.0 op_sel_hi:[1,0]
  v_rcp_f32 v24, v24
  v_rcp_f32 v25, v25
  v_rcp_f32 v26, v26
  v_rcp_f32 v27, v27
  v_rcp_f32 v28, v28
  v_rcp_f32 v29, v29
  v_rcp_f32 v30, v30
  v_rcp_f32 v31, v31
  v_pk_mul_f32 v[24:25], v[24:25], v[96:97]
  v_pk_mul_f32 v[26:27], v[26:27], v[98:99]
  v_pk_mul_f32 v[28:29], v[28:29], v[100:101]
  v_pk_mul_f32 v[30:31], v[30:31], v[102:103]
  v_cvt_pk_bf16_f32 v36, v24, v25
  v_cvt_pk_bf16_f32 v37, v26, v27
  v_cvt_pk_bf16_f32 v38, v28, v29
  v_cvt_pk_bf16_f32 v39, v30, v31
L_skipB20:
  buffer_store_dwordx4 v[36:39], v21, s[20:23], s69 offen offset:3072 sc1
  v_mfma_f32_16x16x32_bf16 v[56:59], v[112:115], a[16:19], 0
  ds_read_b128 v[104:107], v3 offset:0
  s_add_u32 m0, s58, 16384
  s_mov_b32 s67, 3670016
  v_mfma_f32_16x16x32_bf16 v[60:63], v[112:115], a[20:23], 0
  buffer_load_dwordx4 v12, s[12:15], s67 offen offset:0  lds
  v_mfma_f32_16x16x32_bf16 v[68:71], v[116:119], a[20:23], 0
  ds_read_b128 v[108:111], v3 offset:1024
  s_waitcnt lgkmcnt(6)
  v_mfma_f32_16x16x32_bf16 v[64:67], v[116:119], a[16:19], 0
  ds_read_b64_tr_b16 a[202:203], v5 offset:20480
  v_mfma_f32_16x16x32_bf16 v[40:43], v[120:123], a[24:27], v[40:43]
  ds_read_b128 v[112:115], v3 offset:2048
  v_mfma_f32_16x16x32_bf16 v[44:47], v[120:123], a[28:31], v[44:47]
  buffer_load_dwordx4 v13, s[12:15], s67 offen offset:1024  lds
  v_mfma_f32_16x16x32_bf16 v[52:55], v[124:127], a[28:31], v[52:55]
  ds_read_b128 v[116:119], v3 offset:3072
  s_waitcnt lgkmcnt(6)
  v_mfma_f32_16x16x32_bf16 v[48:51], v[124:127], a[24:27], v[48:51]
  ds_read_b64_tr_b16 a[204:205], v7 offset:16384
  v_mfma_f32_16x16x32_bf16 v[56:59], v[128:131], a[24:27], v[56:59]
  ds_read_b128 v[120:123], v3 offset:4096
  v_mfma_f32_16x16x32_bf16 v[60:63], v[128:131], a[28:31], v[60:63]
  buffer_load_dwordx4 v14, s[12:15], s67 offen offset:2048  lds
  v_mfma_f32_16x16x32_bf16 v[68:71], v[132:135], a[28:31], v[68:71]
  ds_read_b128 v[124:127], v3 offset:5120
  s_waitcnt lgkmcnt(6)
  v_mfma_f32_16x16x32_bf16 v[64:67], v[132:135], a[24:27], v[64:67]
  ds_read_b64_tr_b16 a[206:207], v7 offset:20480
  v_mfma_f32_16x16x32_bf16 v[40:43], v[104:107], a[32:35], v[40:43]
  ds_read_b128 v[128:131], v3 offset:6144
  v_mfma_f32_16x16x32_bf16 v[44:47], v[104:107], a[36:39], v[44:47]
  buffer_load_dwordx4 v15, s[12:15], s67 offen offset:3072  lds
  v_mfma_f32_16x16x32_bf16 v[52:55], v[108:111], a[36:39], v[52:55]
  ds_read_b128 v[132:135], v3 offset:7168
  s_waitcnt lgkmcnt(6)
  v_mfma_f32_16x16x32_bf16 v[48:51], v[108:111], a[32:35], v[48:51]
  s_waitcnt vmcnt(20)
  s_barrier
  ds_read_b64_tr_b16 a[208:209], v5 offset:24576
  v_mfma_f32_16x16x32_bf16 v[56:59], v[112:115], a[32:35], v[56:59]
  ds_read_b128 v[104:107], v3 offset:8192
  s_add_u32 m0, s58, 32768
  s_mov_b32 s67, 3932160
  v_mfma_f32_16x16x32_bf16 v[60:63], v[112:115], a[36:39], v[60:63]
  buffer_load_dwordx4 v12, s[12:15], s67 offen offset:0  lds
  v_mfma_f32_16x16x32_bf16 v[68:71], v[116:119], a[36:39], v[68:71]
  ds_read_b128 v[108:111], v3 offset:9216
  s_waitcnt lgkmcnt(6)
  v_mfma_f32_16x16x32_bf16 v[64:67], v[116:119], a[32:35], v[64:67]
  ds_read_b64_tr_b16 a[210:211], v5 offset:28672
  v_mfma_f32_16x16x32_bf16 v[40:43], v[120:123], a[40:43], v[40:43]
  ds_read_b128 v[112:115], v3 offset:10240
  v_mfma_f32_16x16x32_bf16 v[44:47], v[120:123], a[44:47], v[44:47]
  buffer_load_dwordx4 v13, s[12:15], s67 offen offset:1024  lds
  v_mfma_f32_16x16x32_bf16 v[52:55], v[124:127], a[44:47], v[52:55]
  ds_read_b128 v[116:119], v3 offset:11264
  s_waitcnt lgkmcnt(6)
  v_mfma_f32_16x16x32_bf16 v[48:51], v[124:127], a[40:43], v[48:51]
  ds_read_b64_tr_b16 a[212:213], v7 offset:24576
  v_mfma_f32_16x16x32_bf16 v[56:59], v[128:131], a[40:43], v[56:59]
  ds_read_b128 v[120:123], v3 offset:12288
  v_mfma_f32_16x16x32_bf16 v[60:63], v[128:131], a[44:47], v[60:63]
  buffer_load_dwordx4 v14, s[12:15], s67 offen offset:2048  lds
  v_mfma_f32_16x16x32_bf16 v[68:71], v[132:135], a[44:47], v[68:71]
  ds_read_b128 v[124:127], v3 offset:13312
  s_waitcnt lgkmcnt(6)
  v_mfma_f32_16x16x32_bf16 v[64:67], v[132:135], a[40:43], v[64:67]
  ds_read_b64_tr_b16 a[214:215], v7 offset:28672
  v_mfma_f32_16x16x32_bf16 v[40:43], v[104:107], a[48:51], v[40:43]
  ds_read_b128 v[128:131], v3 offset:14336
  v_mfma_f32_16x16x32_bf16 v[44:47], v[104:107], a[52:55], v[44:47]
  buffer_load_dwordx4 v15, s[12:15], s67 offen offset:3072  lds
  v_mfma_f32_16x16x32_bf16 v[52:55], v[108:111], a[52:55], v[52:55]
  ds_read_b128 v[132:135], v3 offset:15360
  s_waitcnt lgkmcnt(6)
  v_mfma_f32_16x16x32_bf16 v[48:51], v[108:111], a[48:51], v[48:51]
  ds_read_b64_tr_b16 a[216:217], v5 offset:32768
  v_mfma_f32_16x16x32_bf16 v[56:59], v[112:115], a[48:51], v[56:59]
  ds_read_b128 v[104:107], v3 offset:16384
  s_add_u32 m0, s59, 16384
  s_add_u32 s66, s64, 81920
  v_mfma_f32_16x16x32_bf16 v[60:63], v[112:115], a[52:55], v[60:63]
  buffer_load_dwordx4 v1, s[16:19], s66 offen offset:0 sc1 lds
  v_mfma_f32_16x16x32_bf16 v[68:71], v[116:119], a[52:55], v[68:71]
  ds_read_b128 v[108:111], v3 offset:17408
  s_waitcnt lgkmcnt(6)
  v_mfma_f32_16x16x32_bf16 v[64:67], v[116:119], a[48:51], v[64:67]
  ds_read_b64_tr_b16 a[218:219], v5 offset:36864
  v_mfma_f32_16x16x32_bf16 v[40:43], v[120:123], a[56:59], v[40:43]
  ds_read_b128 v[112:115], v3 offset:18432
  v_mfma_f32_16x16x32_bf16 v[44:47], v[120:123], a[60:63], v[44:47]
  buffer_load_dwordx4 v17, s[16:19], s66 offen offset:1024 sc1 lds
  v_mfma_f32_16x16x32_bf16 v[52:55], v[124:127], a[60:63], v[52:55]
  ds_read_b128 v[116:119], v3 offset:19456
  s_waitcnt lgkmcnt(6)
  v_mfma_f32_16x16x32_bf16 v[48:51], v[124:127], a[56:59], v[48:51]
  ds_read_b64_tr_b16 a[220:221], v7 offset:32768
  v_mfma_f32_16x16x32_bf16 v[56:59], v[128:131], a[56:59], v[56:59]
  ds_read_b128 v[120:123], v3 offset:20480
  v_mfma_f32_16x16x32_bf16 v[60:63], v[128:131], a[60:63], v[60:63]
  buffer_load_dwordx4 v20, s[16:19], s66 offen offset:2048 sc1 lds
  v_mfma_f32_16x16x32_bf16 v[68:71], v[132:135], a[60:63], v[68:71]
  ds_read_b128 v[124:127], v3 offset:21504
  s_waitcnt lgkmcnt(6)
  v_mfma_f32_16x16x32_bf16 v[64:67], v[132:135], a[56:59], v[64:67]
  ds_read_b64_tr_b16 a[222:223], v7 offset:36864
  v_mfma_f32_16x16x32_bf16 v[40:43], v[104:107], a[64:67], v[40:43]
  ds_read_b128 v[128:131], v3 offset:22528
  v_mfma_f32_16x16x32_bf16 v[44:47], v[104:107], a[68:71], v[44:47]
  buffer_load_dwordx4 v21, s[16:19], s66 offen offset:3072 sc1 lds
  v_mfma_f32_16x16x32_bf16 v[52:55], v[108:111], a[68:71], v[52:55]
  ds_read_b128 v[132:135], v3 offset:23552
  s_waitcnt lgkmcnt(6)
  v_mfma_f32_16x16x32_bf16 v[48:51], v[108:111], a[64:67], v[48:51]
  s_waitcnt vmcnt(13)
  s_barrier
  ds_read_b64_tr_b16 a[224:225], v4 offset:0
  v_mfma_f32_16x16x32_bf16 v[56:59], v[112:115], a[64:67], v[56:59]
  ds_read_b128 v[104:107], v3 offset:24576
  s_add_u32 m0, s58, 49152
  s_mov_b32 s67, 4194304
  v_mfma_f32_16x16x32_bf16 v[60:63], v[112:115], a[68:71], v[60:63]
  buffer_load_dwordx4 v12, s[12:15], s67 offen offset:0  lds
  v_mfma_f32_16x16x32_bf16 v[68:71], v[116:119], a[68:71], v[68:71]
  ds_read_b128 v[108:111], v3 offset:25600
  s_waitcnt lgkmcnt(6)
  v_mfma_f32_16x16x32_bf16 v[64:67], v[116:119], a[64:67], v[64:67]
  ds_read_b64_tr_b16 a[226:227], v4 offset:4096
  v_mfma_f32_16x16x32_bf16 v[40:43], v[120:123], a[72:75], v[40:43]
  ds_read_b128 v[112:115], v3 offset:26624
  v_mfma_f32_16x16x32_bf16 v[44:47], v[120:123], a[76:79], v[44:47]
  buffer_load_dwordx4 v13, s[12:15], s67 offen offset:1024  lds
  v_mfma_f32_16x16x32_bf16 v[52:55], v[124:127], a[76:79], v[52:55]
  ds_read_b128 v[116:119], v3 offset:27648
  s_waitcnt lgkmcnt(6)
  v_mfma_f32_16x16x32_bf16 v[48:51], v[124:127], a[72:75], v[48:51]
  ds_read_b64_tr_b16 a[228:229], v6 offset:0
  s_waitcnt vmcnt(14)
  v_mov_b32 v38, s57
  buffer_store_dword v38, v22, s[20:23], s71 offen sc1
  v_mfma_f32_16x16x32_bf16 v[56:59], v[128:131], a[72:75], v[56:59]
  ds_read_b128 v[120:123], v3 offset:28672
  v_mfma_f32_16x16x32_bf16 v[60:63], v[128:131], a[76:79], v[60:63]
  buffer_load_dwordx4 v14, s[12:15], s67 offen offset:2048  lds
  v_mfma_f32_16x16x32_bf16 v[68:71], v[132:135], a[76:79], v[68:71]
  ds_read_b128 v[124:127], v3 offset:29696
  s_waitcnt lgkmcnt(6)
  v_mfma_f32_16x16x32_bf16 v[64:67], v[132:135], a[72:75], v[64:67]
  ds_read_b64_tr_b16 a[230:231], v6 offset:4096
  v_mfma_f32_16x16x32_bf16 v[40:43], v[104:107], a[80:83], v[40:43]
  ds_read_b128 v[128:131], v3 offset:30720
  v_mfma_f32_16x16x32_bf16 v[44:47], v[104:107], a[84:87], v[44:47]
  buffer_load_dwordx4 v15, s[12:15], s67 offen offset:3072  lds
  v_mfma_f32_16x16x32_bf16 v[52:55], v[108:111], a[84:87], v[52:55]
  ds_read_b128 v[132:135], v3 offset:31744
  s_waitcnt lgkmcnt(6)
  v_mfma_f32_16x16x32_bf16 v[48:51], v[108:111], a[80:83], v[48:51]
  ds_read_b64_tr_b16 a[232:233], v4 offset:8192
  v_mfma_f32_16x16x32_bf16 v[56:59], v[112:115], a[80:83], v[56:59]
  ds_read_b128 v[104:107], v3 offset:32768
  s_add_u32 m0, s59, 32768
  s_add_u32 s66, s64, 102400
  v_mfma_f32_16x16x32_bf16 v[60:63], v[112:115], a[84:87], v[60:63]
  buffer_load_dwordx4 v1, s[16:19], s66 offen offset:0 sc1 lds
  v_mfma_f32_16x16x32_bf16 v[68:71], v[116:119], a[84:87], v[68:71]
  ds_read_b128 v[108:111], v3 offset:33792
  s_waitcnt lgkmcnt(6)
  v_mfma_f32_16x16x32_bf16 v[64:67], v[116:119], a[80:83], v[64:67]
  ds_read_b64_tr_b16 a[234:235], v4 offset:12288
  v_mfma_f32_16x16x32_bf16 v[40:43], v[120:123], a[88:91], v[40:43]
  ds_read_b128 v[112:115], v3 offset:34816
  v_mfma_f32_16x16x32_bf16 v[44:47], v[120:123], a[92:95], v[44:47]
  buffer_load_dwordx4 v17, s[16:19], s66 offen offset:1024 sc1 lds
  v_mfma_f32_16x16x32_bf16 v[52:55], v[124:127], a[92:95], v[52:55]
  ds_read_b128 v[116:119], v3 offset:35840
  s_waitcnt lgkmcnt(6)
  v_mfma_f32_16x16x32_bf16 v[48:51], v[124:127], a[88:91], v[48:51]
  ds_read_b64_tr_b16 a[236:237], v6 offset:8192
  v_mfma_f32_16x16x32_bf16 v[56:59], v[128:131], a[88:91], v[56:59]
  ds_read_b128 v[120:123], v3 offset:36864
  v_mfma_f32_16x16x32_bf16 v[60:63], v[128:131], a[92:95], v[60:63]
  buffer_load_dwordx4 v20, s[16:19], s66 offen offset:2048 sc1 lds
  v_mfma_f32_16x16x32_bf16 v[68:71], v[132:135], a[92:95], v[68:71]
  ds_read_b128 v[124:127], v3 offset:37888
  s_waitcnt lgkmcnt(6)
  v_mfma_f32_16x16x32_bf16 v[64:67], v[132:135], a[88:91], v[64:67]
  ds_read_b64_tr_b16 a[238:239], v6 offset:12288
  v_mfma_f32_16x16x32_bf16 v[40:43], v[104:107], a[96:99], v[40:43]
  ds_read_b128 v[128:131], v3 offset:38912
  v_mfma_f32_16x16x32_bf16 v[44:47], v[104:107], a[100:103], v[44:47]
  buffer_load_dwordx4 v21, s[16:19], s66 offen offset:3072 sc1 lds
  v_mfma_f32_16x16x32_bf16 v[52:55], v[108:111], a[100:103], v[52:55]
  ds_read_b128 v[132:135], v3 offset:39936
  s_waitcnt lgkmcnt(6)
  v_mfma_f32_16x16x32_bf16 v[48:51], v[108:111], a[96:99], v[48:51]
  s_waitcnt vmcnt(17)
  s_barrier
  ds_read_b64_tr_b16 a[240:241], v4 offset:16384
  v_mfma_f32_16x16x32_bf16 v[56:59], v[112:115], a[96:99], v[56:59]
  ds_read_b128 v[104:107], v2 offset:0
  s_add_u32 m0, s58, 65536
  s_mov_b32 s67, 4456448
  v_mfma_f32_16x16x32_bf16 v[60:63], v[112:115], a[100:103], v[60:63]
  buffer_load_dwordx4 v12, s[12:15], s67 offen offset:0  lds
  v_mfma_f32_16x16x32_bf16 v[68:71], v[116:119], a[100:103], v[68:71]
  ds_read_b128 v[108:111], v2 offset:1024
  s_waitcnt lgkmcnt(6)
  v_mfma_f32_16x16x32_bf16 v[64:67], v[116:119], a[96:99], v[64:67]
  ds_read_b64_tr_b16 a[242:243], v4 offset:20480
  v_mfma_f32_16x16x32_bf16 v[40:43], v[120:123], a[104:107], v[40:43]
  ds_read_b128 v[112:115], v2 offset:2048
  v_mfma_f32_16x16x32_bf16 v[44:47], v[120:123], a[108:111], v[44:47]
  buffer_load_dwordx4 v13, s[12:15], s67 offen offset:1024  lds
  v_mfma_f32_16x16x32_bf16 v[52:55], v[124:127], a[108:111], v[52:55]
  ds_read_b128 v[116:119], v2 offset:3072
  s_waitcnt lgkmcnt(6)
  v_mfma_f32_16x16x32_bf16 v[48:51], v[124:127], a[104:107], v[48:51]
  ds_read_b64_tr_b16 a[244:245], v6 offset:16384
  v_mfma_f32_16x16x32_bf16 v[56:59], v[128:131], a[104:107], v[56:59]
  ds_read_b128 v[120:123], v2 offset:4096
  v_mfma_f32_16x16x32_bf16 v[60:63], v[128:131], a[108:111], v[60:63]
  buffer_load_dwordx4 v14, s[12:15], s67 offen offset:2048  lds
  v_mfma_f32_16x16x32_bf16 v[68:71], v[132:135], a[108:111], v[68:71]
  ds_read_b128 v[124:127], v2 offset:5120
  s_waitcnt lgkmcnt(6)
  v_mfma_f32_16x16x32_bf16 v[64:67], v[132:135], a[104:107], v[64:67]
  ds_read_b64_tr_b16 a[246:247], v6 offset:20480
  v_mfma_f32_16x16x32_bf16 v[40:43], v[104:107], a[112:115], v[40:43]
  ds_read_b128 v[128:131], v2 offset:6144
  v_mfma_f32_16x16x32_bf16 v[44:47], v[104:107], a[116:119], v[44:47]
  buffer_load_dwordx4 v15, s[12:15], s67 offen offset:3072  lds
  v_mfma_f32_16x16x32_bf16 v[52:55], v[108:111], a[116:119], v[52:55]
  ds_read_b128 v[132:135], v2 offset:7168
  s_waitcnt lgkmcnt(6)
  v_mfma_f32_16x16x32_bf16 v[48:51], v[108:111], a[112:115], v[48:51]
  ds_read_b64_tr_b16 a[248:249], v4 offset:24576
  v_mfma_f32_16x16x32_bf16 v[56:59], v[112:115], a[112:115], v[56:59]
  ds_read_b128 v[104:107], v2 offset:8192
  s_add_u32 m0, s59, 49152
  s_add_u32 s66, s64, 122880
  v_mfma_f32_16x16x32_bf16 v[60:63], v[112:115], a[116:119], v[60:63]
  buffer_load_dwordx4 v1, s[16:19], s66 offen offset:0 sc1 lds
  v_mfma_f32_16x16x32_bf16 v[68:71], v[116:119], a[116:119], v[68:71]
  ds_read_b128 v[108:111], v2 offset:9216
  s_waitcnt lgkmcnt(6)
  v_mfma_f32_16x16x32_bf16 v[64:67], v[116:119], a[112:115], v[64:67]
  ds_read_b64_tr_b16 a[250:251], v4 offset:28672
  v_mfma_f32_16x16x32_bf16 v[40:43], v[120:123], a[120:123], v[40:43]
  ds_read_b128 v[112:115], v2 offset:10240
  v_mfma_f32_16x16x32_bf16 v[44:47], v[120:123], a[124:127], v[44:47]
  buffer_load_dwordx4 v17, s[16:19], s66 offen offset:1024 sc1 lds
  v_mfma_f32_16x16x32_bf16 v[52:55], v[124:127], a[124:127], v[52:55]
  ds_read_b128 v[116:119], v2 offset:11264
  s_waitcnt lgkmcnt(6)
  v_mfma_f32_16x16x32_bf16 v[48:51], v[124:127], a[120:123], v[48:51]
  ds_read_b64_tr_b16 a[252:253], v6 offset:24576
  v_mfma_f32_16x16x32_bf16 v[56:59], v[128:131], a[120:123], v[56:59]
  ds_read_b128 v[120:123], v2 offset:12288
  v_mfma_f32_16x16x32_bf16 v[60:63], v[128:131], a[124:127], v[60:63]
  buffer_load_dwordx4 v20, s[16:19], s66 offen offset:2048 sc1 lds
  v_mfma_f32_16x16x32_bf16 v[68:71], v[132:135], a[124:127], v[68:71]
  ds_read_b128 v[124:127], v2 offset:13312
  s_waitcnt lgkmcnt(6)
  v_mfma_f32_16x16x32_bf16 v[64:67], v[132:135], a[120:123], v[64:67]
  ds_read_b64_tr_b16 a[254:255], v6 offset:28672
  v_mfma_f32_16x16x32_bf16 v[40:43], v[104:107], a[128:131], v[40:43]
  ds_read_b128 v[128:131], v2 offset:14336
  v_mfma_f32_16x16x32_bf16 v[44:47], v[104:107], a[132:135], v[44:47]
  buffer_load_dwordx4 v21, s[16:19], s66 offen offset:3072 sc1 lds
  v_mfma_f32_16x16x32_bf16 v[52:55], v[108:111], a[132:135], v[52:55]
  ds_read_b128 v[132:135], v2 offset:15360
  s_waitcnt lgkmcnt(6)
  v_mfma_f32_16x16x32_bf16 v[48:51], v[108:111], a[128:131], v[48:51]
  s_waitcnt vmcnt(17)
  s_barrier
  ds_read_b64_tr_b16 v[136:137], v4 offset:32768
  v_mfma_f32_16x16x32_bf16 v[56:59], v[112:115], a[128:131], v[56:59]
  ds_read_b128 v[104:107], v2 offset:16384
  s_add_u32 m0, s58, 0
  s_mov_b32 s67, 4718592
  v_mfma_f32_16x16x32_bf16 v[60:63], v[112:115], a[132:135], v[60:63]
  buffer_load_dwordx4 v12, s[12:15], s67 offen offset:0  lds
  v_mfma_f32_16x16x32_bf16 v[68:71], v[116:119], a[132:135], v[68:71]
  ds_read_b128 v[108:111], v2 offset:17408
  s_waitcnt lgkmcnt(6)
  v_mfma_f32_16x16x32_bf16 v[64:67], v[116:119], a[128:131], v[64:67]
  ds_read_b64_tr_b16 v[138:139], v4 offset:36864
  v_mfma_f32_16x16x32_bf16 v[40:43], v[120:123], a[136:139], v[40:43]
  ds_read_b128 v[112:115], v2 offset:18432
  v_mfma_f32_16x16x32_bf16 v[44:47], v[120:123], a[140:143], v[44:47]
  buffer_load_dwordx4 v13, s[12:15], s67 offen offset:1024  lds
  v_mfma_f32_16x16x32_bf16 v[52:55], v[124:127], a[140:143], v[52:55]
  ds_read_b128 v[116:119], v2 offset:19456
  s_waitcnt lgkmcnt(6)
  v_mfma_f32_16x16x32_bf16 v[48:51], v[124:127], a[136:139], v[48:51]
  ds_read_b64_tr_b16 v[140:141], v6 offset:32768
  v_mfma_f32_16x16x32_bf16 v[56:59], v[128:131], a[136:139], v[56:59]
  ds_read_b128 v[120:123], v2 offset:20480
  v_mfma_f32_16x16x32_bf16 v[60:63], v[128:131], a[140:143], v[60:63]
  buffer_load_dwordx4 v14, s[12:15], s67 offen offset:2048  lds
  v_mfma_f32_16x16x32_bf16 v[68:71], v[132:135], a[140:143], v[68:71]
  ds_read_b128 v[124:127], v2 offset:21504
  s_waitcnt lgkmcnt(6)
  v_mfma_f32_16x16x32_bf16 v[64:67], v[132:135], a[136:139], v[64:67]
  ds_read_b64_tr_b16 v[142:143], v6 offset:36864
  v_mfma_f32_16x16x32_bf16 v[40:43], v[104:107], a[144:147], v[40:43]
  ds_read_b128 v[128:131], v2 offset:22528
  v_mfma_f32_16x16x32_bf16 v[44:47], v[104:107], a[148:151], v[44:47]
  buffer_load_dwordx4 v15, s[12:15], s67 offen offset:3072  lds
  v_mfma_f32_16x16x32_bf16 v[52:55], v[108:111], a[148:151], v[52:55]
  ds_read_b128 v[132:135], v2 offset:23552
  s_waitcnt lgkmcnt(6)
  v_mfma_f32_16x16x32_bf16 v[48:51], v[108:111], a[144:147], v[48:51]
  ds_read_b64_tr_b16 v[144:145], v5 offset:0
  v_mfma_f32_16x16x32_bf16 v[56:59], v[112:115], a[144:147], v[56:59]
  ds_read_b128 v[104:107], v2 offset:24576
  s_add_u32 m0, s59, 65536
  s_add_u32 s66, s64, 143360
  v_mfma_f32_16x16x32_bf16 v[60:63], v[112:115], a[148:151], v[60:63]
  buffer_load_dwordx4 v1, s[16:19], s66 offen offset:0 sc1 lds
  v_mfma_f32_16x16x32_bf16 v[68:71], v[116:119], a[148:151], v[68:71]
  ds_read_b128 v[108:111], v2 offset:25600
  s_waitcnt lgkmcnt(6)
  v_mfma_f32_16x16x32_bf16 v[64:67], v[116:119], a[144:147], v[64:67]
  ds_read_b64_tr_b16 v[146:147], v5 offset:4096
  v_mfma_f32_16x16x32_bf16 v[40:43], v[120:123], a[152:155], v[40:43]
  ds_read_b128 v[112:115], v2 offset:26624
  v_mfma_f32_16x16x32_bf16 v[44:47], v[120:123], a[156:159], v[44:47]
  buffer_load_dwordx4 v17, s[16:19], s66 offen offset:1024 sc1 lds
  v_mfma_f32_16x16x32_bf16 v[52:55], v[124:127], a[156:159], v[52:55]
  ds_read_b128 v[116:119], v2 offset:27648
  s_waitcnt lgkmcnt(6)
  v_mfma_f32_16x16x32_bf16 v[48:51], v[124:127], a[152:155], v[48:51]
  ds_read_b64_tr_b16 v[148:149], v7 offset:0
  v_mfma_f32_16x16x32_bf16 v[56:59], v[128:131], a[152:155], v[56:59]
  ds_read_b128 v[120:123], v2 offset:28672
  v_mfma_f32_16x16x32_bf16 v[60:63], v[128:131], a[156:159], v[60:63]
  buffer_load_dwordx4 v20, s[16:19], s66 offen offset:2048 sc1 lds
  v_mfma_f32_16x16x32_bf16 v[68:71], v[132:135], a[156:159], v[68:71]
  ds_read_b128 v[124:127], v2 offset:29696
  s_waitcnt lgkmcnt(6)
  v_mfma_f32_16x16x32_bf16 v[64:67], v[132:135], a[152:155], v[64:67]
  ds_read_b64_tr_b16 v[150:151], v7 offset:4096
  v_mfma_f32_16x16x32_bf16 v[40:43], v[104:107], a[160:163], v[40:43]
  ds_read_b128 v[128:131], v2 offset:30720
  v_mfma_f32_16x16x32_bf16 v[44:47], v[104:107], a[164:167], v[44:47]
  buffer_load_dwordx4 v21, s[16:19], s66 offen offset:3072 sc1 lds
  v_mfma_f32_16x16x32_bf16 v[52:55], v[108:111], a[164:167], v[52:55]
  ds_read_b128 v[132:135], v2 offset:31744
  s_waitcnt lgkmcnt(6)
  v_mfma_f32_16x16x32_bf16 v[48:51], v[108:111], a[160:163], v[48:51]
  s_waitcnt vmcnt(16)
  s_barrier
  ds_read_b64_tr_b16 v[152:153], v5 offset:8192
  v_mfma_f32_16x16x32_bf16 v[56:59], v[112:115], a[160:163], v[56:59]
  ds_read_b128 v[104:107], v2 offset:32768
  s_add_u32 m0, s58, 16384
  s_mov_b32 s67, 4980736
  v_mfma_f32_16x16x32_bf16 v[60:63], v[112:115], a[164:167], v[60:63]
  buffer_load_dwordx4 v12, s[12:15], s67 offen offset:0  lds
  v_mfma_f32_16x16x32_bf16 v[68:71], v[116:119], a[164:167], v[68:71]
  ds_read_b128 v[108:111], v2 offset:33792
  s_waitcnt lgkmcnt(6)
  v_mfma_f32_16x16x32_bf16 v[64:67], v[116:119], a[160:163], v[64:67]
  ds_read_b64_tr_b16 v[154:155], v5 offset:12288
  v_mfma_f32_16x16x32_bf16 v[40:43], v[120:123], a[168:171], v[40:43]
  ds_read_b128 v[112:115], v2 offset:34816
  v_mfma_f32_16x16x32_bf16 v[44:47], v[120:123], a[172:175], v[44:47]
  buffer_load_dwordx4 v13, s[12:15], s67 offen offset:1024  lds
  v_mfma_f32_16x16x32_bf16 v[52:55], v[124:127], a[172:175], v[52:55]
  ds_read_b128 v[116:119], v2 offset:35840
  s_waitcnt lgkmcnt(6)
  v_mfma_f32_16x16x32_bf16 v[48:51], v[124:127], a[168:171], v[48:51]
  ds_read_b64_tr_b16 v[156:157], v7 offset:8192
  v_mfma_f32_16x16x32_bf16 v[56:59], v[128:131], a[168:171], v[56:59]
  ds_read_b128 v[120:123], v2 offset:36864
  v_mfma_f32_16x16x32_bf16 v[60:63], v[128:131], a[172:175], v[60:63]
  buffer_load_dwordx4 v14, s[12:15], s67 offen offset:2048  lds
  v_mfma_f32_16x16x32_bf16 v[68:71], v[132:135], a[172:175], v[68:71]
  ds_read_b128 v[124:127], v2 offset:37888
  s_waitcnt lgkmcnt(6)
  v_mfma_f32_16x16x32_bf16 v[64:67], v[132:135], a[168:171], v[64:67]
  ds_read_b64_tr_b16 v[158:159], v7 offset:12288
  v_mfma_f32_16x16x32_bf16 v[40:43], v[104:107], a[176:179], v[40:43]
  ds_read_b128 v[128:131], v2 offset:38912
  v_mfma_f32_16x16x32_bf16 v[44:47], v[104:107], a[180:183], v[44:47]
  buffer_load_dwordx4 v15, s[12:15], s67 offen offset:3072  lds
  v_mfma_f32_16x16x32_bf16 v[52:55], v[108:111], a[180:183], v[52:55]
  ds_read_b128 v[132:135], v2 offset:39936
  s_waitcnt lgkmcnt(6)
  v_mfma_f32_16x16x32_bf16 v[48:51], v[108:111], a[176:179], v[48:51]
  ds_read_b64_tr_b16 v[160:161], v5 offset:16384
  v_mfma_f32_16x16x32_bf16 v[56:59], v[112:115], a[176:179], v[56:59]
  ds_read_b128 v[104:107], v3 offset:0
  s_add_u32 m0, s59, 0
  s_add_u32 s66, s64, 163840
  v_mfma_f32_16x16x32_bf16 v[60:63], v[112:115], a[180:183], v[60:63]
  buffer_load_dwordx4 v1, s[16:19], s66 offen offset:0 sc1 lds
  v_mfma_f32_16x16x32_bf16 v[68:71], v[116:119], a[180:183], v[68:71]
  ds_read_b128 v[108:111], v3 offset:1024
  s_waitcnt lgkmcnt(6)
  v_mfma_f32_16x16x32_bf16 v[64:67], v[116:119], a[176:179], v[64:67]
  ds_read_b64_tr_b16 v[162:163], v5 offset:20480
  v_mfma_f32_16x16x32_bf16 v[40:43], v[120:123], a[184:187], v[40:43]
  ds_read_b128 v[112:115], v3 offset:2048
  v_mfma_f32_16x16x32_bf16 v[44:47], v[120:123], a[188:191], v[44:47]
  buffer_load_dwordx4 v17, s[16:19], s66 offen offset:1024 sc1 lds
  v_mfma_f32_16x16x32_bf16 v[52:55], v[124:127], a[188:191], v[52:55]
  ds_read_b128 v[116:119], v3 offset:3072
  s_waitcnt lgkmcnt(6)
  v_mfma_f32_16x16x32_bf16 v[48:51], v[124:127], a[184:187], v[48:51]
  ds_read_b64_tr_b16 v[164:165], v7 offset:16384
  v_mfma_f32_16x16x32_bf16 v[56:59], v[128:131], a[184:187], v[56:59]
  ds_read_b128 v[120:123], v3 offset:4096
  v_mfma_f32_16x16x32_bf16 v[60:63], v[128:131], a[188:191], v[60:63]
  buffer_load_dwordx4 v20, s[16:19], s66 offen offset:2048 sc1 lds
  v_mfma_f32_16x16x32_bf16 v[68:71], v[132:135], a[188:191], v[68:71]
  ds_read_b128 v[124:127], v3 offset:5120
  s_waitcnt lgkmcnt(6)
  v_mfma_f32_16x16x32_bf16 v[64:67], v[132:135], a[184:187], v[64:67]
  ds_read_b64_tr_b16 v[166:167], v7 offset:20480
  v_mfma_f32_16x16x32_bf16 v[40:43], v[104:107], a[192:195], v[40:43]
  ds_read_b128 v[128:131], v3 offset:6144
  v_mfma_f32_16x16x32_bf16 v[44:47], v[104:107], a[196:199], v[44:47]
  buffer_load_dwordx4 v21, s[16:19], s66 offen offset:3072 sc1 lds
  v_mfma_f32_16x16x32_bf16 v[52:55], v[108:111], a[196:199], v[52:55]
  ds_read_b128 v[132:135], v3 offset:7168
  s_waitcnt lgkmcnt(6)
  v_mfma_f32_16x16x32_bf16 v[48:51], v[108:111], a[192:195], v[48:51]
  s_waitcnt vmcnt(16)
  s_barrier
  ds_read_b64_tr_b16 v[168:169], v5 offset:24576
  v_mfma_f32_16x16x32_bf16 v[56:59], v[112:115], a[192:195], v[56:59]
  ds_read_b128 v[104:107], v3 offset:8192
  s_add_u32 m0, s58, 32768
  s_mov_b32 s67, 5242880
  v_mfma_f32_16x16x32_bf16 v[60:63], v[112:115], a[196:199], v[60:63]
  buffer_load_dwordx4 v12, s[12:15], s67 offen offset:0  lds
  v_mfma_f32_16x16x32_bf16 v[68:71], v[116:119], a[196:199], v[68:71]
  ds_read_b128 v[108:111], v3 offset:9216
  s_waitcnt lgkmcnt(6)
  v_mfma_f32_16x16x32_bf16 v[64:67], v[116:119], a[192:195], v[64:67]
  ds_read_b64_tr_b16 v[170:171], v5 offset:28672
  v_mfma_f32_16x16x32_bf16 v[40:43], v[120:123], a[200:203], v[40:43]
  ds_read_b128 v[112:115], v3 offset:10240
  v_mfma_f32_16x16x32_bf16 v[44:47], v[120:123], a[204:207], v[44:47]
  buffer_load_dwordx4 v13, s[12:15], s67 offen offset:1024  lds
  v_mfma_f32_16x16x32_bf16 v[52:55], v[124:127], a[204:207], v[52:55]
  ds_read_b128 v[116:119], v3 offset:11264
  s_waitcnt lgkmcnt(6)
  v_mfma_f32_16x16x32_bf16 v[48:51], v[124:127], a[200:203], v[48:51]
  ds_read_b64_tr_b16 v[172:173], v7 offset:24576
  v_mfma_f32_16x16x32_bf16 v[56:59], v[128:131], a[200:203], v[56:59]
  ds_read_b128 v[120:123], v3 offset:12288
  v_mfma_f32_16x16x32_bf16 v[60:63], v[128:131], a[204:207], v[60:63]
  buffer_load_dwordx4 v14, s[12:15], s67 offen offset:2048  lds
  v_mfma_f32_16x16x32_bf16 v[68:71], v[132:135], a[204:207], v[68:71]
  ds_read_b128 v[124:127], v3 offset:13312
  s_waitcnt lgkmcnt(6)
  v_mfma_f32_16x16x32_bf16 v[64:67], v[132:135], a[200:203], v[64:67]
  ds_read_b64_tr_b16 v[174:175], v7 offset:28672
  v_mfma_f32_16x16x32_bf16 v[40:43], v[104:107], a[208:211], v[40:43]
  ds_read_b128 v[128:131], v3 offset:14336
L_mark6:
  s_cbranch_execz L_touched
  v_mfma_f32_16x16x32_bf16 v[44:47], v[104:107], a[212:215], v[44:47]
  buffer_load_dwordx4 v15, s[12:15], s67 offen offset:3072  lds
  v_mfma_f32_16x16x32_bf16 v[52:55], v[108:111], a[212:215], v[52:55]
  ds_read_b128 v[132:135], v3 offset:15360
  s_waitcnt lgkmcnt(6)
  v_mfma_f32_16x16x32_bf16 v[48:51], v[108:111], a[208:211], v[48:51]
  ds_read_b64_tr_b16 v[176:177], v5 offset:32768
  v_mfma_f32_16x16x32_bf16 v[56:59], v[112:115], a[208:211], v[56:59]
  ds_read_b128 v[104:107], v3 offset:16384
  s_add_u32 m0, s59, 16384
  s_add_u32 s66, s64, 184320
  v_mfma_f32_16x16x32_bf16 v[60:63], v[112:115], a[212:215], v[60:63]
  buffer_load_dwordx4 v1, s[16:19], s66 offen offset:0 sc1 lds
  v_mfma_f32_16x16x32_bf16 v[68:71], v[116:119], a[212:215], v[68:71]
  ds_read_b128 v[108:111], v3 offset:17408
  s_waitcnt lgkmcnt(6)
  v_mfma_f32_16x16x32_bf16 v[64:67], v[116:119], a[208:211], v[64:67]
  ds_read_b64_tr_b16 v[178:179], v5 offset:36864
  v_mfma_f32_16x16x32_bf16 v[40:43], v[120:123], a[216:219], v[40:43]
  ds_read_b128 v[112:115], v3 offset:18432
  v_mfma_f32_16x16x32_bf16 v[44:47], v[120:123], a[220:223], v[44:47]
  buffer_load_dwordx4 v17, s[16:19], s66 offen offset:1024 sc1 lds
  v_mfma_f32_16x16x32_bf16 v[52:55], v[124:127], a[220:223], v[52:55]
  ds_read_b128 v[116:119], v3 offset:19456
  s_waitcnt lgkmcnt(6)
  v_mfma_f32_16x16x32_bf16 v[48:51], v[124:127], a[216:219], v[48:51]
  ds_read_b64_tr_b16 v[180:181], v7 offset:32768
  v_mfma_f32_16x16x32_bf16 v[56:59], v[128:131], a[216:219], v[56:59]
  ds_read_b128 v[120:123], v3 offset:20480
  v_mfma_f32_16x16x32_bf16 v[60:63], v[128:131], a[220:223], v[60:63]
  buffer_load_dwordx4 v20, s[16:19], s66 offen offset:2048 sc1 lds
  v_mfma_f32_16x16x32_bf16 v[68:71], v[132:135], a[220:223], v[68:71]
  ds_read_b128 v[124:127], v3 offset:21504
  s_waitcnt lgkmcnt(6)
  v_mfma_f32_16x16x32_bf16 v[64:67], v[132:135], a[216:219], v[64:67]
  ds_read_b64_tr_b16 v[182:183], v7 offset:36864
  v_mfma_f32_16x16x32_bf16 v[40:43], v[104:107], a[224:227], v[40:43]
  ds_read_b128 v[128:131], v3 offset:22528
  v_mfma_f32_16x16x32_bf16 v[44:47], v[104:107], a[228:231], v[44:47]
  buffer_load_dwordx4 v21, s[16:19], s66 offen offset:3072 sc1 lds
  v_mfma_f32_16x16x32_bf16 v[52:55], v[108:111], a[228:231], v[52:55]
  ds_read_b128 v[132:135], v3 offset:23552
  s_waitcnt lgkmcnt(6)
  v_mfma_f32_16x16x32_bf16 v[48:51], v[108:111], a[224:227], v[48:51]
  s_waitcnt vmcnt(16)
  s_barrier
  ds_read_b64_tr_b16 v[184:185], v4 offset:0
  v_mfma_f32_16x16x32_bf16 v[56:59], v[112:115], a[224:227], v[56:59]
  ds_read_b128 v[104:107], v3 offset:24576
  s_add_u32 m0, s58, 49152
  s_mov_b32 s67, 5505024
  v_mfma_f32_16x16x32_bf16 v[60:63], v[112:115], a[228:231], v[60:63]
  buffer_load_dwordx4 v12, s[12:15], s67 offen offset:0  lds
  v_mfma_f32_16x16x32_bf16 v[68:71], v[116:119], a[228:231], v[68:71]
  ds_read_b128 v[108:111], v3 offset:25600
  s_waitcnt lgkmcnt(6)
  v_mfma_f32_16x16x32_bf16 v[64:67], v[116:119], a[224:227], v[64:67]
  ds_read_b64_tr_b16 v[186:187], v4 offset:4096
  v_mfma_f32_16x16x32_bf16 v[40:43], v[120:123], a[232:235], v[40:43]
  ds_read_b128 v[112:115], v3 offset:26624
  v_mfma_f32_16x16x32_bf16 v[44:47], v[120:123], a[236:239], v[44:47]
  buffer_load_dwordx4 v13, s[12:15], s67 offen offset:1024  lds
  v_mfma_f32_16x16x32_bf16 v[52:55], v[124:127], a[236:239], v[52:55]
  ds_read_b128 v[116:119], v3 offset:27648
  s_waitcnt lgkmcnt(6)
  v_mfma_f32_16x16x32_bf16 v[48:51], v[124:127], a[232:235], v[48:51]
  ds_read_b64_tr_b16 v[188:189], v6 offset:0
  v_mfma_f32_16x16x32_bf16 v[56:59], v[128:131], a[232:235], v[56:59]
  ds_read_b128 v[120:123], v3 offset:28672
  v_mfma_f32_16x16x32_bf16 v[60:63], v[128:131], a[236:239], v[60:63]
  buffer_load_dwordx4 v14, s[12:15], s67 offen offset:2048  lds
  v_mfma_f32_16x16x32_bf16 v[68:71], v[132:135], a[236:239], v[68:71]
  ds_read_b128 v[124:127], v3 offset:29696
  s_waitcnt lgkmcnt(6)
  v_mfma_f32_16x16x32_bf16 v[64:67], v[132:135], a[232:235], v[64:67]
  ds_read_b64_tr_b16 v[190:191], v6 offset:4096
  v_mfma_f32_16x16x32_bf16 v[40:43], v[104:107], a[240:243], v[40:43]
  ds_read_b128 v[128:131], v3 offset:30720
  v_mfma_f32_16x16x32_bf16 v[44:47], v[104:107], a[244:247], v[44:47]
  buffer_load_dwordx4 v15, s[12:15], s67 offen offset:3072  lds
  v_mfma_f32_16x16x32_bf16 v[52:55], v[108:111], a[244:247], v[52:55]
  ds_read_b128 v[132:135], v3 offset:31744
  s_waitcnt lgkmcnt(6)
  v_mfma_f32_16x16x32_bf16 v[48:51], v[108:111], a[240:243], v[48:51]
  ds_read_b64_tr_b16 v[192:193], v4 offset:8192
  v_mfma_f32_16x16x32_bf16 v[56:59], v[112:115], a[240:243], v[56:59]
  ds_read_b128 v[104:107], v3 offset:32768
  s_add_u32 m0, s59, 32768
  s_add_u32 s66, s64, 204800
  v_mfma_f32_16x16x32_bf16 v[60:63], v[112:115], a[244:247], v[60:63]
  buffer_load_dwordx4 v1, s[16:19], s66 offen offset:0 sc1 lds
  v_mfma_f32_16x16x32_bf16 v[68:71], v[116:119], a[244:247], v[68:71]
  ds_read_b128 v[108:111], v3 offset:33792
  s_waitcnt lgkmcnt(6)
  v_mfma_f32_16x16x32_bf16 v[64:67], v[116:119], a[240:243], v[64:67]
  ds_read_b64_tr_b16 v[194:195], v4 offset:12288
  v_mfma_f32_16x16x32_bf16 v[40:43], v[120:123], a[248:251], v[40:43]
  ds_read_b128 v[112:115], v3 offset:34816
  v_mfma_f32_16x16x32_bf16 v[44:47], v[120:123], a[252:255], v[44:47]
  buffer_load_dwordx4 v17, s[16:19], s66 offen offset:1024 sc1 lds
  v_mfma_f32_16x16x32_bf16 v[52:55], v[124:127], a[252:255], v[52:55]
  ds_read_b128 v[116:119], v3 offset:35840
  s_waitcnt lgkmcnt(6)
  v_mfma_f32_16x16x32_bf16 v[48:51], v[124:127], a[248:251], v[48:51]
  ds_read_b64_tr_b16 v[196:197], v6 offset:8192
  v_mfma_f32_16x16x32_bf16 v[56:59], v[128:131], a[248:251], v[56:59]
  ds_read_b128 v[120:123], v3 offset:36864
  v_mfma_f32_16x16x32_bf16 v[60:63], v[128:131], a[252:255], v[60:63]
  buffer_load_dwordx4 v20, s[16:19], s66 offen offset:2048 sc1 lds
  v_mfma_f32_16x16x32_bf16 v[68:71], v[132:135], a[252:255], v[68:71]
  ds_read_b128 v[124:127], v3 offset:37888
  s_waitcnt lgkmcnt(6)
  v_mfma_f32_16x16x32_bf16 v[64:67], v[132:135], a[248:251], v[64:67]
  ds_read_b64_tr_b16 v[198:199], v6 offset:12288
  v_mfma_f32_16x16x32_bf16 v[40:43], v[104:107], v[136:139], v[40:43]
  ds_read_b128 v[128:131], v3 offset:38912
  v_mfma_f32_16x16x32_bf16 v[44:47], v[104:107], v[140:143], v[44:47]
  buffer_load_dwordx4 v21, s[16:19], s66 offen offset:3072 sc1 lds
  v_mfma_f32_16x16x32_bf16 v[52:55], v[108:111], v[140:143], v[52:55]
  ds_read_b128 v[132:135], v3 offset:39936
  s_waitcnt lgkmcnt(6)
  v_mfma_f32_16x16x32_bf16 v[48:51], v[108:111], v[136:139], v[48:51]
  s_waitcnt vmcnt(12)
  s_barrier
  ds_read_b64_tr_b16 v[200:201], v4 offset:16384
  v_mfma_f32_16x16x32_bf16 v[56:59], v[112:115], v[136:139], v[56:59]
  ds_read_b128 v[104:107], v2 offset:0
  s_add_u32 m0, s58, 65536
  s_mov_b32 s67, 5767168
  v_mfma_f32_16x16x32_bf16 v[60:63], v[112:115], v[140:143], v[60:63]
  buffer_load_dwordx4 v12, s[12:15], s67 offen offset:0  lds
  v_subrev_u32 v37, 81920, v2
  v_mfma_f32_16x16x32_bf16 v[68:71], v[116:119], v[140:143], v[68:71]
  ds_read_b128 v[108:111], v2 offset:1024
  v_min_u32 v37, 880, v37
  s_waitcnt lgkmcnt(6)
  v_mfma_f32_16x16x32_bf16 v[64:67], v[116:119], v[136:139], v[64:67]
  ds_read_b64_tr_b16 v[202:203], v4 offset:20480
  v_lshlrev_b32 v37, 1, v37
  v_mfma_f32_16x16x32_bf16 v[40:43], v[120:123], v[144:147], v[40:43]
  ds_read_b128 v[112:115], v2 offset:2048
  buffer_load_dword v39, v37, s[16:19], s73 offen sc1
  v_mfma_f32_16x16x32_bf16 v[44:47], v[120:123], v[148:151], v[44:47]
  buffer_load_dwordx4 v13, s[12:15], s67 offen offset:1024  lds
  v_mfma_f32_16x16x32_bf16 v[52:55], v[124:127], v[148:151], v[52:55]
  ds_read_b128 v[116:119], v2 offset:3072
  s_waitcnt lgkmcnt(6)
  v_mfma_f32_16x16x32_bf16 v[48:51], v[124:127], v[144:147], v[48:51]
  ds_read_b64_tr_b16 v[204:205], v6 offset:16384
  v_mfma_f32_16x16x32_bf16 v[56:59], v[128:131], v[144:147], v[56:59]
  ds_read_b128 v[120:123], v2 offset:4096
  v_mfma_f32_16x16x32_bf16 v[60:63], v[128:131], v[148:151], v[60:63]
  buffer_load_dwordx4 v14, s[12:15], s67 offen offset:2048  lds
  v_mfma_f32_16x16x32_bf16 v[68:71], v[132:135], v[148:151], v[68:71]
  ds_read_b128 v[124:127], v2 offset:5120
  s_waitcnt lgkmcnt(6)
  v_mfma_f32_16x16x32_bf16 v[64:67], v[132:135], v[144:147], v[64:67]
  ds_read_b64_tr_b16 v[206:207], v6 offset:20480
  v_mfma_f32_16x16x32_bf16 v[40:43], v[104:107], v[152:155], v[40:43]
  ds_read_b128 v[128:131], v2 offset:6144
  v_mfma_f32_16x16x32_bf16 v[44:47], v[104:107], v[156:159], v[44:47]
  buffer_load_dwordx4 v15, s[12:15], s67 offen offset:3072  lds
  v_mfma_f32_16x16x32_bf16 v[52:55], v[108:111], v[156:159], v[52:55]
  ds_read_b128 v[132:135], v2 offset:7168
  s_waitcnt lgkmcnt(6)
  v_mfma_f32_16x16x32_bf16 v[48:51], v[108:111], v[152:155], v[48:51]
  ds_read_b64_tr_b16 v[208:209], v4 offset:24576
  v_mfma_f32_16x16x32_bf16 v[56:59], v[112:115], v[152:155], v[56:59]
  ds_read_b128 v[104:107], v2 offset:8192
  v_mfma_f32_16x16x32_bf16 v[60:63], v[112:115], v[156:159], v[60:63]
  v_mfma_f32_16x16x32_bf16 v[68:71], v[116:119], v[156:159], v[68:71]
  ds_read_b128 v[108:111], v2 offset:9216
  s_waitcnt lgkmcnt(6)
  v_mfma_f32_16x16x32_bf16 v[64:67], v[116:119], v[152:155], v[64:67]
  ds_read_b64_tr_b16 v[210:211], v4 offset:28672
  v_mfma_f32_16x16x32_bf16 v[40:43], v[120:123], v[160:163], v[40:43]
  ds_read_b128 v[112:115], v2 offset:10240
  v_mfma_f32_16x16x32_bf16 v[44:47], v[120:123], v[164:167], v[44:47]
  v_mfma_f32_16x16x32_bf16 v[52:55], v[124:127], v[164:167], v[52:55]
  ds_read_b128 v[116:119], v2 offset:11264
  s_waitcnt lgkmcnt(6)
  v_mfma_f32_16x16x32_bf16 v[48:51], v[124:127], v[160:163], v[48:51]
  ds_read_b64_tr_b16 v[212:213], v6 offset:24576
  v_mfma_f32_16x16x32_bf16 v[56:59], v[128:131], v[160:163], v[56:59]
  ds_read_b128 v[120:123], v2 offset:12288
  v_mfma_f32_16x16x32_bf16 v[60:63], v[128:131], v[164:167], v[60:63]
  v_mfma_f32_16x16x32_bf16 v[68:71], v[132:135], v[164:167], v[68:71]
  ds_read_b128 v[124:127], v2 offset:13312
  s_waitcnt lgkmcnt(6)
  v_mfma_f32_16x16x32_bf16 v[64:67], v[132:135], v[160:163], v[64:67]
  ds_read_b64_tr_b16 v[214:215], v6 offset:28672
  v_mfma_f32_16x16x32_bf16 v[40:43], v[104:107], v[168:171], v[40:43]
  ds_read_b128 v[128:131], v2 offset:14336
  ds_read_b64_tr_b16 v[216:217], v4 offset:32768
  v_mfma_f32_16x16x32_bf16 v[44:47], v[104:107], v[172:175], v[44:47]
  ds_read_b64_tr_b16 v[218:219], v4 offset:36864
  v_mfma_f32_16x16x32_bf16 v[52:55], v[108:111], v[172:175], v[52:55]
  ds_read_b128 v[132:135], v2 offset:15360
  ds_read_b64_tr_b16 v[220:221], v6 offset:32768
  ds_read_b64_tr_b16 v[222:223], v6 offset:36864
  s_waitcnt lgkmcnt(10)
  v_mfma_f32_16x16x32_bf16 v[48:51], v[108:111], v[168:171], v[48:51]
  s_waitcnt vmcnt(9)
  s_barrier
  ds_read_b64_tr_b16 v[224:225], v5 offset:0
  v_mfma_f32_16x16x32_bf16 v[56:59], v[112:115], v[168:171], v[56:59]
  ds_read_b128 v[104:107], v2 offset:16384
  s_add_u32 m0, s58, 0
  s_mov_b32 s67, 6029312
  v_mfma_f32_16x16x32_bf16 v[60:63], v[112:115], v[172:175], v[60:63]
  buffer_load_dwordx4 v12, s[12:15], s67 offen offset:0  lds
  v_mfma_f32_16x16x32_bf16 v[68:71], v[116:119], v[172:175], v[68:71]
  ds_read_b128 v[108:111], v2 offset:17408
  s_waitcnt lgkmcnt(10)
  v_mfma_f32_16x16x32_bf16 v[64:67], v[116:119], v[168:171], v[64:67]
  ds_read_b64_tr_b16 v[226:227], v5 offset:4096
  v_mfma_f32_16x16x32_bf16 v[40:43], v[120:123], v[176:179], v[40:43]
  ds_read_b128 v[112:115], v2 offset:18432
  v_mfma_f32_16x16x32_bf16 v[44:47], v[120:123], v[180:183], v[44:47]
  buffer_load_dwordx4 v13, s[12:15], s67 offen offset:1024  lds
  v_mfma_f32_16x16x32_bf16 v[52:55], v[124:127], v[180:183], v[52:55]
  ds_read_b128 v[116:119], v2 offset:19456
  s_waitcnt lgkmcnt(6)
  v_mfma_f32_16x16x32_bf16 v[48:51], v[124:127], v[176:179], v[48:51]
  ds_read_b64_tr_b16 v[228:229], v7 offset:0
  v_mfma_f32_16x16x32_bf16 v[56:59], v[128:131], v[176:179], v[56:59]
  ds_read_b128 v[120:123], v2 offset:20480
  v_mfma_f32_16x16x32_bf16 v[60:63], v[128:131], v[180:183], v[60:63]
  buffer_load_dwordx4 v14, s[12:15], s67 offen offset:2048  lds
  v_mfma_f32_16x16x32_bf16 v[68:71], v[132:135], v[180:183], v[68:71]
  ds_read_b128 v[124:127], v2 offset:21504
  s_waitcnt lgkmcnt(6)
  v_mfma_f32_16x16x32_bf16 v[64:67], v[132:135], v[176:179], v[64:67]
  ds_read_b64_tr_b16 v[230:231], v7 offset:4096
  v_mfma_f32_16x16x32_bf16 v[40:43], v[104:107], v[184:187], v[40:43]
  ds_read_b128 v[128:131], v2 offset:22528
  v_mfma_f32_16x16x32_bf16 v[44:47], v[104:107], v[188:191], v[44:47]
  buffer_load_dwordx4 v15, s[12:15], s67 offen offset:3072  lds
  v_mfma_f32_16x16x32_bf16 v[52:55], v[108:111], v[188:191], v[52:55]
  ds_read_b128 v[132:135], v2 offset:23552
  s_waitcnt lgkmcnt(6)
  v_mfma_f32_16x16x32_bf16 v[48:51], v[108:111], v[184:187], v[48:51]
  ds_read_b64_tr_b16 v[232:233], v5 offset:8192
  v_mfma_f32_16x16x32_bf16 v[56:59], v[112:115], v[184:187], v[56:59]
  ds_read_b128 v[104:107], v2 offset:24576
  v_mfma_f32_16x16x32_bf16 v[60:63], v[112:115], v[188:191], v[60:63]
  v_mfma_f32_16x16x32_bf16 v[68:71], v[116:119], v[188:191], v[68:71]
  ds_read_b128 v[108:111], v2 offset:25600
  s_waitcnt lgkmcnt(6)
  v_mfma_f32_16x16x32_bf16 v[64:67], v[116:119], v[184:187], v[64:67]
  ds_read_b64_tr_b16 v[234:235], v5 offset:12288
  v_mfma_f32_16x16x32_bf16 v[40:43], v[120:123], v[192:195], v[40:43]
  ds_read_b128 v[112:115], v2 offset:26624
  s_waitcnt vmcnt(7)
  v_cmp_ne_u32 vcc, s57, v39
  s_cbranch_vccnz L_spin_y
L_ret_y:
  s_add_u32 m0, s59, 49152
  s_add_u32 s66, s65, 0
  v_mfma_f32_16x16x32_bf16 v[44:47], v[120:123], v[196:199], v[44:47]
  buffer_load_dwordx4 v1, s[16:19], s66 offen offset:0 sc1 lds
  v_mfma_f32_16x16x32_bf16 v[52:55], v[124:127], v[196:199], v[52:55]
  ds_read_b128 v[116:119], v2 offset:27648
  s_waitcnt lgkmcnt(6)
  v_mfma_f32_16x16x32_bf16 v[48:51], v[124:127], v[192:195], v[48:51]
  ds_read_b64_tr_b16 v[236:237], v7 offset:8192
  v_mfma_f32_16x16x32_bf16 v[56:59], v[128:131], v[192:195], v[56:59]
  ds_read_b128 v[120:123], v2 offset:28672
  v_mfma_f32_16x16x32_bf16 v[60:63], v[128:131], v[196:199], v[60:63]
  buffer_load_dwordx4 v17, s[16:19], s66 offen offset:1024 sc1 lds
  v_mfma_f32_16x16x32_bf16 v[68:71], v[132:135], v[196:199], v[68:71]
  ds_read_b128 v[124:127], v2 offset:29696
  s_waitcnt lgkmcnt(6)
  v_mfma_f32_16x16x32_bf16 v[64:67], v[132:135], v[192:195], v[64:67]
  ds_read_b64_tr_b16 v[238:239], v7 offset:12288
  v_mfma_f32_16x16x32_bf16 v[40:43], v[104:107], v[200:203], v[40:43]
  ds_read_b128 v[128:131], v2 offset:30720
  ds_read_b64_tr_b16 v[240:241], v5 offset:16384
  v_mfma_f32_16x16x32_bf16 v[44:47], v[104:107], v[204:207], v[44:47]
  ds_read_b64_tr_b16 v[242:243], v5 offset:20480
  buffer_load_dwordx4 v20, s[16:19], s66 offen offset:2048 sc1 lds
  v_mfma_f32_16x16x32_bf16 v[52:55], v[108:111], v[204:207], v[52:55]
  ds_read_b128 v[132:135], v2 offset:31744
  ds_read_b64_tr_b16 v[244:245], v7 offset:16384
  ds_read_b64_tr_b16 v[246:247], v7 offset:20480
  s_waitcnt lgkmcnt(10)
  v_mfma_f32_16x16x32_bf16 v[48:51], v[108:111], v[200:203], v[48:51]
  s_waitcnt vmcnt(7)
  s_barrier
  ds_read_b64_tr_b16 v[248:249], v5 offset:24576
  v_mfma_f32_16x16x32_bf16 v[56:59], v[112:115], v[200:203], v[56:59]
  ds_read_b128 v[104:107], v2 offset:32768
  v_mfma_f32_16x16x32_bf16 v[60:63], v[112:115], v[204:207], v[60:63]
  buffer_load_dwordx4 v21, s[16:19], s66 offen offset:3072 sc1 lds
  v_mfma_f32_16x16x32_bf16 v[68:71], v[116:119], v[204:207], v[68:71]
  ds_read_b128 v[108:111], v2 offset:33792
  s_waitcnt lgkmcnt(10)
  v_mfma_f32_16x16x32_bf16 v[64:67], v[116:119], v[200:203], v[64:67]
  ds_read_b64_tr_b16 v[250:251], v5 offset:28672
  v_mfma_f32_16x16x32_bf16 v[40:43], v[120:123], v[208:211], v[40:43]
  ds_read_b128 v[112:115], v2 offset:34816
  s_add_u32 m0, s59, 65536
  s_add_u32 s66, s63, 20480
  v_mfma_f32_16x16x32_bf16 v[44:47], v[120:123], v[212:215], v[44:47]
  buffer_load_dwordx4 v1, s[16:19], s66 offen offset:0 sc1 lds
  v_mfma_f32_16x16x32_bf16 v[52:55], v[124:127], v[212:215], v[52:55]
  ds_read_b128 v[116:119], v2 offset:35840
  s_waitcnt lgkmcnt(6)
  v_mfma_f32_16x16x32_bf16 v[48:51], v[124:127], v[208:211], v[48:51]
  ds_read_b64_tr_b16 v[252:253], v7 offset:24576
  v_mfma_f32_16x16x32_bf16 v[56:59], v[128:131], v[208:211], v[56:59]
  ds_read_b128 v[120:123], v2 offset:36864
  v_mfma_f32_16x16x32_bf16 v[60:63], v[128:131], v[212:215], v[60:63]
  buffer_load_dwordx4 v17, s[16:19], s66 offen offset:1024 sc1 lds
  v_mfma_f32_16x16x32_bf16 v[68:71], v[132:135], v[212:215], v[68:71]
  ds_read_b128 v[124:127], v2 offset:37888
  s_waitcnt lgkmcnt(6)
  v_mfma_f32_16x16x32_bf16 v[64:67], v[132:135], v[208:211], v[64:67]
  ds_read_b64_tr_b16 v[254:255], v7 offset:28672
  v_mfma_f32_16x16x32_bf16 v[40:43], v[104:107], v[216:219], v[40:43]
  ds_read_b128 v[128:131], v2 offset:38912
  v_mfma_f32_16x16x32_bf16 v[44:47], v[104:107], v[220:223], v[44:47]
  buffer_load_dwordx4 v20, s[16:19], s66 offen offset:2048 sc1 lds
  v_mfma_f32_16x16x32_bf16 v[52:55], v[108:111], v[220:223], v[52:55]
  ds_read_b128 v[132:135], v2 offset:39936
  s_waitcnt lgkmcnt(6)
  v_mfma_f32_16x16x32_bf16 v[48:51], v[108:111], v[216:219], v[48:51]
  ds_read_b64_tr_b16 a[0:1], v5 offset:32768
  v_mfma_f32_16x16x32_bf16 v[56:59], v[112:115], v[216:219], v[56:59]
  ds_read_b128 v[104:107], v3 offset:0
  v_mfma_f32_16x16x32_bf16 v[60:63], v[112:115], v[220:223], v[60:63]
  buffer_load_dwordx4 v21, s[16:19], s66 offen offset:3072 sc1 lds
  v_mfma_f32_16x16x32_bf16 v[68:71], v[116:119], v[220:223], v[68:71]
  ds_read_b128 v[108:111], v3 offset:1024
  s_waitcnt lgkmcnt(6)
  v_mfma_f32_16x16x32_bf16 v[64:67], v[116:119], v[216:219], v[64:67]
  ds_read_b64_tr_b16 a[2:3], v5 offset:36864
  v_mfma_f32_16x16x32_bf16 v[40:43], v[120:123], v[224:227], v[40:43]
  ds_read_b128 v[112:115], v3 offset:2048
  s_add_u32 m0, s59, 0
  s_add_u32 s66, s63, 30720
  v_mfma_f32_16x16x32_bf16 v[44:47], v[120:123], v[228:231], v[44:47]
  buffer_load_dwordx4 v1, s[16:19], s66 offen offset:0 sc1 lds
  v_mfma_f32_16x16x32_bf16 v[52:55], v[124:127], v[228:231], v[52:55]
  ds_read_b128 v[116:119], v3 offset:3072
  s_waitcnt lgkmcnt(6)
  v_mfma_f32_16x16x32_bf16 v[48:51], v[124:127], v[224:227], v[48:51]
  ds_read_b64_tr_b16 a[4:5], v7 offset:32768
  v_mfma_f32_16x16x32_bf16 v[56:59], v[128:131], v[224:227], v[56:59]
  ds_read_b128 v[120:123], v3 offset:4096
  v_mfma_f32_16x16x32_bf16 v[60:63], v[128:131], v[228:231], v[60:63]
  buffer_load_dwordx4 v17, s[16:19], s66 offen offset:1024 sc1 lds
  v_mfma_f32_16x16x32_bf16 v[68:71], v[132:135], v[228:231], v[68:71]
  ds_read_b128 v[124:127], v3 offset:5120
  s_waitcnt lgkmcnt(6)
  v_mfma_f32_16x16x32_bf16 v[64:67], v[132:135], v[224:227], v[64:67]
  ds_read_b64_tr_b16 a[6:7], v7 offset:36864
  v_mfma_f32_16x16x32_bf16 v[40:43], v[104:107], v[232:235], v[40:43]
  ds_read_b128 v[128:131], v3 offset:6144
  v_mfma_f32_16x16x32_bf16 v[44:47], v[104:107], v[236:239], v[44:47]
  buffer_load_dwordx4 v20, s[16:19], s66 offen offset:2048 sc1 lds
  v_mfma_f32_16x16x32_bf16 v[52:55], v[108:111], v[236:239], v[52:55]
  ds_read_b128 v[132:135], v3 offset:7168
  s_waitcnt lgkmcnt(6)
  v_mfma_f32_16x16x32_bf16 v[48:51], v[108:111], v[232:235], v[48:51]
  s_waitcnt vmcnt(7)
  s_barrier
  ds_read_b64_tr_b16 a[8:9], v4 offset:0
  v_mfma_f32_16x16x32_bf16 v[56:59], v[112:115], v[232:235], v[56:59]
  v_lshlrev_b32 v24, 16, v18
  v_lshlrev_b32 v25, 16, v18
  ds_read_b128 v[104:107], v3 offset:8192
  v_mfma_f32_16x16x32_bf16 v[60:63], v[112:115], v[236:239], v[60:63]
  v_lshlrev_b32 v26, 16, v18
  v_lshlrev_b32 v27, 16, v18
  buffer_load_dwordx4 v21, s[16:19], s66 offen offset:3072 sc1 lds
  v_mfma_f32_16x16x32_bf16 v[68:71], v[116:119], v[236:239], v[68:71]
  v_and_b32 v28, 0xffff0000, v18
  v_and_b32 v29, 0xffff0000, v18
  ds_read_b128 v[108:111], v3 offset:9216
  s_waitcnt lgkmcnt(6)
  v_mfma_f32_16x16x32_bf16 v[64:67], v[116:119], v[232:235], v[64:67]
  v_and_b32 v30, 0xffff0000, v18
  v_and_b32 v31, 0xffff0000, v18
  ds_read_b64_tr_b16 a[10:11], v4 offset:4096
  v_mfma_f32_16x16x32_bf16 v[40:43], v[120:123], v[240:243], v[40:43]
  ds_read_b128 v[112:115], v3 offset:10240
  s_add_u32 m0, s58, 16384
  s_mov_b32 s67, 6291456
  v_mfma_f32_16x16x32_bf16 v[44:47], v[120:123], v[244:247], v[44:47]
  buffer_load_dwordx4 v12, s[12:15], s67 offen offset:0  lds
  v_mfma_f32_16x16x32_bf16 v[52:55], v[124:127], v[244:247], v[52:55]
  ds_read_b128 v[116:119], v3 offset:11264
  s_waitcnt lgkmcnt(6)
  v_mfma_f32_16x16x32_bf16 v[48:51], v[124:127], v[240:243], v[48:51]
  ds_read_b64_tr_b16 a[12:13], v6 offset:0
  v_mfma_f32_16x16x32_bf16 v[56:59], v[128:131], v[240:243], v[56:59]
  ds_read_b128 v[120:123], v3 offset:12288
  v_mfma_f32_16x16x32_bf16 v[60:63], v[128:131], v[244:247], v[60:63]
  buffer_load_dwordx4 v13, s[12:15], s67 offen offset:1024  lds
  v_mfma_f32_16x16x32_bf16 v[68:71], v[132:135], v[244:247], v[68:71]
  ds_read_b128 v[124:127], v3 offset:13312
  s_waitcnt lgkmcnt(6)
  v_mfma_f32_16x16x32_bf16 v[64:67], v[132:135], v[240:243], v[64:67]
  ds_read_b64_tr_b16 a[14:15], v6 offset:4096
  v_mfma_f32_16x16x32_bf16 v[72:75], v[104:107], a[16:19], v[24:27]
  ds_read_b128 v[128:131], v3 offset:14336
  v_mfma_f32_16x16x32_bf16 v[76:79], v[104:107], a[20:23], v[28:31]
  buffer_load_dwordx4 v14, s[12:15], s67 offen offset:2048  lds
  v_mfma_f32_16x16x32_bf16 v[84:87], v[108:111], a[20:23], v[28:31]
  ds_read_b128 v[132:135], v3 offset:15360
  s_waitcnt lgkmcnt(6)
  v_mfma_f32_16x16x32_bf16 v[80:83], v[108:111], a[16:19], v[24:27]
  v_mfma_f32_16x16x32_bf16 v[88:91], v[112:115], a[16:19], v[24:27]
  ds_read_b128 v[104:107], v3 offset:16384
  v_mfma_f32_16x16x32_bf16 v[92:95], v[112:115], a[20:23], v[28:31]
  buffer_load_dwordx4 v15, s[12:15], s67 offen offset:3072  lds
  v_mfma_f32_16x16x32_bf16 v[100:103], v[116:119], a[20:23], v[28:31]
  ds_read_b128 v[108:111], v3 offset:17408
  s_waitcnt lgkmcnt(5)
  v_mfma_f32_16x16x32_bf16 v[96:99], v[116:119], a[16:19], v[24:27]
  v_mfma_f32_16x16x32_bf16 v[72:75], v[120:123], a[24:27], v[72:75]
  ds_read_b128 v[112:115], v3 offset:18432
  s_add_u32 m0, s59, 16384
  s_add_u32 s66, s63, 40960
  v_mfma_f32_16x16x32_bf16 v[76:79], v[120:123], a[28:31], v[76:79]
  buffer_load_dwordx4 v1, s[16:19], s66 offen offset:0 sc1 lds
  v_mfma_f32_16x16x32_bf16 v[84:87], v[124:127], a[28:31], v[84:87]
  ds_read_b128 v[116:119], v3 offset:19456
  s_waitcnt lgkmcnt(4)
  v_mfma_f32_16x16x32_bf16 v[80:83], v[124:127], a[24:27], v[80:83]
  ds_read_b64_tr_b16 a[16:17], v4 offset:8192
  v_mfma_f32_16x16x32_bf16 v[88:91], v[128:131], a[24:27], v[88:91]
  ds_read_b128 v[120:123], v3 offset:20480
  v_mfma_f32_16x16x32_bf16 v[92:95], v[128:131], a[28:31], v[92:95]
  buffer_load_dwordx4 v17, s[16:19], s66 offen offset:1024 sc1 lds
  v_mfma_f32_16x16x32_bf16 v[100:103], v[132:135], a[28:31], v[100:103]
  ds_read_b128 v[124:127], v3 offset:21504
  s_waitcnt lgkmcnt(5)
  v_mfma_f32_16x16x32_bf16 v[96:99], v[132:135], a[24:27], v[96:99]
  ds_read_b64_tr_b16 a[18:19], v4 offset:12288
  v_mfma_f32_16x16x32_bf16 v[72:75], v[104:107], a[32:35], v[72:75]
  ds_read_b128 v[128:131], v3 offset:22528
  ds_read_b64_tr_b16 a[20:21], v6 offset:8192
  v_mfma_f32_16x16x32_bf16 v[76:79], v[104:107], a[36:39], v[76:79]
  ds_read_b64_tr_b16 a[22:23], v6 offset:12288
  buffer_load_dwordx4 v20, s[16:19], s66 offen offset:2048 sc1 lds
  v_mfma_f32_16x16x32_bf16 v[84:87], v[108:111], a[36:39], v[84:87]
  ds_read_b128 v[132:135], v3 offset:23552
  s_waitcnt lgkmcnt(8)
  v_mfma_f32_16x16x32_bf16 v[80:83], v[108:111], a[32:35], v[80:83]
  s_waitcnt vmcnt(11)
  s_barrier
  v_mfma_f32_16x16x32_bf16 v[88:91], v[112:115], a[32:35], v[88:91]
  ds_read_b128 v[104:107], v3 offset:24576
  v_mfma_f32_16x16x32_bf16 v[92:95], v[112:115], a[36:39], v[92:95]
  buffer_load_dwordx4 v21, s[16:19], s66 offen offset:3072 sc1 lds
  v_mfma_f32_16x16x32_bf16 v[100:103], v[116:119], a[36:39], v[100:103]
  ds_read_b128 v[108:111], v3 offset:25600
  s_waitcnt lgkmcnt(7)
  v_mfma_f32_16x16x32_bf16 v[96:99], v[116:119], a[32:35], v[96:99]
  v_mfma_f32_16x16x32_bf16 v[72:75], v[120:123], a[40:43], v[72:75]
  ds_read_b128 v[112:115], v3 offset:26624
  s_add_u32 m0, s58, 32768
  s_mov_b32 s67, 6553600
  v_mfma_f32_16x16x32_bf16 v[76:79], v[120:123], a[44:47], v[76:79]
  buffer_load_dwordx4 v12, s[12:15], s67 offen offset:0  lds
  v_mfma_f32_16x16x32_bf16 v[84:87], v[124:127], a[44:47], v[84:87]
  ds_read_b128 v[116:119], v3 offset:27648
  s_waitcnt lgkmcnt(4)
  v_mfma_f32_16x16x32_bf16 v[80:83], v[124:127], a[40:43], v[80:83]
  v_mfma_f32_16x16x32_bf16 v[88:91], v[128:131], a[40:43], v[88:91]
  ds_read_b128 v[120:123], v3 offset:28672
  v_mfma_f32_16x16x32_bf16 v[92:95], v[128:131], a[44:47], v[92:95]
  buffer_load_dwordx4 v13, s[12:15], s67 offen offset:1024  lds
  v_mfma_f32_16x16x32_bf16 v[100:103], v[132:135], a[44:47], v[100:103]
  ds_read_b128 v[124:127], v3 offset:29696
  s_waitcnt lgkmcnt(4)
  v_mfma_f32_16x16x32_bf16 v[96:99], v[132:135], a[40:43], v[96:99]
  v_mfma_f32_16x16x32_bf16 v[40:43], v[104:107], v[248:251], v[40:43]
  ds_read_b128 v[128:131], v3 offset:30720
  v_mfma_f32_16x16x32_bf16 v[44:47], v[104:107], v[252:255], v[44:47]
  buffer_load_dwordx4 v14, s[12:15], s67 offen offset:2048  lds
  v_mfma_f32_16x16x32_bf16 v[52:55], v[108:111], v[252:255], v[52:55]
  ds_read_b128 v[132:135], v3 offset:31744
  s_waitcnt lgkmcnt(4)
  v_mfma_f32_16x16x32_bf16 v[48:51], v[108:111], v[248:251], v[48:51]
  v_mfma_f32_16x16x32_bf16 v[56:59], v[112:115], v[248:251], v[56:59]
  ds_read_b128 v[104:107], v3 offset:32768
  v_mfma_f32_16x16x32_bf16 v[60:63], v[112:115], v[252:255], v[60:63]
  buffer_load_dwordx4 v15, s[12:15], s67 offen offset:3072  lds
  v_mfma_f32_16x16x32_bf16 v[68:71], v[116:119], v[252:255], v[68:71]
  ds_read_b128 v[108:111], v3 offset:33792
  s_waitcnt lgkmcnt(4)
  v_mfma_f32_16x16x32_bf16 v[64:67], v[116:119], v[248:251], v[64:67]
  v_mfma_f32_16x16x32_bf16 v[72:75], v[120:123], a[48:51], v[72:75]
  ds_read_b128 v[112:115], v3 offset:34816
  s_add_u32 m0, s59, 32768
  s_add_u32 s66, s63, 51200
  v_mfma_f32_16x16x32_bf16 v[76:79], v[120:123], a[52:55], v[76:79]
  buffer_load_dwordx4 v1, s[16:19], s66 offen offset:0 sc1 lds
  v_mfma_f32_16x16x32_bf16 v[84:87], v[124:127], a[52:55], v[84:87]
  ds_read_b128 v[116:119], v3 offset:35840
  s_waitcnt lgkmcnt(4)
  v_mfma_f32_16x16x32_bf16 v[80:83], v[124:127], a[48:51], v[80:83]
  v_mfma_f32_16x16x32_bf16 v[88:91], v[128:131], a[48:51], v[88:91]
  ds_read_b128 v[120:123], v3 offset:36864
  v_mfma_f32_16x16x32_bf16 v[92:95], v[128:131], a[52:55], v[92:95]
  buffer_load_dwordx4 v17, s[16:19], s66 offen offset:1024 sc1 lds
  v_mfma_f32_16x16x32_bf16 v[100:103], v[132:135], a[52:55], v[100:103]
  ds_read_b128 v[124:127], v3 offset:37888
  s_waitcnt lgkmcnt(4)
  v_mfma_f32_16x16x32_bf16 v[96:99], v[132:135], a[48:51], v[96:99]
  v_mfma_f32_16x16x32_bf16 v[40:43], v[104:107], a[0:3], v[40:43]
  ds_read_b128 v[128:131], v3 offset:38912
  v_mfma_f32_16x16x32_bf16 v[44:47], v[104:107], a[4:7], v[44:47]
  buffer_load_dwordx4 v20, s[16:19], s66 offen offset:2048 sc1 lds
  v_mfma_f32_16x16x32_bf16 v[52:55], v[108:111], a[4:7], v[52:55]
  ds_read_b128 v[132:135], v3 offset:39936
  s_waitcnt lgkmcnt(4)
  v_mfma_f32_16x16x32_bf16 v[48:51], v[108:111], a[0:3], v[48:51]
  s_waitcnt vmcnt(11)
  s_barrier
  ds_read_b64_tr_b16 a[24:25], v4 offset:16384
  v_mfma_f32_16x16x32_bf16 v[56:59], v[112:115], a[0:3], v[56:59]
  ds_read_b128 v[104:107], v2 offset:0
  v_mfma_f32_16x16x32_bf16 v[60:63], v[112:115], a[4:7], v[60:63]
  buffer_load_dwordx4 v21, s[16:19], s66 offen offset:3072 sc1 lds
  v_mfma_f32_16x16x32_bf16 v[68:71], v[116:119], a[4:7], v[68:71]
  ds_read_b128 v[108:111], v2 offset:1024
  s_waitcnt lgkmcnt(5)
  v_mfma_f32_16x16x32_bf16 v[64:67], v[116:119], a[0:3], v[64:67]
  ds_read_b64_tr_b16 a[26:27], v4 offset:20480
  v_mfma_f32_16x16x32_bf16 v[72:75], v[120:123], a[56:59], v[72:75]
  ds_read_b128 v[112:115], v2 offset:2048
  s_add_u32 m0, s58, 49152
  s_mov_b32 s67, 6815744
  v_mfma_f32_16x16x32_bf16 v[76:79], v[120:123], a[60:63], v[76:79]
  buffer_load_dwordx4 v12, s[12:15], s67 offen offset:0  lds
  v_mfma_f32_16x16x32_bf16 v[84:87], v[124:127], a[60:63], v[84:87]
  ds_read_b128 v[116:119], v2 offset:3072
  s_waitcnt lgkmcnt(6)
  v_mfma_f32_16x16x32_bf16 v[80:83], v[124:127], a[56:59], v[80:83]
  ds_read_b64_tr_b16 a[28:29], v6 offset:16384
  v_mfma_f32_16x16x32_bf16 v[88:91], v[128:131], a[56:59], v[88:91]
  ds_read_b128 v[120:123], v2 offset:4096
  v_mfma_f32_16x16x32_bf16 v[92:95], v[128:131], a[60:63], v[92:95]
  buffer_load_dwordx4 v13, s[12:15], s67 offen offset:1024  lds
  v_mfma_f32_16x16x32_bf16 v[100:103], v[132:135], a[60:63], v[100:103]
  ds_read_b128 v[124:127], v2 offset:5120
  s_waitcnt lgkmcnt(6)
  v_mfma_f32_16x16x32_bf16 v[96:99], v[132:135], a[56:59], v[96:99]
  ds_read_b64_tr_b16 a[30:31], v6 offset:20480
L_mark7:
  s_cbranch_execz L_touched
  v_mfma_f32_16x16x32_bf16 v[40:43], v[104:107], a[8:11], v[40:43]
  ds_read_b128 v[128:131], v2 offset:6144
  v_mfma_f32_16x16x32_bf16 v[44:47], v[104:107], a[12:15], v[44:47]
  buffer_load_dwordx4 v14, s[12:15], s67 offen offset:2048  lds
  v_mfma_f32_16x16x32_bf16 v[52:55], v[108:111], a[12:15], v[52:55]
  ds_read_b128 v[132:135], v2 offset:7168
  s_waitcnt lgkmcnt(6)
  v_mfma_f32_16x16x32_bf16 v[48:51], v[108:111], a[8:11], v[48:51]
  ds_read_b64_tr_b16 a[32:33], v4 offset:24576
  v_mfma_f32_16x16x32_bf16 v[56:59], v[112:115], a[8:11], v[56:59]
  ds_read_b128 v[104:107], v2 offset:8192
  v_mfma_f32_16x16x32_bf16 v[60:63], v[112:115], a[12:15], v[60:63]
  buffer_load_dwordx4 v15, s[12:15], s67 offen offset:3072  lds
  v_mfma_f32_16x16x32_bf16 v[68:71], v[116:119], a[12:15], v[68:71]
  ds_read_b128 v[108:111], v2 offset:9216
  s_waitcnt lgkmcnt(6)
  v_mfma_f32_16x16x32_bf16 v[64:67], v[116:119], a[8:11], v[64:67]
  ds_read_b64_tr_b16 a[34:35], v4 offset:28672
  v_mfma_f32_16x16x32_bf16 v[72:75], v[120:123], a[64:67], v[72:75]
  ds_read_b128 v[112:115], v2 offset:10240
  s_add_u32 m0, s59, 49152
  s_add_u32 s66, s63, 61440
  v_mfma_f32_16x16x32_bf16 v[76:79], v[120:123], a[68:71], v[76:79]
  buffer_load_dwordx4 v1, s[16:19], s66 offen offset:0 sc1 lds
  v_mfma_f32_16x16x32_bf16 v[84:87], v[124:127], a[68:71], v[84:87]
  ds_read_b128 v[116:119], v2 offset:11264
  s_waitcnt lgkmcnt(6)
  v_mfma_f32_16x16x32_bf16 v[80:83], v[124:127], a[64:67], v[80:83]
  ds_read_b64_tr_b16 a[36:37], v6 offset:24576
  v_mfma_f32_16x16x32_bf16 v[88:91], v[128:131], a[64:67], v[88:91]
  ds_read_b128 v[120:123], v2 offset:12288
  v_mfma_f32_16x16x32_bf16 v[92:95], v[128:131], a[68:71], v[92:95]
  buffer_load_dwordx4 v17, s[16:19], s66 offen offset:1024 sc1 lds
  v_mfma_f32_16x16x32_bf16 v[100:103], v[132:135], a[68:71], v[100:103]
  ds_read_b128 v[124:127], v2 offset:13312
  s_waitcnt lgkmcnt(6)
  v_mfma_f32_16x16x32_bf16 v[96:99], v[132:135], a[64:67], v[96:99]
  ds_read_b64_tr_b16 a[38:39], v6 offset:28672
  v_mfma_f32_16x16x32_bf16 v[40:43], v[104:107], a[16:19], v[40:43]
  ds_read_b128 v[128:131], v2 offset:14336
  v_mfma_f32_16x16x32_bf16 v[44:47], v[104:107], a[20:23], v[44:47]
  buffer_load_dwordx4 v20, s[16:19], s66 offen offset:2048 sc1 lds
  v_mfma_f32_16x16x32_bf16 v[52:55], v[108:111], a[20:23], v[52:55]
  ds_read_b128 v[132:135], v2 offset:15360
  s_waitcnt lgkmcnt(6)
  v_mfma_f32_16x16x32_bf16 v[48:51], v[108:111], a[16:19], v[48:51]
  s_waitcnt vmcnt(11)
  s_barrier
  ds_read_b64_tr_b16 a[40:41], v4 offset:32768
  v_mfma_f32_16x16x32_bf16 v[56:59], v[112:115], a[16:19], v[56:59]
  ds_read_b128 v[104:107], v2 offset:16384
  v_mfma_f32_16x16x32_bf16 v[60:63], v[112:115], a[20:23], v[60:63]
  buffer_load_dwordx4 v21, s[16:19], s66 offen offset:3072 sc1 lds
  v_mfma_f32_16x16x32_bf16 v[68:71], v[116:119], a[20:23], v[68:71]
  ds_read_b128 v[108:111], v2 offset:17408
  s_waitcnt lgkmcnt(6)
  v_mfma_f32_16x16x32_bf16 v[64:67], v[116:119], a[16:19], v[64:67]
  ds_read_b64_tr_b16 a[42:43], v4 offset:36864
  v_mfma_f32_16x16x32_bf16 v[72:75], v[120:123], a[72:75], v[72:75]
  ds_read_b128 v[112:115], v2 offset:18432
  s_add_u32 m0, s58, 65536
  s_mov_b32 s67, 7077888
  v_mfma_f32_16x16x32_bf16 v[76:79], v[120:123], a[76:79], v[76:79]
  buffer_load_dwordx4 v12, s[12:15], s67 offen offset:0  lds
  v_mfma_f32_16x16x32_bf16 v[84:87], v[124:127], a[76:79], v[84:87]
  ds_read_b128 v[116:119], v2 offset:19456
  s_waitcnt lgkmcnt(6)
  v_mfma_f32_16x16x32_bf16 v[80:83], v[124:127], a[72:75], v[80:83]
  ds_read_b64_tr_b16 a[44:45], v6 offset:32768
  v_mfma_f32_16x16x32_bf16 v[88:91], v[128:131], a[72:75], v[88:91]
  ds_read_b128 v[120:123], v2 offset:20480
  v_mfma_f32_16x16x32_bf16 v[92:95], v[128:131], a[76:79], v[92:95]
  buffer_load_dwordx4 v13, s[12:15], s67 offen offset:1024  lds
  v_mfma_f32_16x16x32_bf16 v[100:103], v[132:135], a[76:79], v[100:103]
  ds_read_b128 v[124:127], v2 offset:21504
  s_waitcnt lgkmcnt(6)
  v_mfma_f32_16x16x32_bf16 v[96:99], v[132:135], a[72:75], v[96:99]
  ds_read_b64_tr_b16 a[46:47], v6 offset:36864
  v_mfma_f32_16x16x32_bf16 v[40:43], v[104:107], a[24:27], v[40:43]
  ds_read_b128 v[128:131], v2 offset:22528
  v_mfma_f32_16x16x32_bf16 v[44:47], v[104:107], a[28:31], v[44:47]
  buffer_load_dwordx4 v14, s[12:15], s67 offen offset:2048  lds
  v_mfma_f32_16x16x32_bf16 v[52:55], v[108:111], a[28:31], v[52:55]
  ds_read_b128 v[132:135], v2 offset:23552
  s_waitcnt lgkmcnt(6)
  v_mfma_f32_16x16x32_bf16 v[48:51], v[108:111], a[24:27], v[48:51]
  ds_read_b64_tr_b16 a[48:49], v5 offset:0
  v_mfma_f32_16x16x32_bf16 v[56:59], v[112:115], a[24:27], v[56:59]
  ds_read_b128 v[104:107], v2 offset:24576
  v_mfma_f32_16x16x32_bf16 v[60:63], v[112:115], a[28:31], v[60:63]
  buffer_load_dwordx4 v15, s[12:15], s67 offen offset:3072  lds
  v_mfma_f32_16x16x32_bf16 v[68:71], v[116:119], a[28:31], v[68:71]
  ds_read_b128 v[108:111], v2 offset:25600
  s_waitcnt lgkmcnt(6)
  v_mfma_f32_16x16x32_bf16 v[64:67], v[116:119], a[24:27], v[64:67]
  ds_read_b64_tr_b16 a[50:51], v5 offset:4096
  v_mfma_f32_16x16x32_bf16 v[72:75], v[120:123], a[80:83], v[72:75]
  ds_read_b128 v[112:115], v2 offset:26624
  s_add_u32 m0, s59, 65536
  s_add_u32 s66, s63, 71680
  v_mfma_f32_16x16x32_bf16 v[76:79], v[120:123], a[84:87], v[76:79]
  buffer_load_dwordx4 v1, s[16:19], s66 offen offset:0 sc1 lds
  v_mfma_f32_16x16x32_bf16 v[84:87], v[124:127], a[84:87], v[84:87]
  ds_read_b128 v[116:119], v2 offset:27648
  s_waitcnt lgkmcnt(6)
  v_mfma_f32_16x16x32_bf16 v[80:83], v[124:127], a[80:83], v[80:83]
  ds_read_b64_tr_b16 a[52:53], v7 offset:0
  v_mfma_f32_16x16x32_bf16 v[88:91], v[128:131], a[80:83], v[88:91]
  ds_read_b128 v[120:123], v2 offset:28672
  v_mfma_f32_16x16x32_bf16 v[92:95], v[128:131], a[84:87], v[92:95]
  buffer_load_dwordx4 v17, s[16:19], s66 offen offset:1024 sc1 lds
  v_mfma_f32_16x16x32_bf16 v[100:103], v[132:135], a[84:87], v[100:103]
  ds_read_b128 v[124:127], v2 offset:29696
  s_waitcnt lgkmcnt(6)
  v_mfma_f32_16x16x32_bf16 v[96:99], v[132:135], a[80:83], v[96:99]
  ds_read_b64_tr_b16 a[54:55], v7 offset:4096
  v_mfma_f32_16x16x32_bf16 v[40:43], v[104:107], a[32:35], v[40:43]
  ds_read_b128 v[128:131], v2 offset:30720
  v_mfma_f32_16x16x32_bf16 v[44:47], v[104:107], a[36:39], v[44:47]
  buffer_load_dwordx4 v20, s[16:19], s66 offen offset:2048 sc1 lds
  v_mfma_f32_16x16x32_bf16 v[52:55], v[108:111], a[36:39], v[52:55]
  ds_read_b128 v[132:135], v2 offset:31744
  s_waitcnt lgkmcnt(6)
  v_mfma_f32_16x16x32_bf16 v[48:51], v[108:111], a[32:35], v[48:51]
  s_waitcnt vmcnt(11)
  s_barrier
  ds_read_b64_tr_b16 a[56:57], v5 offset:8192
  v_mfma_f32_16x16x32_bf16 v[56:59], v[112:115], a[32:35], v[56:59]
  ds_read_b128 v[104:107], v2 offset:32768
  v_mfma_f32_16x16x32_bf16 v[60:63], v[112:115], a[36:39], v[60:63]
  buffer_load_dwordx4 v21, s[16:19], s66 offen offset:3072 sc1 lds
  v_mfma_f32_16x16x32_bf16 v[68:71], v[116:119], a[36:39], v[68:71]
  ds_read_b128 v[108:111], v2 offset:33792
  s_waitcnt lgkmcnt(6)
  v_mfma_f32_16x16x32_bf16 v[64:67], v[116:119], a[32:35], v[64:67]
  ds_read_b64_tr_b16 a[58:59], v5 offset:12288
  v_mfma_f32_16x16x32_bf16 v[72:75], v[120:123], a[88:91], v[72:75]
  ds_read_b128 v[112:115], v2 offset:34816
  s_add_u32 m0, s59, 0
  s_add_u32 s66, s65, 81920
  v_mfma_f32_16x16x32_bf16 v[76:79], v[120:123], a[92:95], v[76:79]
  buffer_load_dwordx4 v1, s[16:19], s66 offen offset:0 sc1 lds
  v_mfma_f32_16x16x32_bf16 v[84:87], v[124:127], a[92:95], v[84:87]
  ds_read_b128 v[116:119], v2 offset:35840
  s_waitcnt lgkmcnt(6)
  v_mfma_f32_16x16x32_bf16 v[80:83], v[124:127], a[88:91], v[80:83]
  ds_read_b64_tr_b16 a[60:61], v7 offset:8192
  v_mfma_f32_16x16x32_bf16 v[88:91], v[128:131], a[88:91], v[88:91]
  ds_read_b128 v[120:123], v2 offset:36864
  v_mfma_f32_16x16x32_bf16 v[92:95], v[128:131], a[92:95], v[92:95]
  buffer_load_dwordx4 v17, s[16:19], s66 offen offset:1024 sc1 lds
  v_mfma_f32_16x16x32_bf16 v[100:103], v[132:135], a[92:95], v[100:103]
  ds_read_b128 v[124:127], v2 offset:37888
  s_waitcnt lgkmcnt(6)
  v_mfma_f32_16x16x32_bf16 v[96:99], v[132:135], a[88:91], v[96:99]
  ds_read_b64_tr_b16 a[62:63], v7 offset:12288
  v_mfma_f32_16x16x32_bf16 v[40:43], v[104:107], a[40:43], v[40:43]
  ds_read_b128 v[128:131], v2 offset:38912
  v_mfma_f32_16x16x32_bf16 v[44:47], v[104:107], a[44:47], v[44:47]
  buffer_load_dwordx4 v20, s[16:19], s66 offen offset:2048 sc1 lds
  v_mfma_f32_16x16x32_bf16 v[52:55], v[108:111], a[44:47], v[52:55]
  ds_read_b128 v[132:135], v2 offset:39936
  s_waitcnt lgkmcnt(6)
  v_mfma_f32_16x16x32_bf16 v[48:51], v[108:111], a[40:43], v[48:51]
  ds_read_b64_tr_b16 a[64:65], v5 offset:16384
  v_mfma_f32_16x16x32_bf16 v[56:59], v[112:115], a[40:43], v[56:59]
  ds_read_b128 v[104:107], v3 offset:0
  v_mfma_f32_16x16x32_bf16 v[60:63], v[112:115], a[44:47], v[60:63]
  buffer_load_dwordx4 v21, s[16:19], s66 offen offset:3072 sc1 lds
  v_mfma_f32_16x16x32_bf16 v[68:71], v[116:119], a[44:47], v[68:71]
  ds_read_b128 v[108:111], v3 offset:1024
  s_waitcnt lgkmcnt(6)
  v_mfma_f32_16x16x32_bf16 v[64:67], v[116:119], a[40:43], v[64:67]
  ds_read_b64_tr_b16 a[66:67], v5 offset:20480
  v_mfma_f32_16x16x32_bf16 v[72:75], v[120:123], a[96:99], v[72:75]
  ds_read_b128 v[112:115], v3 offset:2048
  v_mfma_f32_16x16x32_bf16 v[76:79], v[120:123], a[100:103], v[76:79]
  v_mfma_f32_16x16x32_bf16 v[84:87], v[124:127], a[100:103], v[84:87]
  ds_read_b128 v[116:119], v3 offset:3072
  s_waitcnt lgkmcnt(6)
  v_mfma_f32_16x16x32_bf16 v[80:83], v[124:127], a[96:99], v[80:83]
  ds_read_b64_tr_b16 a[68:69], v7 offset:16384
  v_mfma_f32_16x16x32_bf16 v[88:91], v[128:131], a[96:99], v[88:91]
  ds_read_b128 v[120:123], v3 offset:4096
  v_mfma_f32_16x16x32_bf16 v[92:95], v[128:131], a[100:103], v[92:95]
  v_mfma_f32_16x16x32_bf16 v[100:103], v[132:135], a[100:103], v[100:103]
  ds_read_b128 v[124:127], v3 offset:5120
  s_waitcnt lgkmcnt(6)
  v_mfma_f32_16x16x32_bf16 v[96:99], v[132:135], a[96:99], v[96:99]
  ds_read_b64_tr_b16 a[70:71], v7 offset:20480
  v_mfma_f32_16x16x32_bf16 v[40:43], v[104:107], a[48:51], v[40:43]
  ds_read_b128 v[128:131], v3 offset:6144
  v_mfma_f32_16x16x32_bf16 v[44:47], v[104:107], a[52:55], v[44:47]
  v_mfma_f32_16x16x32_bf16 v[52:55], v[108:111], a[52:55], v[52:55]
  ds_read_b128 v[132:135], v3 offset:7168
  s_waitcnt lgkmcnt(6)
  v_mfma_f32_16x16x32_bf16 v[48:51], v[108:111], a[48:51], v[48:51]
  s_waitcnt vmcnt(8)
  s_barrier
  ds_read_b64_tr_b16 a[72:73], v5 offset:24576
  v_mfma_f32_16x16x32_bf16 v[56:59], v[112:115], a[48:51], v[56:59]
  ds_read_b128 v[104:107], v3 offset:8192
  s_add_u32 m0, s59, 16384
  s_add_u32 s66, s65, 102400
  v_mfma_f32_16x16x32_bf16 v[60:63], v[112:115], a[52:55], v[60:63]
  buffer_load_dwordx4 v1, s[16:19], s66 offen offset:0 sc1 lds
  v_mfma_f32_16x16x32_bf16 v[68:71], v[116:119], a[52:55], v[68:71]
  ds_read_b128 v[108:111], v3 offset:9216
  s_waitcnt lgkmcnt(6)
  v_mfma_f32_16x16x32_bf16 v[64:67], v[116:119], a[48:51], v[64:67]
  ds_read_b64_tr_b16 a[74:75], v5 offset:28672
  v_mfma_f32_16x16x32_bf16 v[72:75], v[120:123], a[104:107], v[72:75]
  ds_read_b128 v[112:115], v3 offset:10240
  v_mfma_f32_16x16x32_bf16 v[76:79], v[120:123], a[108:111], v[76:79]
  buffer_load_dwordx4 v17, s[16:19], s66 offen offset:1024 sc1 lds
  v_mfma_f32_16x16x32_bf16 v[84:87], v[124:127], a[108:111], v[84:87]
  ds_read_b128 v[116:119], v3 offset:11264
  s_waitcnt lgkmcnt(6)
  v_mfma_f32_16x16x32_bf16 v[80:83], v[124:127], a[104:107], v[80:83]
  ds_read_b64_tr_b16 a[76:77], v7 offset:24576
  v_mfma_f32_16x16x32_bf16 v[88:91], v[128:131], a[104:107], v[88:91]
  ds_read_b128 v[120:123], v3 offset:12288
  v_mfma_f32_16x16x32_bf16 v[92:95], v[128:131], a[108:111], v[92:95]
  buffer_load_dwordx4 v20, s[16:19], s66 offen offset:2048 sc1 lds
  v_mfma_f32_16x16x32_bf16 v[100:103], v[132:135], a[108:111], v[100:103]
  ds_read_b128 v[124:127], v3 offset:13312
  s_waitcnt lgkmcnt(6)
  v_mfma_f32_16x16x32_bf16 v[96:99], v[132:135], a[104:107], v[96:99]
  ds_read_b64_tr_b16 a[78:79], v7 offset:28672
  v_mfma_f32_16x16x32_bf16 v[40:43], v[104:107], a[56:59], v[40:43]
  ds_read_b128 v[128:131], v3 offset:14336
  v_mfma_f32_16x16x32_bf16 v[44:47], v[104:107], a[60:63], v[44:47]
  buffer_load_dwordx4 v21, s[16:19], s66 offen offset:3072 sc1 lds
  v_mfma_f32_16x16x32_bf16 v[52:55], v[108:111], a[60:63], v[52:55]
  ds_read_b128 v[132:135], v3 offset:15360
  s_waitcnt lgkmcnt(6)
  v_mfma_f32_16x16x32_bf16 v[48:51], v[108:111], a[56:59], v[48:51]
  ds_read_b64_tr_b16 a[80:81], v5 offset:32768
  v_mfma_f32_16x16x32_bf16 v[56:59], v[112:115], a[56:59], v[56:59]
  ds_read_b128 v[104:107], v3 offset:16384
  v_mfma_f32_16x16x32_bf16 v[60:63], v[112:115], a[60:63], v[60:63]
  v_mfma_f32_16x16x32_bf16 v[68:71], v[116:119], a[60:63], v[68:71]
  ds_read_b128 v[108:111], v3 offset:17408
  s_waitcnt lgkmcnt(6)
  v_mfma_f32_16x16x32_bf16 v[64:67], v[116:119], a[56:59], v[64:67]
  ds_read_b64_tr_b16 a[82:83], v5 offset:36864
  v_mfma_f32_16x16x32_bf16 v[72:75], v[120:123], a[112:115], v[72:75]
  ds_read_b128 v[112:115], v3 offset:18432
  v_mfma_f32_16x16x32_bf16 v[76:79], v[120:123], a[116:119], v[76:79]
  v_mfma_f32_16x16x32_bf16 v[84:87], v[124:127], a[116:119], v[84:87]
  ds_read_b128 v[116:119], v3 offset:19456
  s_waitcnt lgkmcnt(6)
  v_mfma_f32_16x16x32_bf16 v[80:83], v[124:127], a[112:115], v[80:83]
  ds_read_b64_tr_b16 a[84:85], v7 offset:32768
  v_mfma_f32_16x16x32_bf16 v[88:91], v[128:131], a[112:115], v[88:91]
  ds_read_b128 v[120:123], v3 offset:20480
  v_mfma_f32_16x16x32_bf16 v[92:95], v[128:131], a[116:119], v[92:95]
  v_mfma_f32_16x16x32_bf16 v[100:103], v[132:135], a[116:119], v[100:103]
  ds_read_b128 v[124:127], v3 offset:21504
  s_waitcnt lgkmcnt(6)
  v_mfma_f32_16x16x32_bf16 v[96:99], v[132:135], a[112:115], v[96:99]
  ds_read_b64_tr_b16 a[86:87], v7 offset:36864
  v_mfma_f32_16x16x32_bf16 v[40:43], v[104:107], a[64:67], v[40:43]
  ds_read_b128 v[128:131], v3 offset:22528
  v_mfma_f32_16x16x32_bf16 v[44:47], v[104:107], a[68:71], v[44:47]
  v_mfma_f32_16x16x32_bf16 v[52:55], v[108:111], a[68:71], v[52:55]
  ds_read_b128 v[132:135], v3 offset:23552
  s_waitcnt lgkmcnt(6)
  v_mfma_f32_16x16x32_bf16 v[48:51], v[108:111], a[64:67], v[48:51]
  s_waitcnt vmcnt(8)
  s_barrier
  v_mfma_f32_16x16x32_bf16 v[56:59], v[112:115], a[64:67], v[56:59]
  ds_read_b128 v[104:107], v3 offset:24576
  s_add_u32 m0, s59, 32768
  s_add_u32 s66, s65, 122880
  v_mfma_f32_16x16x32_bf16 v[60:63], v[112:115], a[68:71], v[60:63]
  buffer_load_dwordx4 v1, s[16:19], s66 offen offset:0 sc1 lds
  v_mfma_f32_16x16x32_bf16 v[68:71], v[116:119], a[68:71], v[68:71]
  ds_read_b128 v[108:111], v3 offset:25600
  s_waitcnt lgkmcnt(5)
  v_mfma_f32_16x16x32_bf16 v[64:67], v[116:119], a[64:67], v[64:67]
  v_mfma_f32_16x16x32_bf16 v[72:75], v[120:123], a[120:123], v[72:75]
  ds_read_b128 v[112:115], v3 offset:26624
  v_mfma_f32_16x16x32_bf16 v[76:79], v[120:123], a[124:127], v[76:79]
  buffer_load_dwordx4 v17, s[16:19], s66 offen offset:1024 sc1 lds
  v_mfma_f32_16x16x32_bf16 v[84:87], v[124:127], a[124:127], v[84:87]
  ds_read_b128 v[116:119], v3 offset:27648
  s_waitcnt lgkmcnt(4)
  v_mfma_f32_16x16x32_bf16 v[80:83], v[124:127], a[120:123], v[80:83]
  v_mfma_f32_16x16x32_bf16 v[88:91], v[128:131], a[120:123], v[88:91]
  ds_read_b128 v[120:123], v3 offset:28672
  v_mfma_f32_16x16x32_bf16 v[92:95], v[128:131], a[124:127], v[92:95]
  buffer_load_dwordx4 v20, s[16:19], s66 offen offset:2048 sc1 lds
  v_mfma_f32_16x16x32_bf16 v[100:103], v[132:135], a[124:127], v[100:103]
  ds_read_b128 v[124:127], v3 offset:29696
  s_waitcnt lgkmcnt(4)
  v_mfma_f32_16x16x32_bf16 v[96:99], v[132:135], a[120:123], v[96:99]
  v_mfma_f32_16x16x32_bf16 v[40:43], v[104:107], a[72:75], v[40:43]
  ds_read_b128 v[128:131], v3 offset:30720
  v_mfma_f32_16x16x32_bf16 v[44:47], v[104:107], a[76:79], v[44:47]
  buffer_load_dwordx4 v21, s[16:19], s66 offen offset:3072 sc1 lds
  v_mfma_f32_16x16x32_bf16 v[52:55], v[108:111], a[76:79], v[52:55]
  ds_read_b128 v[132:135], v3 offset:31744
  s_waitcnt lgkmcnt(4)
  v_mfma_f32_16x16x32_bf16 v[48:51], v[108:111], a[72:75], v[48:51]
  v_mfma_f32_16x16x32_bf16 v[56:59], v[112:115], a[72:75], v[56:59]
  ds_read_b128 v[104:107], v3 offset:32768
  v_mfma_f32_16x16x32_bf16 v[60:63], v[112:115], a[76:79], v[60:63]
  v_mfma_f32_16x16x32_bf16 v[68:71], v[116:119], a[76:79], v[68:71]
  ds_read_b128 v[108:111], v3 offset:33792
  s_waitcnt lgkmcnt(4)
  v_mfma_f32_16x16x32_bf16 v[64:67], v[116:119], a[72:75], v[64:67]
  v_mfma_f32_16x16x32_bf16 v[72:75], v[120:123], a[128:131], v[72:75]
  ds_read_b128 v[112:115], v3 offset:34816
  v_mfma_f32_16x16x32_bf16 v[76:79], v[120:123], a[132:135], v[76:79]
  v_mfma_f32_16x16x32_bf16 v[84:87], v[124:127], a[132:135], v[84:87]
  ds_read_b128 v[116:119], v3 offset:35840
  s_waitcnt lgkmcnt(4)
  v_mfma_f32_16x16x32_bf16 v[80:83], v[124:127], a[128:131], v[80:83]
  v_mfma_f32_16x16x32_bf16 v[88:91], v[128:131], a[128:131], v[88:91]
  ds_read_b128 v[120:123], v3 offset:36864
  v_mfma_f32_16x16x32_bf16 v[92:95], v[128:131], a[132:135], v[92:95]
  v_mfma_f32_16x16x32_bf16 v[100:103], v[132:135], a[132:135], v[100:103]
  ds_read_b128 v[124:127], v3 offset:37888
  s_waitcnt lgkmcnt(4)
  v_mfma_f32_16x16x32_bf16 v[96:99], v[132:135], a[128:131], v[96:99]
  v_mfma_f32_16x16x32_bf16 v[40:43], v[104:107], a[80:83], v[40:43]
  ds_read_b128 v[128:131], v3 offset:38912
  v_mfma_f32_16x16x32_bf16 v[44:47], v[104:107], a[84:87], v[44:47]
  v_mfma_f32_16x16x32_bf16 v[52:55], v[108:111], a[84:87], v[52:55]
  ds_read_b128 v[132:135], v3 offset:39936
  s_waitcnt lgkmcnt(4)
  v_mfma_f32_16x16x32_bf16 v[48:51], v[108:111], a[80:83], v[48:51]
  s_waitcnt vmcnt(8)
  s_barrier
  v_mfma_f32_16x16x32_bf16 v[56:59], v[112:115], a[80:83], v[56:59]
  ds_read_b128 v[104:107], v2 offset:0
  s_add_u32 m0, s59, 49152
  s_add_u32 s66, s65, 143360
  v_mfma_f32_16x16x32_bf16 v[60:63], v[112:115], a[84:87], v[60:63]
  buffer_load_dwordx4 v1, s[16:19], s66 offen offset:0 sc1 lds
  v_mfma_f32_16x16x32_bf16 v[68:71], v[116:119], a[84:87], v[68:71]
  ds_read_b128 v[108:111], v2 offset:1024
  s_waitcnt lgkmcnt(4)
  v_mfma_f32_16x16x32_bf16 v[64:67], v[116:119], a[80:83], v[64:67]
  v_mfma_f32_16x16x32_bf16 v[72:75], v[120:123], a[136:139], v[72:75]
  ds_read_b128 v[112:115], v2 offset:2048
  v_mfma_f32_16x16x32_bf16 v[76:79], v[120:123], a[140:143], v[76:79]
  buffer_load_dwordx4 v17, s[16:19], s66 offen offset:1024 sc1 lds
  v_mfma_f32_16x16x32_bf16 v[84:87], v[124:127], a[140:143], v[84:87]
  ds_read_b128 v[116:119], v2 offset:3072
  v_cvt_pk_bf16_f32 v40, v40, v44
  v_cvt_pk_bf16_f32 v41, v41, v45
  s_waitcnt lgkmcnt(4)
  v_mfma_f32_16x16x32_bf16 v[80:83], v[124:127], a[136:139], v[80:83]
  v_cvt_pk_bf16_f32 v42, v42, v46
  v_cvt_pk_bf16_f32 v43, v43, v47
  v_mfma_f32_16x16x32_bf16 v[88:91], v[128:131], a[136:139], v[88:91]
  ds_read_b128 v[120:123], v2 offset:4096
  v_mfma_f32_16x16x32_bf16 v[92:95], v[128:131], a[140:143], v[92:95]
  buffer_store_dwordx4 v[40:43], v1, s[16:19], s78 offen offset:0 sc1
  buffer_load_dwordx4 v20, s[16:19], s66 offen offset:2048 sc1 lds
  v_mfma_f32_16x16x32_bf16 v[100:103], v[132:135], a[140:143], v[100:103]
  ds_read_b128 v[124:127], v2 offset:5120
  s_waitcnt lgkmcnt(4)
  v_mfma_f32_16x16x32_bf16 v[96:99], v[132:135], a[136:139], v[96:99]
  v_mfma_f32_16x16x32_bf16 v[72:75], v[104:107], a[144:147], v[72:75]
  ds_read_b128 v[128:131], v2 offset:6144
  v_mfma_f32_16x16x32_bf16 v[76:79], v[104:107], a[148:151], v[76:79]
  buffer_load_dwordx4 v21, s[16:19], s66 offen offset:3072 sc1 lds
  v_mfma_f32_16x16x32_bf16 v[84:87], v[108:111], a[148:151], v[84:87]
  ds_read_b128 v[132:135], v2 offset:7168
  s_waitcnt lgkmcnt(4)
  v_mfma_f32_16x16x32_bf16 v[80:83], v[108:111], a[144:147], v[80:83]
  v_mfma_f32_16x16x32_bf16 v[88:91], v[112:115], a[144:147], v[88:91]
  ds_read_b128 v[104:107], v2 offset:8192
  v_mfma_f32_16x16x32_bf16 v[92:95], v[112:115], a[148:151], v[92:95]
  v_mfma_f32_16x16x32_bf16 v[100:103], v[116:119], a[148:151], v[100:103]
  ds_read_b128 v[108:111], v2 offset:9216
  s_waitcnt lgkmcnt(4)
  v_mfma_f32_16x16x32_bf16 v[96:99], v[116:119], a[144:147], v[96:99]
  v_mfma_f32_16x16x32_bf16 v[72:75], v[120:123], a[152:155], v[72:75]
  ds_read_b128 v[112:115], v2 offset:10240
  v_mfma_f32_16x16x32_bf16 v[76:79], v[120:123], a[156:159], v[76:79]
  v_mfma_f32_16x16x32_bf16 v[84:87], v[124:127], a[156:159], v[84:87]
  ds_read_b128 v[116:119], v2 offset:11264
  v_cvt_pk_bf16_f32 v48, v48, v52
  v_cvt_pk_bf16_f32 v49, v49, v53
  s_waitcnt lgkmcnt(4)
  v_mfma_f32_16x16x32_bf16 v[80:83], v[124:127], a[152:155], v[80:83]
  v_cvt_pk_bf16_f32 v50, v50, v54
  v_cvt_pk_bf16_f32 v51, v51, v55
  v_mfma_f32_16x16x32_bf16 v[88:91], v[128:131], a[152:155], v[88:91]
  ds_read_b128 v[120:123], v2 offset:12288
  v_mfma_f32_16x16x32_bf16 v[92:95], v[128:131], a[156:159], v[92:95]
  buffer_store_dwordx4 v[48:51], v17, s[16:19], s78 offen offset:1024 sc1
  v_mfma_f32_16x16x32_bf16 v[100:103], v[132:135], a[156:159], v[100:103]
  ds_read_b128 v[124:127], v2 offset:13312
  s_waitcnt lgkmcnt(4)
  v_mfma_f32_16x16x32_bf16 v[96:99], v[132:135], a[152:155], v[96:99]
  v_mfma_f32_16x16x32_bf16 v[72:75], v[104:107], a[160:163], v[72:75]
  ds_read_b128 v[128:131], v2 offset:14336
  v_mfma_f32_16x16x32_bf16 v[76:79], v[104:107], a[164:167], v[76:79]
  v_mfma_f32_16x16x32_bf16 v[84:87], v[108:111], a[164:167], v[84:87]
  ds_read_b128 v[132:135], v2 offset:15360
  s_waitcnt lgkmcnt(4)
  v_mfma_f32_16x16x32_bf16 v[80:83], v[108:111], a[160:163], v[80:83]
  s_waitcnt vmcnt(10)
  s_barrier
  v_mfma_f32_16x16x32_bf16 v[88:91], v[112:115], a[160:163], v[88:91]
  ds_read_b128 v[104:107], v2 offset:16384
  s_add_u32 m0, s59, 65536
  s_add_u32 s66, s65, 163840
  v_mfma_f32_16x16x32_bf16 v[92:95], v[112:115], a[164:167], v[92:95]
  buffer_load_dwordx4 v1, s[16:19], s66 offen offset:0 sc1 lds
  v_mfma_f32_16x16x32_bf16 v[100:103], v[116:119], a[164:167], v[100:103]
  ds_read_b128 v[108:111], v2 offset:17408
  s_waitcnt lgkmcnt(4)
  v_mfma_f32_16x16x32_bf16 v[96:99], v[116:119], a[160:163], v[96:99]
  v_mfma_f32_16x16x32_bf16 v[72:75], v[120:123], a[168:171], v[72:75]
  ds_read_b128 v[112:115], v2 offset:18432
  v_mfma_f32_16x16x32_bf16 v[76:79], v[120:123], a[172:175], v[76:79]
  buffer_load_dwordx4 v17, s[16:19], s66 offen offset:1024 sc1 lds
  v_mfma_f32_16x16x32_bf16 v[84:87], v[124:127], a[172:175], v[84:87]
  ds_read_b128 v[116:119], v2 offset:19456
  v_cvt_pk_bf16_f32 v56, v56, v60
  v_cvt_pk_bf16_f32 v57, v57, v61
  s_waitcnt lgkmcnt(4)
  v_mfma_f32_16x16x32_bf16 v[80:83], v[124:127], a[168:171], v[80:83]
  v_cvt_pk_bf16_f32 v58, v58, v62
  v_cvt_pk_bf16_f32 v59, v59, v63
  v_mfma_f32_16x16x32_bf16 v[88:91], v[128:131], a[168:171], v[88:91]
  ds_read_b128 v[120:123], v2 offset:20480
  v_mfma_f32_16x16x32_bf16 v[92:95], v[128:131], a[172:175], v[92:95]
  buffer_store_dwordx4 v[56:59], v20, s[16:19], s78 offen offset:2048 sc1
  buffer_load_dwordx4 v20, s[16:19], s66 offen offset:2048 sc1 lds
  v_mfma_f32_16x16x32_bf16 v[100:103], v[132:135], a[172:175], v[100:103]
  ds_read_b128 v[124:127], v2 offset:21504
  s_waitcnt lgkmcnt(4)
  v_mfma_f32_16x16x32_bf16 v[96:99], v[132:135], a[168:171], v[96:99]
  v_mfma_f32_16x16x32_bf16 v[72:75], v[104:107], a[176:179], v[72:75]
  ds_read_b128 v[128:131], v2 offset:22528
  v_mfma_f32_16x16x32_bf16 v[76:79], v[104:107], a[180:183], v[76:79]
  buffer_load_dwordx4 v21, s[16:19], s66 offen offset:3072 sc1 lds
  v_mfma_f32_16x16x32_bf16 v[84:87], v[108:111], a[180:183], v[84:87]
  ds_read_b128 v[132:135], v2 offset:23552
  s_waitcnt lgkmcnt(4)
  v_mfma_f32_16x16x32_bf16 v[80:83], v[108:111], a[176:179], v[80:83]
  v_mfma_f32_16x16x32_bf16 v[88:91], v[112:115], a[176:179], v[88:91]
  ds_read_b128 v[104:107], v2 offset:24576
  v_mfma_f32_16x16x32_bf16 v[92:95], v[112:115], a[180:183], v[92:95]
  v_mfma_f32_16x16x32_bf16 v[100:103], v[116:119], a[180:183], v[100:103]
  ds_read_b128 v[108:111], v2 offset:25600
  s_waitcnt lgkmcnt(4)
  v_mfma_f32_16x16x32_bf16 v[96:99], v[116:119], a[176:179], v[96:99]
  v_mfma_f32_16x16x32_bf16 v[72:75], v[120:123], a[184:187], v[72:75]
  ds_read_b128 v[112:115], v2 offset:26624
  v_mfma_f32_16x16x32_bf16 v[76:79], v[120:123], a[188:191], v[76:79]
  v_mfma_f32_16x16x32_bf16 v[84:87], v[124:127], a[188:191], v[84:87]
  ds_read_b128 v[116:119], v2 offset:27648
  v_cvt_pk_bf16_f32 v64, v64, v68
  v_cvt_pk_bf16_f32 v65, v65, v69
  s_waitcnt lgkmcnt(4)
  v_mfma_f32_16x16x32_bf16 v[80:83], v[124:127], a[184:187], v[80:83]
  v_cvt_pk_bf16_f32 v66, v66, v70
  v_cvt_pk_bf16_f32 v67, v67, v71
  v_mfma_f32_16x16x32_bf16 v[88:91], v[128:131], a[184:187], v[88:91]
  ds_read_b128 v[120:123], v2 offset:28672
  v_mfma_f32_16x16x32_bf16 v[92:95], v[128:131], a[188:191], v[92:95]
  buffer_store_dwordx4 v[64:67], v21, s[16:19], s78 offen offset:3072 sc1
  v_mfma_f32_16x16x32_bf16 v[100:103], v[132:135], a[188:191], v[100:103]
  ds_read_b128 v[124:127], v2 offset:29696
  s_waitcnt lgkmcnt(4)
  v_mfma_f32_16x16x32_bf16 v[96:99], v[132:135], a[184:187], v[96:99]
  v_mfma_f32_16x16x32_bf16 v[72:75], v[104:107], a[192:195], v[72:75]
  ds_read_b128 v[128:131], v2 offset:30720
  v_mfma_f32_16x16x32_bf16 v[76:79], v[104:107], a[196:199], v[76:79]
  v_mfma_f32_16x16x32_bf16 v[84:87], v[108:111], a[196:199], v[84:87]
  ds_read_b128 v[132:135], v2 offset:31744
  s_waitcnt lgkmcnt(4)
  v_mfma_f32_16x16x32_bf16 v[80:83], v[108:111], a[192:195], v[80:83]
  s_waitcnt vmcnt(12)
  s_barrier
  v_mfma_f32_16x16x32_bf16 v[88:91], v[112:115], a[192:195], v[88:91]
  ds_read_b128 v[104:107], v2 offset:32768
  s_add_u32 m0, s59, 0
  s_add_u32 s66, s65, 184320
  v_mfma_f32_16x16x32_bf16 v[92:95], v[112:115], a[196:199], v[92:95]
  buffer_load_dwordx4 v1, s[16:19], s66 offen offset:0 sc1 lds
  v_mfma_f32_16x16x32_bf16 v[100:103], v[116:119], a[196:199], v[100:103]
  ds_read_b128 v[108:111], v2 offset:33792
  s_waitcnt lgkmcnt(4)
  v_mfma_f32_16x16x32_bf16 v[96:99], v[116:119], a[192:195], v[96:99]
  v_mfma_f32_16x16x32_bf16 v[72:75], v[120:123], a[200:203], v[72:75]
  ds_read_b128 v[112:115], v2 offset:34816
  v_mfma_f32_16x16x32_bf16 v[76:79], v[120:123], a[204:207], v[76:79]
  buffer_load_dwordx4 v17, s[16:19], s66 offen offset:1024 sc1 lds
  v_mfma_f32_16x16x32_bf16 v[84:87], v[124:127], a[204:207], v[84:87]
  ds_read_b128 v[116:119], v2 offset:35840
  s_waitcnt lgkmcnt(4)
  v_mfma_f32_16x16x32_bf16 v[80:83], v[124:127], a[200:203], v[80:83]
  v_mfma_f32_16x16x32_bf16 v[88:91], v[128:131], a[200:203], v[88:91]
  ds_read_b128 v[120:123], v2 offset:36864
  v_mfma_f32_16x16x32_bf16 v[92:95], v[128:131], a[204:207], v[92:95]
  buffer_load_dwordx4 v20, s[16:19], s66 offen offset:2048 sc1 lds
  v_mfma_f32_16x16x32_bf16 v[100:103], v[132:135], a[204:207], v[100:103]
  ds_read_b128 v[124:127], v2 offset:37888
  s_waitcnt lgkmcnt(4)
  v_mfma_f32_16x16x32_bf16 v[96:99], v[132:135], a[200:203], v[96:99]
  v_mfma_f32_16x16x32_bf16 v[72:75], v[104:107], a[208:211], v[72:75]
  ds_read_b128 v[128:131], v2 offset:38912
  v_mfma_f32_16x16x32_bf16 v[76:79], v[104:107], a[212:215], v[76:79]
  buffer_load_dwordx4 v21, s[16:19], s66 offen offset:3072 sc1 lds
  v_mfma_f32_16x16x32_bf16 v[84:87], v[108:111], a[212:215], v[84:87]
  ds_read_b128 v[132:135], v2 offset:39936
  s_waitcnt lgkmcnt(4)
  v_mfma_f32_16x16x32_bf16 v[80:83], v[108:111], a[208:211], v[80:83]
  v_mfma_f32_16x16x32_bf16 v[88:91], v[112:115], a[208:211], v[88:91]
  ds_read_b128 v[104:107], v3 offset:0
  v_mfma_f32_16x16x32_bf16 v[92:95], v[112:115], a[212:215], v[92:95]
  v_mfma_f32_16x16x32_bf16 v[100:103], v[116:119], a[212:215], v[100:103]
  ds_read_b128 v[108:111], v3 offset:1024
  s_waitcnt lgkmcnt(4)
  v_mfma_f32_16x16x32_bf16 v[96:99], v[116:119], a[208:211], v[96:99]
  v_mfma_f32_16x16x32_bf16 v[72:75], v[120:123], a[216:219], v[72:75]
  ds_read_b128 v[112:115], v3 offset:2048
  v_mfma_f32_16x16x32_bf16 v[76:79], v[120:123], a[220:223], v[76:79]
  v_mfma_f32_16x16x32_bf16 v[84:87], v[124:127], a[220:223], v[84:87]
  ds_read_b128 v[116:119], v3 offset:3072
  s_waitcnt lgkmcnt(4)
  v_mfma_f32_16x16x32_bf16 v[80:83], v[124:127], a[216:219], v[80:83]
  v_mfma_f32_16x16x32_bf16 v[88:91], v[128:131], a[216:219], v[88:91]
  ds_read_b128 v[120:123], v3 offset:4096
  v_mfma_f32_16x16x32_bf16 v[92:95], v[128:131], a[220:223], v[92:95]
  v_mfma_f32_16x16x32_bf16 v[100:103], v[132:135], a[220:223], v[100:103]
  ds_read_b128 v[124:127], v3 offset:5120
  s_waitcnt lgkmcnt(4)
  v_mfma_f32_16x16x32_bf16 v[96:99], v[132:135], a[216:219], v[96:99]
  v_mfma_f32_16x16x32_bf16 v[72:75], v[104:107], a[224:227], v[72:75]
  ds_read_b128 v[128:131], v3 offset:6144
  v_mfma_f32_16x16x32_bf16 v[76:79], v[104:107], a[228:231], v[76:79]
  v_mfma_f32_16x16x32_bf16 v[84:87], v[108:111], a[228:231], v[84:87]
  ds_read_b128 v[132:135], v3 offset:7168
  s_waitcnt lgkmcnt(4)
  v_mfma_f32_16x16x32_bf16 v[80:83], v[108:111], a[224:227], v[80:83]
  s_waitcnt vmcnt(11)
  s_barrier
  v_mfma_f32_16x16x32_bf16 v[88:91], v[112:115], a[224:227], v[88:91]
  ds_read_b128 v[104:107], v3 offset:8192
  s_add_u32 m0, s59, 16384
  s_add_u32 s66, s65, 204800
L_mark8:
  s_cbranch_execz L_touched
  v_mfma_f32_16x16x32_bf16 v[92:95], v[112:115], a[228:231], v[92:95]
  buffer_load_dwordx4 v1, s[16:19], s66 offen offset:0 sc1 lds
  v_mfma_f32_16x16x32_bf16 v[100:103], v[116:119], a[228:231], v[100:103]
  ds_read_b128 v[108:111], v3 offset:9216
  s_waitcnt lgkmcnt(4)
  v_mfma_f32_16x16x32_bf16 v[96:99], v[116:119], a[224:227], v[96:99]
  v_mfma_f32_16x16x32_bf16 v[72:75], v[120:123], a[232:235], v[72:75]
  ds_read_b128 v[112:115], v3 offset:10240
  v_mfma_f32_16x16x32_bf16 v[76:79], v[120:123], a[236:239], v[76:79]
  buffer_load_dwordx4 v17, s[16:19], s66 offen offset:1024 sc1 lds
  v_mfma_f32_16x16x32_bf16 v[84:87], v[124:127], a[236:239], v[84:87]
  ds_read_b128 v[116:119], v3 offset:11264
  s_waitcnt lgkmcnt(4)
  v_mfma_f32_16x16x32_bf16 v[80:83], v[124:127], a[232:235], v[80:83]
  v_mfma_f32_16x16x32_bf16 v[88:91], v[128:131], a[232:235], v[88:91]
  ds_read_b128 v[120:123], v3 offset:12288
  v_mfma_f32_16x16x32_bf16 v[92:95], v[128:131], a[236:239], v[92:95]
  buffer_load_dwordx4 v20, s[16:19], s66 offen offset:2048 sc1 lds
  v_mfma_f32_16x16x32_bf16 v[100:103], v[132:135], a[236:239], v[100:103]
  ds_read_b128 v[124:127], v3 offset:13312
  s_waitcnt lgkmcnt(4)
  v_mfma_f32_16x16x32_bf16 v[96:99], v[132:135], a[232:235], v[96:99]
  v_mfma_f32_16x16x32_bf16 v[72:75], v[104:107], a[240:243], v[72:75]
  ds_read_b128 v[128:131], v3 offset:14336
  v_mfma_f32_16x16x32_bf16 v[76:79], v[104:107], a[244:247], v[76:79]
  buffer_load_dwordx4 v21, s[16:19], s66 offen offset:3072 sc1 lds
  v_mfma_f32_16x16x32_bf16 v[84:87], v[108:111], a[244:247], v[84:87]
  ds_read_b128 v[132:135], v3 offset:15360
  s_waitcnt lgkmcnt(4)
  v_mfma_f32_16x16x32_bf16 v[80:83], v[108:111], a[240:243], v[80:83]
  v_mfma_f32_16x16x32_bf16 v[88:91], v[112:115], a[240:243], v[88:91]
  ds_read_b128 v[104:107], v3 offset:16384
  s_waitcnt vmcnt(8)
  v_mov_b32 v38, s57
  buffer_store_dword v38, v22, s[16:19], s76 offen sc1
  v_mfma_f32_16x16x32_bf16 v[92:95], v[112:115], a[244:247], v[92:95]
  v_mfma_f32_16x16x32_bf16 v[100:103], v[116:119], a[244:247], v[100:103]
  ds_read_b128 v[108:111], v3 offset:17408
  s_waitcnt lgkmcnt(4)
  v_mfma_f32_16x16x32_bf16 v[96:99], v[116:119], a[240:243], v[96:99]
  v_mfma_f32_16x16x32_bf16 v[72:75], v[120:123], a[248:251], v[72:75]
  ds_read_b128 v[112:115], v3 offset:18432
  v_mfma_f32_16x16x32_bf16 v[76:79], v[120:123], a[252:255], v[76:79]
  v_mfma_f32_16x16x32_bf16 v[84:87], v[124:127], a[252:255], v[84:87]
  ds_read_b128 v[116:119], v3 offset:19456
  s_waitcnt lgkmcnt(4)
  v_mfma_f32_16x16x32_bf16 v[80:83], v[124:127], a[248:251], v[80:83]
  v_mfma_f32_16x16x32_bf16 v[88:91], v[128:131], a[248:251], v[88:91]
  ds_read_b128 v[120:123], v3 offset:20480
  v_mfma_f32_16x16x32_bf16 v[92:95], v[128:131], a[252:255], v[92:95]
  v_mfma_f32_16x16x32_bf16 v[100:103], v[132:135], a[252:255], v[100:103]
  ds_read_b128 v[124:127], v3 offset:21504
  s_waitcnt lgkmcnt(4)
  v_mfma_f32_16x16x32_bf16 v[96:99], v[132:135], a[248:251], v[96:99]
  v_mfma_f32_16x16x32_bf16 v[72:75], v[104:107], v[136:139], v[72:75]
  ds_read_b128 v[128:131], v3 offset:22528
  v_mfma_f32_16x16x32_bf16 v[76:79], v[104:107], v[140:143], v[76:79]
  v_mfma_f32_16x16x32_bf16 v[84:87], v[108:111], v[140:143], v[84:87]
  ds_read_b128 v[132:135], v3 offset:23552
  s_waitcnt lgkmcnt(4)
  v_mfma_f32_16x16x32_bf16 v[80:83], v[108:111], v[136:139], v[80:83]
  s_barrier
  v_mfma_f32_16x16x32_bf16 v[88:91], v[112:115], v[136:139], v[88:91]
  ds_read_b128 v[104:107], v3 offset:24576
  s_add_u32 m0, s59, 32768
  s_add_u32 s66, s65, 225280
  v_mfma_f32_16x16x32_bf16 v[92:95], v[112:115], v[140:143], v[92:95]
  buffer_load_dwordx4 v1, s[16:19], s66 offen offset:0 sc1 lds
  v_mfma_f32_16x16x32_bf16 v[100:103], v[116:119], v[140:143], v[100:103]
  ds_read_b128 v[108:111], v3 offset:25600
  s_waitcnt lgkmcnt(4)
  v_mfma_f32_16x16x32_bf16 v[96:99], v[116:119], v[136:139], v[96:99]
  v_mfma_f32_16x16x32_bf16 v[72:75], v[120:123], v[144:147], v[72:75]
  ds_read_b128 v[112:115], v3 offset:26624
  v_mfma_f32_16x16x32_bf16 v[76:79], v[120:123], v[148:151], v[76:79]
  buffer_load_dwordx4 v17, s[16:19], s66 offen offset:1024 sc1 lds
  v_mfma_f32_16x16x32_bf16 v[84:87], v[124:127], v[148:151], v[84:87]
  ds_read_b128 v[116:119], v3 offset:27648
  s_waitcnt lgkmcnt(4)
  v_mfma_f32_16x16x32_bf16 v[80:83], v[124:127], v[144:147], v[80:83]
  v_mfma_f32_16x16x32_bf16 v[88:91], v[128:131], v[144:147], v[88:91]
  ds_read_b128 v[120:123], v3 offset:28672
  v_mfma_f32_16x16x32_bf16 v[92:95], v[128:131], v[148:151], v[92:95]
  buffer_load_dwordx4 v20, s[16:19], s66 offen offset:2048 sc1 lds
  v_mfma_f32_16x16x32_bf16 v[100:103], v[132:135], v[148:151], v[100:103]
  ds_read_b128 v[124:127], v3 offset:29696
  s_waitcnt lgkmcnt(4)
  v_mfma_f32_16x16x32_bf16 v[96:99], v[132:135], v[144:147], v[96:99]
  v_mfma_f32_16x16x32_bf16 v[72:75], v[104:107], v[152:155], v[72:75]
  ds_read_b128 v[128:131], v3 offset:30720
  v_mfma_f32_16x16x32_bf16 v[76:79], v[104:107], v[156:159], v[76:79]
  buffer_load_dwordx4 v21, s[16:19], s66 offen offset:3072 sc1 lds
  v_mfma_f32_16x16x32_bf16 v[84:87], v[108:111], v[156:159], v[84:87]
  ds_read_b128 v[132:135], v3 offset:31744
  s_waitcnt lgkmcnt(4)
  v_mfma_f32_16x16x32_bf16 v[80:83], v[108:111], v[152:155], v[80:83]
  v_mfma_f32_16x16x32_bf16 v[88:91], v[112:115], v[152:155], v[88:91]
  ds_read_b128 v[104:107], v3 offset:32768
  v_mfma_f32_16x16x32_bf16 v[92:95], v[112:115], v[156:159], v[92:95]
  v_mfma_f32_16x16x32_bf16 v[100:103], v[116:119], v[156:159], v[100:103]
  ds_read_b128 v[108:111], v3 offset:33792
  s_waitcnt lgkmcnt(4)
  v_mfma_f32_16x16x32_bf16 v[96:99], v[116:119], v[152:155], v[96:99]
  v_mfma_f32_16x16x32_bf16 v[72:75], v[120:123], v[160:163], v[72:75]
  ds_read_b128 v[112:115], v3 offset:34816
  v_mfma_f32_16x16x32_bf16 v[76:79], v[120:123], v[164:167], v[76:79]
  v_mfma_f32_16x16x32_bf16 v[84:87], v[124:127], v[164:167], v[84:87]
  ds_read_b128 v[116:119], v3 offset:35840
  s_waitcnt lgkmcnt(4)
  v_mfma_f32_16x16x32_bf16 v[80:83], v[124:127], v[160:163], v[80:83]
  v_mfma_f32_16x16x32_bf16 v[88:91], v[128:131], v[160:163], v[88:91]
  ds_read_b128 v[120:123], v3 offset:36864
  v_mfma_f32_16x16x32_bf16 v[92:95], v[128:131], v[164:167], v[92:95]
  v_mfma_f32_16x16x32_bf16 v[100:103], v[132:135], v[164:167], v[100:103]
  ds_read_b128 v[124:127], v3 offset:37888
  s_waitcnt lgkmcnt(4)
  v_mfma_f32_16x16x32_bf16 v[96:99], v[132:135], v[160:163], v[96:99]
  v_mfma_f32_16x16x32_bf16 v[72:75], v[104:107], v[168:171], v[72:75]
  ds_read_b128 v[128:131], v3 offset:38912
  v_mfma_f32_16x16x32_bf16 v[76:79], v[104:107], v[172:175], v[76:79]
  v_mfma_f32_16x16x32_bf16 v[84:87], v[108:111], v[172:175], v[84:87]
  ds_read_b128 v[132:135], v3 offset:39936
  s_waitcnt lgkmcnt(4)
  v_mfma_f32_16x16x32_bf16 v[80:83], v[108:111], v[168:171], v[80:83]
  s_waitcnt vmcnt(9)
  s_barrier
  v_mfma_f32_16x16x32_bf16 v[88:91], v[112:115], v[168:171], v[88:91]
  ds_read_b128 v[104:107], v2 offset:0
  s_add_u32 m0, s59, 49152
  s_add_u32 s66, s65, 245760
  v_mfma_f32_16x16x32_bf16 v[92:95], v[112:115], v[172:175], v[92:95]
  buffer_load_dwordx4 v1, s[16:19], s66 offen offset:0 sc1 lds
  v_mfma_f32_16x16x32_bf16 v[100:103], v[116:119], v[172:175], v[100:103]
  ds_read_b128 v[108:111], v2 offset:1024
  s_waitcnt lgkmcnt(4)
  v_mfma_f32_16x16x32_bf16 v[96:99], v[116:119], v[168:171], v[96:99]
  v_mfma_f32_16x16x32_bf16 v[72:75], v[120:123], v[176:179], v[72:75]
  ds_read_b128 v[112:115], v2 offset:2048
  v_mfma_f32_16x16x32_bf16 v[76:79], v[120:123], v[180:183], v[76:79]
  buffer_load_dwordx4 v17, s[16:19], s66 offen offset:1024 sc1 lds
  v_mfma_f32_16x16x32_bf16 v[84:87], v[124:127], v[180:183], v[84:87]
  ds_read_b128 v[116:119], v2 offset:3072
  s_waitcnt lgkmcnt(4)
  v_mfma_f32_16x16x32_bf16 v[80:83], v[124:127], v[176:179], v[80:83]
  v_mfma_f32_16x16x32_bf16 v[88:91], v[128:131], v[176:179], v[88:91]
  ds_read_b128 v[120:123], v2 offset:4096
  v_mfma_f32_16x16x32_bf16 v[92:95], v[128:131], v[180:183], v[92:95]
  buffer_load_dwordx4 v20, s[16:19], s66 offen offset:2048 sc1 lds
  v_mfma_f32_16x16x32_bf16 v[100:103], v[132:135], v[180:183], v[100:103]
  ds_read_b128 v[124:127], v2 offset:5120
  s_waitcnt lgkmcnt(4)
  v_mfma_f32_16x16x32_bf16 v[96:99], v[132:135], v[176:179], v[96:99]
  v_mfma_f32_16x16x32_bf16 v[72:75], v[104:107], v[184:187], v[72:75]
  ds_read_b128 v[128:131], v2 offset:6144
  v_mfma_f32_16x16x32_bf16 v[76:79], v[104:107], v[188:191], v[76:79]
  buffer_load_dwordx4 v21, s[16:19], s66 offen offset:3072 sc1 lds
  v_mfma_f32_16x16x32_bf16 v[84:87], v[108:111], v[188:191], v[84:87]
  ds_read_b128 v[132:135], v2 offset:7168
  s_waitcnt lgkmcnt(4)
  v_mfma_f32_16x16x32_bf16 v[80:83], v[108:111], v[184:187], v[80:83]
  v_mfma_f32_16x16x32_bf16 v[88:91], v[112:115], v[184:187], v[88:91]
  ds_read_b128 v[104:107], v2 offset:8192
  v_mfma_f32_16x16x32_bf16 v[92:95], v[112:115], v[188:191], v[92:95]
  v_mfma_f32_16x16x32_bf16 v[100:103], v[116:119], v[188:191], v[100:103]
  ds_read_b128 v[108:111], v2 offset:9216
  s_waitcnt lgkmcnt(4)
  v_mfma_f32_16x16x32_bf16 v[96:99], v[116:119], v[184:187], v[96:99]
  v_mfma_f32_16x16x32_bf16 v[72:75], v[120:123], v[192:195], v[72:75]
  ds_read_b128 v[112:115], v2 offset:10240
  v_mfma_f32_16x16x32_bf16 v[76:79], v[120:123], v[196:199], v[76:79]
  v_mfma_f32_16x16x32_bf16 v[84:87], v[124:127], v[196:199], v[84:87]
  ds_read_b128 v[116:119], v2 offset:11264
  s_waitcnt lgkmcnt(4)
  v_mfma_f32_16x16x32_bf16 v[80:83], v[124:127], v[192:195], v[80:83]
  v_mfma_f32_16x16x32_bf16 v[88:91], v[128:131], v[192:195], v[88:91]
  ds_read_b128 v[120:123], v2 offset:12288
  v_mfma_f32_16x16x32_bf16 v[92:95], v[128:131], v[196:199], v[92:95]
  v_mfma_f32_16x16x32_bf16 v[100:103], v[132:135], v[196:199], v[100:103]
  ds_read_b128 v[124:127], v2 offset:13312
  s_waitcnt lgkmcnt(4)
  v_mfma_f32_16x16x32_bf16 v[96:99], v[132:135], v[192:195], v[96:99]
  v_mfma_f32_16x16x32_bf16 v[72:75], v[104:107], v[200:203], v[72:75]
  ds_read_b128 v[128:131], v2 offset:14336
  v_mfma_f32_16x16x32_bf16 v[76:79], v[104:107], v[204:207], v[76:79]
  v_mfma_f32_16x16x32_bf16 v[84:87], v[108:111], v[204:207], v[84:87]
  ds_read_b128 v[132:135], v2 offset:15360
  s_waitcnt lgkmcnt(4)
  v_mfma_f32_16x16x32_bf16 v[80:83], v[108:111], v[200:203], v[80:83]
  s_waitcnt vmcnt(9)
  s_barrier
  v_mfma_f32_16x16x32_bf16 v[88:91], v[112:115], v[200:203], v[88:91]
  ds_read_b128 v[104:107], v2 offset:16384
  s_add_u32 m0, s59, 65536
  s_add_u32 s66, s65, 266240
  v_mfma_f32_16x16x32_bf16 v[92:95], v[112:115], v[204:207], v[92:95]
  buffer_load_dwordx4 v1, s[16:19], s66 offen offset:0 sc1 lds
  v_mfma_f32_16x16x32_bf16 v[100:103], v[116:119], v[204:207], v[100:103]
  ds_read_b128 v[108:111], v2 offset:17408
  s_waitcnt lgkmcnt(4)
  v_mfma_f32_16x16x32_bf16 v[96:99], v[116:119], v[200:203], v[96:99]
  v_mfma_f32_16x16x32_bf16 v[72:75], v[120:123], v[208:211], v[72:75]
  ds_read_b128 v[112:115], v2 offset:18432
  v_mfma_f32_16x16x32_bf16 v[76:79], v[120:123], v[212:215], v[76:79]
  buffer_load_dwordx4 v17, s[16:19], s66 offen offset:1024 sc1 lds
  v_mfma_f32_16x16x32_bf16 v[84:87], v[124:127], v[212:215], v[84:87]
  ds_read_b128 v[116:119], v2 offset:19456
  s_waitcnt lgkmcnt(4)
  v_mfma_f32_16x16x32_bf16 v[80:83], v[124:127], v[208:211], v[80:83]
  v_mfma_f32_16x16x32_bf16 v[88:91], v[128:131], v[208:211], v[88:91]
  ds_read_b128 v[120:123], v2 offset:20480
  v_mfma_f32_16x16x32_bf16 v[92:95], v[128:131], v[212:215], v[92:95]
  buffer_load_dwordx4 v20, s[16:19], s66 offen offset:2048 sc1 lds
  v_mfma_f32_16x16x32_bf16 v[100:103], v[132:135], v[212:215], v[100:103]
  ds_read_b128 v[124:127], v2 offset:21504
  s_waitcnt lgkmcnt(4)
  v_mfma_f32_16x16x32_bf16 v[96:99], v[132:135], v[208:211], v[96:99]
  v_mfma_f32_16x16x32_bf16 v[72:75], v[104:107], v[216:219], v[72:75]
  ds_read_b128 v[128:131], v2 offset:22528
  v_mfma_f32_16x16x32_bf16 v[76:79], v[104:107], v[220:223], v[76:79]
  buffer_load_dwordx4 v21, s[16:19], s66 offen offset:3072 sc1 lds
  v_mfma_f32_16x16x32_bf16 v[84:87], v[108:111], v[220:223], v[84:87]
  ds_read_b128 v[132:135], v2 offset:23552
  s_waitcnt lgkmcnt(4)
  v_mfma_f32_16x16x32_bf16 v[80:83], v[108:111], v[216:219], v[80:83]
  v_mfma_f32_16x16x32_bf16 v[88:91], v[112:115], v[216:219], v[88:91]
  ds_read_b128 v[104:107], v2 offset:24576
  v_mfma_f32_16x16x32_bf16 v[92:95], v[112:115], v[220:223], v[92:95]
  v_mfma_f32_16x16x32_bf16 v[100:103], v[116:119], v[220:223], v[100:103]
  ds_read_b128 v[108:111], v2 offset:25600
  s_waitcnt lgkmcnt(4)
  v_mfma_f32_16x16x32_bf16 v[96:99], v[116:119], v[216:219], v[96:99]
  v_mfma_f32_16x16x32_bf16 v[72:75], v[120:123], v[224:227], v[72:75]
  ds_read_b128 v[112:115], v2 offset:26624
  v_mfma_f32_16x16x32_bf16 v[76:79], v[120:123], v[228:231], v[76:79]
  v_mfma_f32_16x16x32_bf16 v[84:87], v[124:127], v[228:231], v[84:87]
  ds_read_b128 v[116:119], v2 offset:27648
  s_waitcnt lgkmcnt(4)
  v_mfma_f32_16x16x32_bf16 v[80:83], v[124:127], v[224:227], v[80:83]
  v_mfma_f32_16x16x32_bf16 v[88:91], v[128:131], v[224:227], v[88:91]
  ds_read_b128 v[120:123], v2 offset:28672
  v_mfma_f32_16x16x32_bf16 v[92:95], v[128:131], v[228:231], v[92:95]
  v_mfma_f32_16x16x32_bf16 v[100:103], v[132:135], v[228:231], v[100:103]
  ds_read_b128 v[124:127], v2 offset:29696
  s_waitcnt lgkmcnt(4)
  v_mfma_f32_16x16x32_bf16 v[96:99], v[132:135], v[224:227], v[96:99]
  v_mfma_f32_16x16x32_bf16 v[72:75], v[104:107], v[232:235], v[72:75]
  ds_read_b128 v[128:131], v2 offset:30720
  buffer_load_dword v39, off, s[16:19], s77 sc1
  v_mfma_f32_16x16x32_bf16 v[76:79], v[104:107], v[236:239], v[76:79]
  v_mfma_f32_16x16x32_bf16 v[84:87], v[108:111], v[236:239], v[84:87]
  ds_read_b128 v[132:135], v2 offset:31744
  s_waitcnt lgkmcnt(4)
  v_mfma_f32_16x16x32_bf16 v[80:83], v[108:111], v[232:235], v[80:83]
  s_waitcnt vmcnt(9)
  s_barrier
  v_mfma_f32_16x16x32_bf16 v[88:91], v[112:115], v[232:235], v[88:91]
  ds_read_b128 v[104:107], v2 offset:32768
  v_mfma_f32_16x16x32_bf16 v[92:95], v[112:115], v[236:239], v[92:95]
  v_mfma_f32_16x16x32_bf16 v[100:103], v[116:119], v[236:239], v[100:103]
  ds_read_b128 v[108:111], v2 offset:33792
  s_waitcnt lgkmcnt(4)
  v_mfma_f32_16x16x32_bf16 v[96:99], v[116:119], v[232:235], v[96:99]
  v_mfma_f32_16x16x32_bf16 v[72:75], v[120:123], v[240:243], v[72:75]
  ds_read_b128 v[112:115], v2 offset:34816
  v_mfma_f32_16x16x32_bf16 v[76:79], v[120:123], v[244:247], v[76:79]
  v_mfma_f32_16x16x32_bf16 v[84:87], v[124:127], v[244:247], v[84:87]
  ds_read_b128 v[116:119], v2 offset:35840
  s_waitcnt lgkmcnt(4)
  v_mfma_f32_16x16x32_bf16 v[80:83], v[124:127], v[240:243], v[80:83]
  v_mfma_f32_16x16x32_bf16 v[88:91], v[128:131], v[240:243], v[88:91]
  ds_read_b128 v[120:123], v2 offset:36864
  v_mfma_f32_16x16x32_bf16 v[92:95], v[128:131], v[244:247], v[92:95]
  v_mfma_f32_16x16x32_bf16 v[100:103], v[132:135], v[244:247], v[100:103]
  ds_read_b128 v[124:127], v2 offset:37888
  s_waitcnt lgkmcnt(4)
  v_mfma_f32_16x16x32_bf16 v[96:99], v[132:135], v[240:243], v[96:99]
  v_mfma_f32_16x16x32_bf16 v[72:75], v[104:107], v[248:251], v[72:75]
  ds_read_b128 v[128:131], v2 offset:38912
  v_mfma_f32_16x16x32_bf16 v[76:79], v[104:107], v[252:255], v[76:79]
  v_mfma_f32_16x16x32_bf16 v[84:87], v[108:111], v[252:255], v[84:87]
  ds_read_b128 v[132:135], v2 offset:39936
  s_waitcnt lgkmcnt(4)
  v_mfma_f32_16x16x32_bf16 v[80:83], v[108:111], v[248:251], v[80:83]
  v_mfma_f32_16x16x32_bf16 v[88:91], v[112:115], v[248:251], v[88:91]
  ds_read_b128 v[104:107], v3 offset:0
  v_mfma_f32_16x16x32_bf16 v[92:95], v[112:115], v[252:255], v[92:95]
  v_mfma_f32_16x16x32_bf16 v[100:103], v[116:119], v[252:255], v[100:103]
  ds_read_b128 v[108:111], v3 offset:1024
  s_waitcnt lgkmcnt(4)
  v_mfma_f32_16x16x32_bf16 v[96:99], v[116:119], v[248:251], v[96:99]
  v_mfma_f32_16x16x32_bf16 v[72:75], v[120:123], a[0:3], v[72:75]
  ds_read_b128 v[112:115], v3 offset:2048
  v_mfma_f32_16x16x32_bf16 v[76:79], v[120:123], a[4:7], v[76:79]
  v_mfma_f32_16x16x32_bf16 v[84:87], v[124:127], a[4:7], v[84:87]
  ds_read_b128 v[116:119], v3 offset:3072
  s_waitcnt lgkmcnt(4)
  v_mfma_f32_16x16x32_bf16 v[80:83], v[124:127], a[0:3], v[80:83]
  v_mfma_f32_16x16x32_bf16 v[88:91], v[128:131], a[0:3], v[88:91]
  ds_read_b128 v[120:123], v3 offset:4096
  v_mfma_f32_16x16x32_bf16 v[92:95], v[128:131], a[4:7], v[92:95]
  v_mfma_f32_16x16x32_bf16 v[100:103], v[132:135], a[4:7], v[100:103]
  ds_read_b128 v[124:127], v3 offset:5120
  s_waitcnt lgkmcnt(4)
  v_mfma_f32_16x16x32_bf16 v[96:99], v[132:135], a[0:3], v[96:99]
  v_mfma_f32_16x16x32_bf16 v[72:75], v[104:107], a[8:11], v[72:75]
  ds_read_b128 v[128:131], v3 offset:6144
  v_mfma_f32_16x16x32_bf16 v[76:79], v[104:107], a[12:15], v[76:79]
  v_mfma_f32_16x16x32_bf16 v[84:87], v[108:111], a[12:15], v[84:87]
  ds_read_b128 v[132:135], v3 offset:7168
  s_waitcnt lgkmcnt(4)
  v_mfma_f32_16x16x32_bf16 v[80:83], v[108:111], a[8:11], v[80:83]
  s_waitcnt vmcnt(5)
  s_barrier
  v_mfma_f32_16x16x32_bf16 v[88:91], v[112:115], a[8:11], v[88:91]
  ds_read_b128 v[104:107], v3 offset:8192
  v_mfma_f32_16x16x32_bf16 v[92:95], v[112:115], a[12:15], v[92:95]
  v_mfma_f32_16x16x32_bf16 v[100:103], v[116:119], a[12:15], v[100:103]
  ds_read_b128 v[108:111], v3 offset:9216
  s_waitcnt lgkmcnt(4)
  v_mfma_f32_16x16x32_bf16 v[96:99], v[116:119], a[8:11], v[96:99]
  v_mfma_f32_16x16x32_bf16 v[72:75], v[120:123], a[16:19], v[72:75]
  ds_read_b128 v[112:115], v3 offset:10240
  s_waitcnt vmcnt(0)
  v_cmp_ne_u32 vcc, s57, v39
  s_cbranch_vccnz L_spin_3
L_ret_3:
  v_mfma_f32_16x16x32_bf16 v[76:79], v[120:123], a[20:23], v[76:79]
  buffer_load_dwordx4 v[40:43], v1, s[16:19], s80 offen offset:0 sc1
  v_mfma_f32_16x16x32_bf16 v[84:87], v[124:127], a[20:23], v[84:87]
  ds_read_b128 v[116:119], v3 offset:11264
  s_waitcnt lgkmcnt(4)
  v_mfma_f32_16x16x32_bf16 v[80:83], v[124:127], a[16:19], v[80:83]
  v_mfma_f32_16x16x32_bf16 v[88:91], v[128:131], a[16:19], v[88:91]
  ds_read_b128 v[120:123], v3 offset:12288
  v_mfma_f32_16x16x32_bf16 v[92:95], v[128:131], a[20:23], v[92:95]
  buffer_load_dwordx4 v[48:51], v17, s[16:19], s80 offen offset:1024 sc1
  v_mfma_f32_16x16x32_bf16 v[100:103], v[132:135], a[20:23], v[100:103]
  ds_read_b128 v[124:127], v3 offset:13312
  s_waitcnt lgkmcnt(4)
  v_mfma_f32_16x16x32_bf16 v[96:99], v[132:135], a[16:19], v[96:99]
  v_mfma_f32_16x16x32_bf16 v[72:75], v[104:107], a[24:27], v[72:75]
  ds_read_b128 v[128:131], v3 offset:14336
  v_mfma_f32_16x16x32_bf16 v[76:79], v[104:107], a[28:31], v[76:79]
  buffer_load_dwordx4 v[56:59], v20, s[16:19], s80 offen offset:2048 sc1
  v_mfma_f32_16x16x32_bf16 v[84:87], v[108:111], a[28:31], v[84:87]
  ds_read_b128 v[132:135], v3 offset:15360
  s_waitcnt lgkmcnt(4)
  v_mfma_f32_16x16x32_bf16 v[80:83], v[108:111], a[24:27], v[80:83]
  v_mfma_f32_16x16x32_bf16 v[88:91], v[112:115], a[24:27], v[88:91]
  ds_read_b128 v[104:107], v3 offset:16384
  v_mfma_f32_16x16x32_bf16 v[92:95], v[112:115], a[28:31], v[92:95]
  buffer_load_dwordx4 v[64:67], v21, s[16:19], s80 offen offset:3072 sc1
  v_mfma_f32_16x16x32_bf16 v[100:103], v[116:119], a[28:31], v[100:103]
  ds_read_b128 v[108:111], v3 offset:17408
  s_waitcnt lgkmcnt(4)
  v_mfma_f32_16x16x32_bf16 v[96:99], v[116:119], a[24:27], v[96:99]
  v_mfma_f32_16x16x32_bf16 v[72:75], v[120:123], a[32:35], v[72:75]
  ds_read_b128 v[112:115], v3 offset:18432
  v_mfma_f32_16x16x32_bf16 v[76:79], v[120:123], a[36:39], v[76:79]
  v_mfma_f32_16x16x32_bf16 v[84:87], v[124:127], a[36:39], v[84:87]
  ds_read_b128 v[116:119], v3 offset:19456
  s_waitcnt lgkmcnt(4)
  v_mfma_f32_16x16x32_bf16 v[80:83], v[124:127], a[32:35], v[80:83]
  v_subrev_u32 v9, 81920, v2
  v_and_b32 v8, 240, v9
  v_mfma_f32_16x16x32_bf16 v[88:91], v[128:131], a[32:35], v[88:91]
  ds_read_b128 v[120:123], v3 offset:20480
  v_lshlrev_b32 v8, 7, v8
  v_lshrrev_b32 v9, 4, v9
  v_mfma_f32_16x16x32_bf16 v[92:95], v[128:131], a[36:39], v[92:95]
  v_and_b32 v9, 0x30, v9
  s_lshl_b32 s87, s56, 16
  v_mfma_f32_16x16x32_bf16 v[100:103], v[132:135], a[36:39], v[100:103]
  ds_read_b128 v[124:127], v3 offset:21504
  v_or3_b32 v8, v8, v9, s87
  s_waitcnt lgkmcnt(4)
  v_mfma_f32_16x16x32_bf16 v[96:99], v[132:135], a[32:35], v[96:99]
  v_mfma_f32_16x16x32_bf16 v[72:75], v[104:107], a[40:43], v[72:75]
  ds_read_b128 v[128:131], v3 offset:22528
  v_mfma_f32_16x16x32_bf16 v[76:79], v[104:107], a[44:47], v[76:79]
  v_mfma_f32_16x16x32_bf16 v[84:87], v[108:111], a[44:47], v[84:87]
  ds_read_b128 v[132:135], v3 offset:23552
  s_waitcnt lgkmcnt(4)
  v_mfma_f32_16x16x32_bf16 v[80:83], v[108:111], a[40:43], v[80:83]
  s_barrier
  v_mfma_f32_16x16x32_bf16 v[88:91], v[112:115], a[40:43], v[88:91]
  ds_read_b128 v[104:107], v3 offset:24576
  v_mfma_f32_16x16x32_bf16 v[92:95], v[112:115], a[44:47], v[92:95]
  v_mfma_f32_16x16x32_bf16 v[100:103], v[116:119], a[44:47], v[100:103]
  ds_read_b128 v[108:111], v3 offset:25600
  s_waitcnt lgkmcnt(4)
  v_mfma_f32_16x16x32_bf16 v[96:99], v[116:119], a[40:43], v[96:99]
  v_mfma_f32_16x16x32_bf16 v[72:75], v[120:123], a[48:51], v[72:75]
  ds_read_b128 v[112:115], v3 offset:26624
  v_mfma_f32_16x16x32_bf16 v[76:79], v[120:123], a[52:55], v[76:79]
  v_mfma_f32_16x16x32_bf16 v[84:87], v[124:127], a[52:55], v[84:87]
  ds_read_b128 v[116:119], v3 offset:27648
  s_waitcnt lgkmcnt(4)
  v_mfma_f32_16x16x32_bf16 v[80:83], v[124:127], a[48:51], v[80:83]
  v_mfma_f32_16x16x32_bf16 v[88:91], v[128:131], a[48:51], v[88:91]
  ds_read_b128 v[120:123], v3 offset:28672
  v_mfma_f32_16x16x32_bf16 v[92:95], v[128:131], a[52:55], v[92:95]
  v_mfma_f32_16x16x32_bf16 v[100:103], v[132:135], a[52:55], v[100:103]
  ds_read_b128 v[124:127], v3 offset:29696
  s_waitcnt lgkmcnt(4)
  v_mfma_f32_16x16x32_bf16 v[96:99], v[132:135], a[48:51], v[96:99]
  v_mfma_f32_16x16x32_bf16 v[72:75], v[104:107], a[56:59], v[72:75]
  ds_read_b128 v[128:131], v3 offset:30720
  v_mfma_f32_16x16x32_bf16 v[76:79], v[104:107], a[60:63], v[76:79]
  v_mfma_f32_16x16x32_bf16 v[84:87], v[108:111], a[60:63], v[84:87]
  ds_read_b128 v[132:135], v3 offset:31744
  s_waitcnt lgkmcnt(4)
  v_mfma_f32_16x16x32_bf16 v[80:83], v[108:111], a[56:59], v[80:83]
  v_mfma_f32_16x16x32_bf16 v[88:91], v[112:115], a[56:59], v[88:91]
  ds_read_b128 v[104:107], v3 offset:32768
  v_mfma_f32_16x16x32_bf16 v[92:95], v[112:115], a[60:63], v[92:95]
  v_mfma_f32_16x16x32_bf16 v[100:103], v[116:119], a[60:63], v[100:103]
  ds_read_b128 v[108:111], v3 offset:33792
  s_waitcnt lgkmcnt(4)
  v_mfma_f32_16x16x32_bf16 v[96:99], v[116:119], a[56:59], v[96:99]
  v_mfma_f32_16x16x32_bf16 v[72:75], v[120:123], a[64:67], v[72:75]
  ds_read_b128 v[112:115], v3 offset:34816
  v_mfma_f32_16x16x32_bf16 v[76:79], v[120:123], a[68:71], v[76:79]
  v_mfma_f32_16x16x32_bf16 v[84:87], v[124:127], a[68:71], v[84:87]
  ds_read_b128 v[116:119], v3 offset:35840
  s_waitcnt lgkmcnt(4)
  v_mfma_f32_16x16x32_bf16 v[80:83], v[124:127], a[64:67], v[80:83]
  v_mfma_f32_16x16x32_bf16 v[88:91], v[128:131], a[64:67], v[88:91]
  ds_read_b128 v[120:123], v3 offset:36864
  v_mfma_f32_16x16x32_bf16 v[92:95], v[128:131], a[68:71], v[92:95]
  s_waitcnt vmcnt(3)
  v_and_b32 v44, 0xffff0000, v40
  v_lshlrev_b32 v40, 16, v40
  v_mfma_f32_16x16x32_bf16 v[100:103], v[132:135], a[68:71], v[100:103]
  ds_read_b128 v[124:127], v3 offset:37888
  v_and_b32 v45, 0xffff0000, v41
  v_lshlrev_b32 v41, 16, v41
  s_waitcnt lgkmcnt(4)
  v_mfma_f32_16x16x32_bf16 v[96:99], v[132:135], a[64:67], v[96:99]
  v_and_b32 v46, 0xffff0000, v42
  v_lshlrev_b32 v42, 16, v42
  v_mfma_f32_16x16x32_bf16 v[72:75], v[104:107], a[72:75], v[72:75]
  ds_read_b128 v[128:131], v3 offset:38912
  v_and_b32 v47, 0xffff0000, v43
  v_lshlrev_b32 v43, 16, v43
  v_mfma_f32_16x16x32_bf16 v[76:79], v[104:107], a[76:79], v[76:79]
  s_waitcnt vmcnt(2)
  v_and_b32 v52, 0xffff0000, v48
  v_lshlrev_b32 v48, 16, v48
  v_mfma_f32_16x16x32_bf16 v[84:87], v[108:111], a[76:79], v[84:87]
  ds_read_b128 v[132:135], v3 offset:39936
  v_and_b32 v53, 0xffff0000, v49
  v_lshlrev_b32 v49, 16, v49
  s_waitcnt lgkmcnt(4)
  v_mfma_f32_16x16x32_bf16 v[80:83], v[108:111], a[72:75], v[80:83]
  v_and_b32 v54, 0xffff0000, v50
  v_lshlrev_b32 v50, 16, v50
  v_mfma_f32_16x16x32_bf16 v[88:91], v[112:115], a[72:75], v[88:91]
  v_and_b32 v55, 0xffff0000, v51
  v_lshlrev_b32 v51, 16, v51
  v_mfma_f32_16x16x32_bf16 v[92:95], v[112:115], a[76:79], v[92:95]
  s_waitcnt vmcnt(1)
  v_and_b32 v60, 0xffff0000, v56
  v_lshlrev_b32 v56, 16, v56
  v_mfma_f32_16x16x32_bf16 v[100:103], v[116:119], a[76:79], v[100:103]
  v_and_b32 v61, 0xffff0000, v57
  v_lshlrev_b32 v57, 16, v57
  s_waitcnt lgkmcnt(2)
  v_mfma_f32_16x16x32_bf16 v[96:99], v[116:119], a[72:75], v[96:99]
  v_and_b32 v62, 0xffff0000, v58
  v_lshlrev_b32 v58, 16, v58
  v_mfma_f32_16x16x32_bf16 v[72:75], v[120:123], a[80:83], v[72:75]
  v_and_b32 v63, 0xffff0000, v59
  v_lshlrev_b32 v59, 16, v59
  v_mfma_f32_16x16x32_bf16 v[76:79], v[120:123], a[84:87], v[76:79]
  s_waitcnt vmcnt(0)
  v_and_b32 v68, 0xffff0000, v64
  v_lshlrev_b32 v64, 16, v64
  v_mfma_f32_16x16x32_bf16 v[84:87], v[124:127], a[84:87], v[84:87]
  v_and_b32 v69, 0xffff0000, v65
  v_lshlrev_b32 v65, 16, v65
  s_waitcnt lgkmcnt(0)
  v_mfma_f32_16x16x32_bf16 v[80:83], v[124:127], a[80:83], v[80:83]
  v_and_b32 v70, 0xffff0000, v66
  v_lshlrev_b32 v66, 16, v66
  v_mfma_f32_16x16x32_bf16 v[88:91], v[128:131], a[80:83], v[88:91]
  v_and_b32 v71, 0xffff0000, v67
  v_lshlrev_b32 v67, 16, v67
  v_mfma_f32_16x16x32_bf16 v[92:95], v[128:131], a[84:87], v[92:95]
  v_mfma_f32_16x16x32_bf16 v[100:103], v[132:135], a[84:87], v[100:103]
  v_mfma_f32_16x16x32_bf16 v[96:99], v[132:135], a[80:83], v[96:99]
  s_nop 3
  v_pk_add_f32 v[72:73], v[72:73], v[40:41]
  v_pk_add_f32 v[74:75], v[74:75], v[42:43]
  v_pk_add_f32 v[80:81], v[80:81], v[48:49]
  v_pk_add_f32 v[82:83], v[82:83], v[50:51]
  v_cvt_pk_bf16_f32 v24, v72, v80
  v_cvt_pk_bf16_f32 v25, v73, v81
  v_cvt_pk_bf16_f32 v26, v74, v82
  v_cvt_pk_bf16_f32 v27, v75, v83
  buffer_store_dwordx4 v[24:27], v8, s[24:27], 0 offen offset:0
  v_pk_add_f32 v[76:77], v[76:77], v[44:45]
  v_pk_add_f32 v[78:79], v[78:79], v[46:47]
  v_pk_add_f32 v[84:85], v[84:85], v[52:53]
  v_pk_add_f32 v[86:87], v[86:87], v[54:55]
  v_cvt_pk_bf16_f32 v28, v76, v84
  v_cvt_pk_bf16_f32 v29, v77, v85
  v_cvt_pk_bf16_f32 v30, v78, v86
  v_cvt_pk_bf16_f32 v31, v79, v87
  buffer_store_dwordx4 v[28:31], v8, s[24:27], s83 offen offset:0
  v_pk_add_f32 v[88:89], v[88:89], v[56:57]
  v_pk_add_f32 v[90:91], v[90:91], v[58:59]
  v_pk_add_f32 v[96:97], v[96:97], v[64:65]
  v_pk_add_f32 v[98:99], v[98:99], v[66:67]
  v_cvt_pk_bf16_f32 v32, v88, v96
  v_cvt_pk_bf16_f32 v33, v89, v97
  v_cvt_pk_bf16_f32 v34, v90, v98
  v_cvt_pk_bf16_f32 v35, v91, v99
  buffer_store_dwordx4 v[32:35], v8, s[24:27], 0 offen offset:64
  v_pk_add_f32 v[92:93], v[92:93], v[60:61]
  v_pk_add_f32 v[94:95], v[94:95], v[62:63]
  v_pk_add_f32 v[100:101], v[100:101], v[68:69]
  v_pk_add_f32 v[102:103], v[102:103], v[70:71]
  v_cvt_pk_bf16_f32 v36, v92, v100
  v_cvt_pk_bf16_f32 v37, v93, v101
  v_cvt_pk_bf16_f32 v38, v94, v102
  v_cvt_pk_bf16_f32 v39, v95, v103
  buffer_store_dwordx4 v[36:39], v8, s[24:27], s83 offen offset:64
  s_or_b32 s87, s2, s56
  s_cmp_eq_u32 s87, 0
  s_cselect_b32 s87, 0, 1073741824
  v_mov_b32 v38, s57
  buffer_store_dword v38, v22, s[16:19], s87 offen sc1
  s_endpgm
L_last:
.section .rodata,"a"
.p2align 6
.amdhsa_kernel standalone__mixer_token_mlp__prompt_kernel
  .amdhsa_next_free_vgpr 512
  .amdhsa_next_free_sgpr 102
  .amdhsa_accum_offset 256
  .amdhsa_group_segment_fixed_size 0
  .amdhsa_kernarg_size 64
  .amdhsa_user_sgpr_count 2
  .amdhsa_user_sgpr_kernarg_segment_ptr 1
  .amdhsa_system_sgpr_workgroup_id_x 1
.end_amdhsa_kernel
```
